```python
import torch

def _softmax(x, axis=-1):
    return torch.softmax(x, dim=axis)

def _gelu(x):
    return torch.nn.functional.gelu(x, approximate='tanh')

def _silu(x):
    return torch.nn.functional.silu(x)

def _sigmoid(x):
    return torch.sigmoid(x)

def _layernorm(x, axis=-1, eps=1e-05):
    m = x.mean(dim=axis, keepdim=True)
    v = x.var(dim=axis, keepdim=True, unbiased=False)
    return (x - m) / torch.sqrt(v + eps)

def _scatter_add(tgt, idx, src, axis=0):
    return tgt.clone().index_add_(axis, idx, src)

def _segment_sum(src, seg, n):
    out = torch.zeros((n,) + src.shape[1:], dtype=src.dtype)
    return out.index_add_(0, seg, src)

def _pad(x, pw):
    flat = tuple((v for pair in reversed(pw) for v in pair))
    return torch.nn.functional.pad(x, flat)
kernel_name = 'parallel_sum__memory_aug_recurrent_mem_tr__moe_arch_mod__prompt'

def setup_inputs():

    _w = lambda a: (lambda t: t.to(torch.bfloat16) if t.is_floating_point() else t)(torch.as_tensor(a))

    def _A_setup():
        B, S, Dm = (1, 2048, 512)
        H, Dh = (32, 128)
        M, seg = (8, 32)
        seg = min(seg, S)
        S = S // seg * seg
        return {'x': _w((lambda *s: torch.randn(*s, dtype=torch.bfloat16) * 0.05)(B, S, Dm)), 'mem0': _w((lambda *s: torch.randn(*s, dtype=torch.bfloat16) * 1.6)(B, M, Dm)), 'Wq': _w((lambda *s: torch.randn(*s, dtype=torch.bfloat16) * 0.8)(Dm, H, Dh) * Dm ** (-0.5)), 'Wk': _w((lambda *s: torch.randn(*s, dtype=torch.bfloat16) * 0.8)(Dm, H, Dh) * Dm ** (-0.5)), 'Wv': _w((lambda *s: torch.randn(*s, dtype=torch.bfloat16) * 1.6)(Dm, H, Dh) * Dm ** (-0.5)), 'Wo': _w((lambda *s: torch.randn(*s, dtype=torch.bfloat16) * 1.6)(H, Dh, Dm) * (H * Dh) ** (-0.5)), 'seg_len': seg}
    _A_in = _A_setup()

    def _B_setup():
        B, S, D, F, C = (1, 2048, 512, 1792, 8)
        return {'x': _w((lambda *s: torch.randn(*s, dtype=torch.bfloat16) * 0.05)(B, S, D)), 'w_r': _w((lambda *s: torch.randn(*s, dtype=torch.bfloat16) * 0.05)(D)), 'w_gate': _w((lambda *s: torch.randn(*s, dtype=torch.bfloat16) * 0.05)(D, F)), 'w_up': _w((lambda *s: torch.randn(*s, dtype=torch.bfloat16) * 0.05)(D, F)), 'w_down': _w((lambda *s: torch.randn(*s, dtype=torch.bfloat16) * 0.05)(F, D))}
    _B_in = _B_setup()
    return {'A_x': _A_in['x'], 'A_mem0': _A_in['mem0'], 'A_Wq': _A_in['Wq'], 'A_Wk': _A_in['Wk'], 'A_Wv': _A_in['Wv'], 'A_Wo': _A_in['Wo'], 'A_seg_len': _A_in['seg_len'], 'B_x': _B_in['x'], 'B_w_r': _B_in['w_r'], 'B_w_gate': _B_in['w_gate'], 'B_w_up': _B_in['w_up'], 'B_w_down': _B_in['w_down']}

def reference(A_x, A_mem0, A_Wq, A_Wk, A_Wv, A_Wo, A_seg_len, B_x, B_w_r, B_w_gate, B_w_up, B_w_down):

    def _A_ref(x, mem0, Wq, Wk, Wv, Wo, seg_len):
        B, S, Dm = x.shape
        H, Dh = (Wq.shape[1], Wq.shape[2])
        M = mem0.shape[1]
        scale = Dh ** (-0.5)
        n_seg = S // seg_len
        L = M + seg_len
        idx = torch.arange(L)
        mask = (idx[:, None] < M) | (idx[:, None] >= idx[None, :])
        mem = mem0
        outs = []
        for s in range(n_seg):
            xs = x[:, s * seg_len:(s + 1) * seg_len, :].clone()
            h = torch.concatenate([mem, xs], axis=1)
            q = torch.einsum('btd,dhe->bhte', h, Wq)
            k = torch.einsum('btd,dhe->bhte', h, Wk)
            v = torch.einsum('btd,dhe->bhte', h, Wv)
            scores = torch.einsum('bhqe,bhke->bhqk', q, k) * scale
            scores = torch.where(mask[None, None], scores, -1000000000.0)
            p = _softmax(scores, axis=-1)
            o = torch.einsum('bhqk,bhke->bhqe', p, v)
            o = torch.einsum('bhte,hed->btd', o, Wo)
            mem = o[:, :M, :].clone()
            outs.append(o[:, M:, :])
        return torch.concatenate(outs, axis=1)

    def _B_ref(x, w_r, w_gate, w_up, w_down):
        B, S, D = x.shape
        C = 8
        r = x @ w_r
        idx = torch.argsort(-r, axis=-1)[:, :C]
        idx_e = (lambda x, n, axis: torch.repeat_interleave(x, n, dim=axis))(idx.reshape(B, C, 1), D, axis=2)
        x_sel = (lambda x, i, axis: torch.take_along_dim(x, i, dim=axis))(x, idx_e, axis=1)
        g = _silu(x_sel @ w_gate)
        u = x_sel @ w_up
        y = g * u @ w_down
        r_sel = _sigmoid((lambda x, i, axis: torch.take_along_dim(x, i, dim=axis))(r, idx, axis=1))
        y = y * r_sel.reshape(B, C, 1)
        b_off = (torch.arange(B) * S).reshape(B, 1)
        flat_idx = (idx + b_off).reshape(B * C)
        zero = (x * 0.0).reshape(B * S, D)
        upd = _scatter_add(zero, flat_idx, y.reshape(B * C, D), axis=0)
        return x + upd.reshape(B, S, D)
    x = A_x
    xn = _layernorm(x, axis=-1)
    return x + _A_ref(xn, A_mem0, A_Wq, A_Wk, A_Wv, A_Wo, A_seg_len) + _B_ref(xn, B_w_r, B_w_gate, B_w_up, B_w_down)
```

```asm
; @launch kernel=main_kernel grid=(256,1,1) block=(256,1,1) lds=162816
.amdgcn_target "amdgcn-amd-amdhsa--gfx950"
.text
.globl main_kernel
.p2align 8
.type main_kernel,@function
main_kernel:
    s_cmp_ge_u32 s2, 256
    s_cbranch_scc1 CH_END
    s_and_b32 s3, s2, 7
    s_cmp_lg_u32 s3, 0
    s_cbranch_scc1 WK_START
    s_lshr_b32 s6, s2, 3
    s_load_dwordx2 s[4:5], s[0:1], 112
    s_load_dwordx2 s[8:9], s[0:1], 8
    s_load_dwordx2 s[28:29], s[0:1], 104
    v_lshrrev_b32 v1, 6, v0
    v_and_b32 v2, 63, v0
    s_nop 0
    v_readfirstlane_b32 s3, v1
    v_lshlrev_b32 v3, 4, v2
    s_getreg_b32 s24, hwreg(HW_REG_XCC_ID)
    s_and_b32 s24, s24, 15
    s_add_u32 s24, s24, 1
    s_memrealtime s[30:31]
    s_waitcnt lgkmcnt(0)
    s_or_b32 s46, s30, 1
    s_lshl_b32 s25, s6, 2
    s_add_u32 s25, s25, s3
    s_lshl_b32 s26, s25, 2
    s_add_u32 s26, s26, 4390912
    s_add_u32 s30, s4, s26
    s_addc_u32 s31, s5, 0
    s_add_u32 s36, s28, 128
    s_addc_u32 s37, s29, 0
    s_cmp_eq_u32 s25, 0
    s_cselect_b32 s30, s36, s30
    s_cselect_b32 s31, s37, s31
    v_mov_b32 v4, 0
    v_mov_b32 v5, s46
    s_mov_b64 exec, 1
    global_store_dword v4, v5, s[30:31] sc0 sc1
    s_mov_b64 exec, -1
    s_mov_b32 s49, s25
    v_mov_b32 v4, s49
    v_mov_b32 v5, s24
    s_mov_b64 exec, 1
    global_store_byte v4, v5, s[28:29] sc0 sc1
    s_mov_b64 exec, -1
    s_load_dwordx2 s[12:13], s[0:1], 16
    s_load_dwordx2 s[14:15], s[0:1], 24
    s_load_dwordx2 s[16:17], s[0:1], 32
    s_load_dwordx2 s[18:19], s[0:1], 40
    v_and_b32 v16, 1, v2
    v_lshlrev_b32 v16, 4, v16
    v_mov_b32 v17, 0x3f80
    v_lshlrev_b32 v16, v16, v17
    v_lshrrev_b32 v17, 4, v2
    v_bfe_u32 v18, v2, 3, 1
    v_sub_u32 v17, v17, v18
    v_lshlrev_b32 v17, 2, v17
    v_bfe_u32 v18, v2, 1, 2
    v_add_u32 v17, v17, v18
    v_cmp_eq_u32 vcc, 0, v17
    s_nop 1
    v_cndmask_b32 v8, 0, v16, vcc
    v_cmp_eq_u32 vcc, 1, v17
    s_nop 1
    v_cndmask_b32 v9, 0, v16, vcc
    v_cmp_eq_u32 vcc, 2, v17
    s_nop 1
    v_cndmask_b32 v10, 0, v16, vcc
    v_cmp_eq_u32 vcc, 3, v17
    s_nop 1
    v_cndmask_b32 v11, 0, v16, vcc
    v_cmp_eq_u32 vcc, 8, v17
    s_nop 1
    v_cndmask_b32 v12, 0, v16, vcc
    v_cmp_eq_u32 vcc, 9, v17
    s_nop 1
    v_cndmask_b32 v13, 0, v16, vcc
    v_cmp_eq_u32 vcc, 10, v17
    s_nop 1
    v_cndmask_b32 v14, 0, v16, vcc
    v_cmp_eq_u32 vcc, 11, v17
    s_nop 1
    v_cndmask_b32 v15, 0, v16, vcc
    v_bfe_u32 v16, v2, 2, 2
    v_lshlrev_b32 v16, 3, v16
    v_and_b32 v17, 3, v2
    v_add_u32 v16, v16, v17
    v_lshlrev_b32 v16, 13, v16
    v_lshrrev_b32 v17, 4, v2
    v_lshlrev_b32 v17, 4, v17
    v_add_u32 v4, v16, v17
    v_add_u32 v5, 32768, v4
    v_and_b32 v16, 15, v2
    v_lshlrev_b32 v16, 10, v16
    v_add_u32 v6, v16, v17
    v_add_u32 v7, 16384, v6
    s_waitcnt lgkmcnt(0)
    s_lshl_b32 s25, s6, 8
    s_lshl_b32 s26, s3, 6
    s_add_u32 s25, s25, s26
    s_add_u32 s12, s12, s25
    s_addc_u32 s13, s13, 0
    s_add_u32 s14, s14, s25
    s_addc_u32 s15, s15, 0
    s_add_u32 s16, s16, s25
    s_addc_u32 s17, s17, 0
    s_lshl_b32 s25, s6, 17
    s_lshl_b32 s26, s3, 15
    s_add_u32 s25, s25, s26
    s_add_u32 s18, s18, s25
    s_addc_u32 s19, s19, 0
    v_add_u32 v1, s26, v3
    v_add_u32 v1, 16384, v1
    s_lshl_b32 s26, s3, 11
    s_add_u32 s26, s26, 8192
    s_mov_b32 m0, s26
    s_lshl_b32 s48, s3, 20
    global_load_dwordx4 v[16:19], v6, s[18:19] offset:0
    global_load_dwordx4 v[20:23], v7, s[18:19] offset:0
    global_load_dwordx4 v[24:27], v6, s[18:19] offset:64
    global_load_dwordx4 v[28:31], v7, s[18:19] offset:64
    global_load_dwordx4 v[32:35], v6, s[18:19] offset:128
    global_load_dwordx4 v[36:39], v7, s[18:19] offset:128
    global_load_dwordx4 v[40:43], v6, s[18:19] offset:192
    global_load_dwordx4 v[44:47], v7, s[18:19] offset:192
    global_load_dwordx4 v[48:51], v6, s[18:19] offset:256
    global_load_dwordx4 v[52:55], v7, s[18:19] offset:256
    global_load_dwordx4 v[56:59], v6, s[18:19] offset:320
    global_load_dwordx4 v[60:63], v7, s[18:19] offset:320
    global_load_dwordx4 v[64:67], v6, s[18:19] offset:384
    global_load_dwordx4 v[68:71], v7, s[18:19] offset:384
    global_load_dwordx4 v[72:75], v6, s[18:19] offset:448
    global_load_dwordx4 v[76:79], v7, s[18:19] offset:448
    s_xor_b32 s37, s48, 0
    s_add_u32 s36, s12, s37
    s_addc_u32 s37, s13, 0
    global_load_dwordx4 a[0:3], v4, s[36:37]
    global_load_dwordx4 a[8:11], v5, s[36:37]
    s_xor_b32 s37, s48, 262144
    s_add_u32 s36, s12, s37
    s_addc_u32 s37, s13, 0
    global_load_dwordx4 a[4:7], v4, s[36:37]
    global_load_dwordx4 a[12:15], v5, s[36:37]
    s_xor_b32 s37, s48, 524288
    s_add_u32 s36, s12, s37
    s_addc_u32 s37, s13, 0
    global_load_dwordx4 a[16:19], v4, s[36:37]
    global_load_dwordx4 a[24:27], v5, s[36:37]
    s_xor_b32 s37, s48, 786432
    s_add_u32 s36, s12, s37
    s_addc_u32 s37, s13, 0
    global_load_dwordx4 a[20:23], v4, s[36:37]
    global_load_dwordx4 a[28:31], v5, s[36:37]
    s_xor_b32 s37, s48, 1048576
    s_add_u32 s36, s12, s37
    s_addc_u32 s37, s13, 0
    global_load_dwordx4 a[32:35], v4, s[36:37]
    global_load_dwordx4 a[40:43], v5, s[36:37]
    s_xor_b32 s37, s48, 1310720
    s_add_u32 s36, s12, s37
    s_addc_u32 s37, s13, 0
    global_load_dwordx4 a[36:39], v4, s[36:37]
    global_load_dwordx4 a[44:47], v5, s[36:37]
    s_xor_b32 s37, s48, 1572864
    s_add_u32 s36, s12, s37
    s_addc_u32 s37, s13, 0
    global_load_dwordx4 a[48:51], v4, s[36:37]
    global_load_dwordx4 a[56:59], v5, s[36:37]
    s_xor_b32 s37, s48, 1835008
    s_add_u32 s36, s12, s37
    s_addc_u32 s37, s13, 0
    global_load_dwordx4 a[52:55], v4, s[36:37]
    global_load_dwordx4 a[60:63], v5, s[36:37]
    s_xor_b32 s37, s48, 2097152
    s_add_u32 s36, s12, s37
    s_addc_u32 s37, s13, 0
    global_load_dwordx4 a[64:67], v4, s[36:37]
    global_load_dwordx4 a[72:75], v5, s[36:37]
    s_lshl_b32 s25, s6, 19
    s_lshl_b32 s26, s3, 11
    s_add_u32 s25, s25, s26
    s_add_u32 s26, s25, 50331648
    s_add_u32 s72, s4, s26
    s_addc_u32 s73, s5, 0
    s_add_u32 s26, s25, 67108864
    s_add_u32 s74, s4, s26
    s_addc_u32 s75, s5, 0
    s_lshl_b32 s34, s6, 9
    s_add_u32 s34, s34, 4456448
    s_waitcnt vmcnt(32)
    v_mfma_f32_16x16x32_bf16 v[96:99], v[16:19], v[8:11], 0
    v_mfma_f32_16x16x32_bf16 v[100:103], v[16:19], v[12:15], 0
    v_mfma_f32_16x16x32_bf16 v[104:107], v[20:23], v[8:11], 0
    v_mfma_f32_16x16x32_bf16 v[108:111], v[20:23], v[12:15], 0
    global_load_dwordx4 v[16:19], v6, s[18:19] offset:512
    global_load_dwordx4 v[20:23], v7, s[18:19] offset:512
    s_xor_b32 s37, s48, 2359296
    s_add_u32 s36, s12, s37
    s_addc_u32 s37, s13, 0
    global_load_dwordx4 a[68:71], v4, s[36:37]
    global_load_dwordx4 a[76:79], v5, s[36:37]
    s_waitcnt vmcnt(34)
    v_mfma_f32_16x16x32_bf16 v[112:115], v[24:27], v[8:11], 0
    v_mfma_f32_16x16x32_bf16 v[116:119], v[24:27], v[12:15], 0
    v_mfma_f32_16x16x32_bf16 v[120:123], v[28:31], v[8:11], 0
    v_mfma_f32_16x16x32_bf16 v[124:127], v[28:31], v[12:15], 0
    v_cvt_pk_bf16_f32 v80, v96, v97
    v_cvt_pk_bf16_f32 v81, v98, v99
    v_cvt_pk_bf16_f32 v82, v104, v105
    v_cvt_pk_bf16_f32 v83, v106, v107
    v_cvt_pk_bf16_f32 v84, v100, v101
    v_cvt_pk_bf16_f32 v85, v102, v103
    v_cvt_pk_bf16_f32 v86, v108, v109
    v_cvt_pk_bf16_f32 v87, v110, v111
    ds_write_b128 v1, v[80:83] offset:0
    ds_write_b128 v1, v[84:87] offset:1024
    global_load_dwordx4 v[24:27], v6, s[18:19] offset:576
    global_load_dwordx4 v[28:31], v7, s[18:19] offset:576
    s_waitcnt vmcnt(34)
    v_mfma_f32_16x16x32_bf16 v[96:99], v[32:35], v[8:11], 0
    v_mfma_f32_16x16x32_bf16 v[100:103], v[32:35], v[12:15], 0
    v_mfma_f32_16x16x32_bf16 v[104:107], v[36:39], v[8:11], 0
    v_mfma_f32_16x16x32_bf16 v[108:111], v[36:39], v[12:15], 0
    v_cvt_pk_bf16_f32 v80, v112, v113
    v_cvt_pk_bf16_f32 v81, v114, v115
    v_cvt_pk_bf16_f32 v82, v120, v121
    v_cvt_pk_bf16_f32 v83, v122, v123
    v_cvt_pk_bf16_f32 v84, v116, v117
    v_cvt_pk_bf16_f32 v85, v118, v119
    v_cvt_pk_bf16_f32 v86, v124, v125
    v_cvt_pk_bf16_f32 v87, v126, v127
    ds_write_b128 v1, v[80:83] offset:2048
    ds_write_b128 v1, v[84:87] offset:3072
    global_load_dwordx4 v[32:35], v6, s[18:19] offset:640
    global_load_dwordx4 v[36:39], v7, s[18:19] offset:640
    s_waitcnt vmcnt(34)
    v_mfma_f32_16x16x32_bf16 v[112:115], v[40:43], v[8:11], 0
    v_mfma_f32_16x16x32_bf16 v[116:119], v[40:43], v[12:15], 0
    v_mfma_f32_16x16x32_bf16 v[120:123], v[44:47], v[8:11], 0
    v_mfma_f32_16x16x32_bf16 v[124:127], v[44:47], v[12:15], 0
    v_cvt_pk_bf16_f32 v80, v96, v97
    v_cvt_pk_bf16_f32 v81, v98, v99
    v_cvt_pk_bf16_f32 v82, v104, v105
    v_cvt_pk_bf16_f32 v83, v106, v107
    v_cvt_pk_bf16_f32 v84, v100, v101
    v_cvt_pk_bf16_f32 v85, v102, v103
    v_cvt_pk_bf16_f32 v86, v108, v109
    v_cvt_pk_bf16_f32 v87, v110, v111
    ds_write_b128 v1, v[80:83] offset:4096
    ds_write_b128 v1, v[84:87] offset:5120
    global_load_dwordx4 v[40:43], v6, s[18:19] offset:704
    global_load_dwordx4 v[44:47], v7, s[18:19] offset:704
    s_waitcnt vmcnt(34)
    v_mfma_f32_16x16x32_bf16 v[96:99], v[48:51], v[8:11], 0
    v_mfma_f32_16x16x32_bf16 v[100:103], v[48:51], v[12:15], 0
    v_mfma_f32_16x16x32_bf16 v[104:107], v[52:55], v[8:11], 0
    v_mfma_f32_16x16x32_bf16 v[108:111], v[52:55], v[12:15], 0
    v_cvt_pk_bf16_f32 v80, v112, v113
    v_cvt_pk_bf16_f32 v81, v114, v115
    v_cvt_pk_bf16_f32 v82, v120, v121
    v_cvt_pk_bf16_f32 v83, v122, v123
    v_cvt_pk_bf16_f32 v84, v116, v117
    v_cvt_pk_bf16_f32 v85, v118, v119
    v_cvt_pk_bf16_f32 v86, v124, v125
    v_cvt_pk_bf16_f32 v87, v126, v127
    ds_write_b128 v1, v[80:83] offset:6144
    ds_write_b128 v1, v[84:87] offset:7168
    global_load_dwordx4 v[48:51], v6, s[18:19] offset:768
    global_load_dwordx4 v[52:55], v7, s[18:19] offset:768
    s_waitcnt vmcnt(34)
    v_mfma_f32_16x16x32_bf16 v[112:115], v[56:59], v[8:11], 0
    v_mfma_f32_16x16x32_bf16 v[116:119], v[56:59], v[12:15], 0
    v_mfma_f32_16x16x32_bf16 v[120:123], v[60:63], v[8:11], 0
    v_mfma_f32_16x16x32_bf16 v[124:127], v[60:63], v[12:15], 0
    v_cvt_pk_bf16_f32 v80, v96, v97
    v_cvt_pk_bf16_f32 v81, v98, v99
    v_cvt_pk_bf16_f32 v82, v104, v105
    v_cvt_pk_bf16_f32 v83, v106, v107
    v_cvt_pk_bf16_f32 v84, v100, v101
    v_cvt_pk_bf16_f32 v85, v102, v103
    v_cvt_pk_bf16_f32 v86, v108, v109
    v_cvt_pk_bf16_f32 v87, v110, v111
    ds_write_b128 v1, v[80:83] offset:8192
    ds_write_b128 v1, v[84:87] offset:9216
    global_load_dwordx4 v[56:59], v6, s[18:19] offset:832
    global_load_dwordx4 v[60:63], v7, s[18:19] offset:832
    s_waitcnt vmcnt(34)
    v_mfma_f32_16x16x32_bf16 v[96:99], v[64:67], v[8:11], 0
    v_mfma_f32_16x16x32_bf16 v[100:103], v[64:67], v[12:15], 0
    v_mfma_f32_16x16x32_bf16 v[104:107], v[68:71], v[8:11], 0
    v_mfma_f32_16x16x32_bf16 v[108:111], v[68:71], v[12:15], 0
    v_cvt_pk_bf16_f32 v80, v112, v113
    v_cvt_pk_bf16_f32 v81, v114, v115
    v_cvt_pk_bf16_f32 v82, v120, v121
    v_cvt_pk_bf16_f32 v83, v122, v123
    v_cvt_pk_bf16_f32 v84, v116, v117
    v_cvt_pk_bf16_f32 v85, v118, v119
    v_cvt_pk_bf16_f32 v86, v124, v125
    v_cvt_pk_bf16_f32 v87, v126, v127
    ds_write_b128 v1, v[80:83] offset:10240
    ds_write_b128 v1, v[84:87] offset:11264
    global_load_dwordx4 v[64:67], v6, s[18:19] offset:896
    global_load_dwordx4 v[68:71], v7, s[18:19] offset:896
    s_waitcnt vmcnt(34)
    v_mfma_f32_16x16x32_bf16 v[112:115], v[72:75], v[8:11], 0
    v_mfma_f32_16x16x32_bf16 v[116:119], v[72:75], v[12:15], 0
    v_mfma_f32_16x16x32_bf16 v[120:123], v[76:79], v[8:11], 0
    v_mfma_f32_16x16x32_bf16 v[124:127], v[76:79], v[12:15], 0
    v_cvt_pk_bf16_f32 v80, v96, v97
    v_cvt_pk_bf16_f32 v81, v98, v99
    v_cvt_pk_bf16_f32 v82, v104, v105
    v_cvt_pk_bf16_f32 v83, v106, v107
    v_cvt_pk_bf16_f32 v84, v100, v101
    v_cvt_pk_bf16_f32 v85, v102, v103
    v_cvt_pk_bf16_f32 v86, v108, v109
    v_cvt_pk_bf16_f32 v87, v110, v111
    ds_write_b128 v1, v[80:83] offset:12288
    ds_write_b128 v1, v[84:87] offset:13312
    global_load_dwordx4 v[72:75], v6, s[18:19] offset:960
    global_load_dwordx4 v[76:79], v7, s[18:19] offset:960
    s_waitcnt vmcnt(16)
    v_mfma_f32_16x16x32_bf16 v[96:99], v[16:19], v[8:11], 0
    v_mfma_f32_16x16x32_bf16 v[100:103], v[16:19], v[12:15], 0
    v_mfma_f32_16x16x32_bf16 v[104:107], v[20:23], v[8:11], 0
    v_mfma_f32_16x16x32_bf16 v[108:111], v[20:23], v[12:15], 0
    v_cvt_pk_bf16_f32 v80, v112, v113
    v_cvt_pk_bf16_f32 v81, v114, v115
    v_cvt_pk_bf16_f32 v82, v120, v121
    v_cvt_pk_bf16_f32 v83, v122, v123
    v_cvt_pk_bf16_f32 v84, v116, v117
    v_cvt_pk_bf16_f32 v85, v118, v119
    v_cvt_pk_bf16_f32 v86, v124, v125
    v_cvt_pk_bf16_f32 v87, v126, v127
    ds_write_b128 v1, v[80:83] offset:14336
    ds_write_b128 v1, v[84:87] offset:15360
    s_xor_b32 s37, s48, 2621440
    s_add_u32 s36, s12, s37
    s_addc_u32 s37, s13, 0
    global_load_dwordx4 a[80:83], v4, s[36:37]
    global_load_dwordx4 a[88:91], v5, s[36:37]
    s_xor_b32 s37, s48, 2883584
    s_add_u32 s36, s12, s37
    s_addc_u32 s37, s13, 0
    global_load_dwordx4 a[84:87], v4, s[36:37]
    global_load_dwordx4 a[92:95], v5, s[36:37]
    s_xor_b32 s37, s48, 3145728
    s_add_u32 s36, s12, s37
    s_addc_u32 s37, s13, 0
    global_load_dwordx4 a[96:99], v4, s[36:37]
    global_load_dwordx4 a[104:107], v5, s[36:37]
    s_xor_b32 s37, s48, 3407872
    s_add_u32 s36, s12, s37
    s_addc_u32 s37, s13, 0
    global_load_dwordx4 a[100:103], v4, s[36:37]
    global_load_dwordx4 a[108:111], v5, s[36:37]
    s_xor_b32 s37, s48, 3670016
    s_add_u32 s36, s12, s37
    s_addc_u32 s37, s13, 0
    global_load_dwordx4 a[112:115], v4, s[36:37]
    global_load_dwordx4 a[120:123], v5, s[36:37]
    s_xor_b32 s37, s48, 3932160
    s_add_u32 s36, s12, s37
    s_addc_u32 s37, s13, 0
    global_load_dwordx4 a[116:119], v4, s[36:37]
    global_load_dwordx4 a[124:127], v5, s[36:37]
    s_xor_b32 s37, s48, 0
    s_add_u32 s36, s14, s37
    s_addc_u32 s37, s15, 0
    global_load_dwordx4 a[128:131], v4, s[36:37]
    global_load_dwordx4 a[136:139], v5, s[36:37]
    s_xor_b32 s37, s48, 262144
    s_add_u32 s36, s14, s37
    s_addc_u32 s37, s15, 0
    global_load_dwordx4 a[132:135], v4, s[36:37]
    global_load_dwordx4 a[140:143], v5, s[36:37]
    s_xor_b32 s37, s48, 524288
    s_add_u32 s36, s14, s37
    s_addc_u32 s37, s15, 0
    global_load_dwordx4 a[144:147], v4, s[36:37]
    global_load_dwordx4 a[152:155], v5, s[36:37]
    s_xor_b32 s37, s48, 786432
    s_add_u32 s36, s14, s37
    s_addc_u32 s37, s15, 0
    global_load_dwordx4 a[148:151], v4, s[36:37]
    global_load_dwordx4 a[156:159], v5, s[36:37]
    s_waitcnt vmcnt(32)
    v_mfma_f32_16x16x32_bf16 v[112:115], v[24:27], v[8:11], 0
    v_mfma_f32_16x16x32_bf16 v[116:119], v[24:27], v[12:15], 0
    v_mfma_f32_16x16x32_bf16 v[120:123], v[28:31], v[8:11], 0
    v_mfma_f32_16x16x32_bf16 v[124:127], v[28:31], v[12:15], 0
    v_cvt_pk_bf16_f32 v80, v96, v97
    v_cvt_pk_bf16_f32 v81, v98, v99
    v_cvt_pk_bf16_f32 v82, v104, v105
    v_cvt_pk_bf16_f32 v83, v106, v107
    v_cvt_pk_bf16_f32 v84, v100, v101
    v_cvt_pk_bf16_f32 v85, v102, v103
    v_cvt_pk_bf16_f32 v86, v108, v109
    v_cvt_pk_bf16_f32 v87, v110, v111
    ds_write_b128 v1, v[80:83] offset:16384
    ds_write_b128 v1, v[84:87] offset:17408
    s_xor_b32 s37, s48, 1048576
    s_add_u32 s36, s14, s37
    s_addc_u32 s37, s15, 0
    global_load_dwordx4 a[160:163], v4, s[36:37]
    global_load_dwordx4 a[168:171], v5, s[36:37]
    s_xor_b32 s37, s48, 1310720
    s_add_u32 s36, s14, s37
    s_addc_u32 s37, s15, 0
    global_load_dwordx4 a[164:167], v4, s[36:37]
    global_load_dwordx4 a[172:175], v5, s[36:37]
    s_waitcnt vmcnt(34)
    v_mfma_f32_16x16x32_bf16 v[96:99], v[32:35], v[8:11], 0
    v_mfma_f32_16x16x32_bf16 v[100:103], v[32:35], v[12:15], 0
    v_mfma_f32_16x16x32_bf16 v[104:107], v[36:39], v[8:11], 0
    v_mfma_f32_16x16x32_bf16 v[108:111], v[36:39], v[12:15], 0
    v_cvt_pk_bf16_f32 v80, v112, v113
    v_cvt_pk_bf16_f32 v81, v114, v115
    v_cvt_pk_bf16_f32 v82, v120, v121
    v_cvt_pk_bf16_f32 v83, v122, v123
    v_cvt_pk_bf16_f32 v84, v116, v117
    v_cvt_pk_bf16_f32 v85, v118, v119
    v_cvt_pk_bf16_f32 v86, v124, v125
    v_cvt_pk_bf16_f32 v87, v126, v127
    ds_write_b128 v1, v[80:83] offset:18432
    ds_write_b128 v1, v[84:87] offset:19456
    s_xor_b32 s37, s48, 1572864
    s_add_u32 s36, s14, s37
    s_addc_u32 s37, s15, 0
    global_load_dwordx4 a[176:179], v4, s[36:37]
    global_load_dwordx4 a[184:187], v5, s[36:37]
    s_waitcnt vmcnt(34)
    v_mfma_f32_16x16x32_bf16 v[112:115], v[40:43], v[8:11], 0
    v_mfma_f32_16x16x32_bf16 v[116:119], v[40:43], v[12:15], 0
    v_mfma_f32_16x16x32_bf16 v[120:123], v[44:47], v[8:11], 0
    v_mfma_f32_16x16x32_bf16 v[124:127], v[44:47], v[12:15], 0
    v_cvt_pk_bf16_f32 v80, v96, v97
    v_cvt_pk_bf16_f32 v81, v98, v99
    v_cvt_pk_bf16_f32 v82, v104, v105
    v_cvt_pk_bf16_f32 v83, v106, v107
    v_cvt_pk_bf16_f32 v84, v100, v101
    v_cvt_pk_bf16_f32 v85, v102, v103
    v_cvt_pk_bf16_f32 v86, v108, v109
    v_cvt_pk_bf16_f32 v87, v110, v111
    ds_write_b128 v1, v[80:83] offset:20480
    ds_write_b128 v1, v[84:87] offset:21504
    s_xor_b32 s37, s48, 1835008
    s_add_u32 s36, s14, s37
    s_addc_u32 s37, s15, 0
    global_load_dwordx4 a[180:183], v4, s[36:37]
    global_load_dwordx4 a[188:191], v5, s[36:37]
    s_waitcnt vmcnt(34)
    v_mfma_f32_16x16x32_bf16 v[96:99], v[48:51], v[8:11], 0
    v_mfma_f32_16x16x32_bf16 v[100:103], v[48:51], v[12:15], 0
    v_mfma_f32_16x16x32_bf16 v[104:107], v[52:55], v[8:11], 0
    v_mfma_f32_16x16x32_bf16 v[108:111], v[52:55], v[12:15], 0
    v_cvt_pk_bf16_f32 v80, v112, v113
    v_cvt_pk_bf16_f32 v81, v114, v115
    v_cvt_pk_bf16_f32 v82, v120, v121
    v_cvt_pk_bf16_f32 v83, v122, v123
    v_cvt_pk_bf16_f32 v84, v116, v117
    v_cvt_pk_bf16_f32 v85, v118, v119
    v_cvt_pk_bf16_f32 v86, v124, v125
    v_cvt_pk_bf16_f32 v87, v126, v127
    ds_write_b128 v1, v[80:83] offset:22528
    ds_write_b128 v1, v[84:87] offset:23552
    s_xor_b32 s37, s48, 2097152
    s_add_u32 s36, s14, s37
    s_addc_u32 s37, s15, 0
    global_load_dwordx4 a[192:195], v4, s[36:37]
    global_load_dwordx4 a[200:203], v5, s[36:37]
    s_waitcnt vmcnt(34)
    v_mfma_f32_16x16x32_bf16 v[112:115], v[56:59], v[8:11], 0
    v_mfma_f32_16x16x32_bf16 v[116:119], v[56:59], v[12:15], 0
    v_mfma_f32_16x16x32_bf16 v[120:123], v[60:63], v[8:11], 0
    v_mfma_f32_16x16x32_bf16 v[124:127], v[60:63], v[12:15], 0
    v_cvt_pk_bf16_f32 v80, v96, v97
    v_cvt_pk_bf16_f32 v81, v98, v99
    v_cvt_pk_bf16_f32 v82, v104, v105
    v_cvt_pk_bf16_f32 v83, v106, v107
    v_cvt_pk_bf16_f32 v84, v100, v101
    v_cvt_pk_bf16_f32 v85, v102, v103
    v_cvt_pk_bf16_f32 v86, v108, v109
    v_cvt_pk_bf16_f32 v87, v110, v111
    ds_write_b128 v1, v[80:83] offset:24576
    ds_write_b128 v1, v[84:87] offset:25600
    s_xor_b32 s37, s48, 2359296
    s_add_u32 s36, s14, s37
    s_addc_u32 s37, s15, 0
    global_load_dwordx4 a[196:199], v4, s[36:37]
    global_load_dwordx4 a[204:207], v5, s[36:37]
    s_waitcnt vmcnt(34)
    v_mfma_f32_16x16x32_bf16 v[96:99], v[64:67], v[8:11], 0
    v_mfma_f32_16x16x32_bf16 v[100:103], v[64:67], v[12:15], 0
    v_mfma_f32_16x16x32_bf16 v[104:107], v[68:71], v[8:11], 0
    v_mfma_f32_16x16x32_bf16 v[108:111], v[68:71], v[12:15], 0
    v_cvt_pk_bf16_f32 v80, v112, v113
    v_cvt_pk_bf16_f32 v81, v114, v115
    v_cvt_pk_bf16_f32 v82, v120, v121
    v_cvt_pk_bf16_f32 v83, v122, v123
    v_cvt_pk_bf16_f32 v84, v116, v117
    v_cvt_pk_bf16_f32 v85, v118, v119
    v_cvt_pk_bf16_f32 v86, v124, v125
    v_cvt_pk_bf16_f32 v87, v126, v127
    ds_write_b128 v1, v[80:83] offset:26624
    ds_write_b128 v1, v[84:87] offset:27648
    s_xor_b32 s37, s48, 2621440
    s_add_u32 s36, s14, s37
    s_addc_u32 s37, s15, 0
    global_load_dwordx4 a[208:211], v4, s[36:37]
    global_load_dwordx4 a[216:219], v5, s[36:37]
    s_waitcnt vmcnt(34)
    v_mfma_f32_16x16x32_bf16 v[112:115], v[72:75], v[8:11], 0
    v_mfma_f32_16x16x32_bf16 v[116:119], v[72:75], v[12:15], 0
    v_mfma_f32_16x16x32_bf16 v[120:123], v[76:79], v[8:11], 0
    v_mfma_f32_16x16x32_bf16 v[124:127], v[76:79], v[12:15], 0
    v_cvt_pk_bf16_f32 v80, v96, v97
    v_cvt_pk_bf16_f32 v81, v98, v99
    v_cvt_pk_bf16_f32 v82, v104, v105
    v_cvt_pk_bf16_f32 v83, v106, v107
    v_cvt_pk_bf16_f32 v84, v100, v101
    v_cvt_pk_bf16_f32 v85, v102, v103
    v_cvt_pk_bf16_f32 v86, v108, v109
    v_cvt_pk_bf16_f32 v87, v110, v111
    ds_write_b128 v1, v[80:83] offset:28672
    ds_write_b128 v1, v[84:87] offset:29696
    s_xor_b32 s37, s48, 2883584
    s_add_u32 s36, s14, s37
    s_addc_u32 s37, s15, 0
    global_load_dwordx4 a[212:215], v4, s[36:37]
    global_load_dwordx4 a[220:223], v5, s[36:37]
    v_mfma_f32_16x16x32_bf16 v[96:99], a[0:3], v[8:11], 0
    v_mfma_f32_16x16x32_bf16 v[100:103], a[0:3], v[12:15], 0
    v_mfma_f32_16x16x32_bf16 v[104:107], a[8:11], v[8:11], 0
    v_mfma_f32_16x16x32_bf16 v[108:111], a[8:11], v[12:15], 0
    v_cvt_pk_bf16_f32 v80, v112, v113
    v_cvt_pk_bf16_f32 v81, v114, v115
    v_cvt_pk_bf16_f32 v82, v120, v121
    v_cvt_pk_bf16_f32 v83, v122, v123
    v_cvt_pk_bf16_f32 v84, v116, v117
    v_cvt_pk_bf16_f32 v85, v118, v119
    v_cvt_pk_bf16_f32 v86, v124, v125
    v_cvt_pk_bf16_f32 v87, v126, v127
    ds_write_b128 v1, v[80:83] offset:30720
    ds_write_b128 v1, v[84:87] offset:31744
    v_mfma_f32_16x16x32_bf16 v[112:115], a[4:7], v[8:11], 0
    v_mfma_f32_16x16x32_bf16 v[116:119], a[4:7], v[12:15], 0
    v_mfma_f32_16x16x32_bf16 v[120:123], a[12:15], v[8:11], 0
    v_mfma_f32_16x16x32_bf16 v[124:127], a[12:15], v[12:15], 0
    v_cvt_pk_bf16_f32 v88, v96, v97
    v_cvt_pk_bf16_f32 v89, v98, v99
    v_cvt_pk_bf16_f32 v90, v104, v105
    v_cvt_pk_bf16_f32 v91, v106, v107
    v_cvt_pk_bf16_f32 v92, v100, v101
    v_cvt_pk_bf16_f32 v93, v102, v103
    v_cvt_pk_bf16_f32 v94, v108, v109
    v_cvt_pk_bf16_f32 v95, v110, v111
    s_nop 0
    v_accvgpr_write_b32 a0, v88
    v_accvgpr_write_b32 a1, v89
    v_accvgpr_write_b32 a2, v90
    v_accvgpr_write_b32 a3, v91
    v_accvgpr_write_b32 a8, v92
    v_accvgpr_write_b32 a9, v93
    v_accvgpr_write_b32 a10, v94
    v_accvgpr_write_b32 a11, v95
    v_mfma_f32_16x16x32_bf16 v[32:35], a[16:19], v[8:11], 0
    v_mfma_f32_16x16x32_bf16 v[36:39], a[16:19], v[12:15], 0
    v_mfma_f32_16x16x32_bf16 v[40:43], a[24:27], v[8:11], 0
    v_mfma_f32_16x16x32_bf16 v[44:47], a[24:27], v[12:15], 0
    v_cvt_pk_bf16_f32 v88, v112, v113
    v_cvt_pk_bf16_f32 v89, v114, v115
    v_cvt_pk_bf16_f32 v90, v120, v121
    v_cvt_pk_bf16_f32 v91, v122, v123
    v_cvt_pk_bf16_f32 v92, v116, v117
    v_cvt_pk_bf16_f32 v93, v118, v119
    v_cvt_pk_bf16_f32 v94, v124, v125
    v_cvt_pk_bf16_f32 v95, v126, v127
    s_nop 0
    v_accvgpr_write_b32 a4, v88
    v_accvgpr_write_b32 a5, v89
    v_accvgpr_write_b32 a6, v90
    v_accvgpr_write_b32 a7, v91
    v_accvgpr_write_b32 a12, v92
    v_accvgpr_write_b32 a13, v93
    v_accvgpr_write_b32 a14, v94
    v_accvgpr_write_b32 a15, v95
    v_mfma_f32_16x16x32_bf16 v[48:51], a[20:23], v[8:11], 0
    v_mfma_f32_16x16x32_bf16 v[52:55], a[20:23], v[12:15], 0
    v_mfma_f32_16x16x32_bf16 v[56:59], a[28:31], v[8:11], 0
    v_mfma_f32_16x16x32_bf16 v[60:63], a[28:31], v[12:15], 0
    v_cvt_pk_bf16_f32 v88, v32, v33
    v_cvt_pk_bf16_f32 v89, v34, v35
    v_cvt_pk_bf16_f32 v90, v40, v41
    v_cvt_pk_bf16_f32 v91, v42, v43
    v_cvt_pk_bf16_f32 v92, v36, v37
    v_cvt_pk_bf16_f32 v93, v38, v39
    v_cvt_pk_bf16_f32 v94, v44, v45
    v_cvt_pk_bf16_f32 v95, v46, v47
    s_nop 0
    v_accvgpr_write_b32 a16, v88
    v_accvgpr_write_b32 a17, v89
    v_accvgpr_write_b32 a18, v90
    v_accvgpr_write_b32 a19, v91
    v_accvgpr_write_b32 a24, v92
    v_accvgpr_write_b32 a25, v93
    v_accvgpr_write_b32 a26, v94
    v_accvgpr_write_b32 a27, v95
    v_mfma_f32_16x16x32_bf16 v[32:35], a[32:35], v[8:11], 0
    v_mfma_f32_16x16x32_bf16 v[36:39], a[32:35], v[12:15], 0
    v_mfma_f32_16x16x32_bf16 v[40:43], a[40:43], v[8:11], 0
    v_mfma_f32_16x16x32_bf16 v[44:47], a[40:43], v[12:15], 0
    v_cvt_pk_bf16_f32 v88, v48, v49
    v_cvt_pk_bf16_f32 v89, v50, v51
    v_cvt_pk_bf16_f32 v90, v56, v57
    v_cvt_pk_bf16_f32 v91, v58, v59
    v_cvt_pk_bf16_f32 v92, v52, v53
    v_cvt_pk_bf16_f32 v93, v54, v55
    v_cvt_pk_bf16_f32 v94, v60, v61
    v_cvt_pk_bf16_f32 v95, v62, v63
    s_nop 0
    v_accvgpr_write_b32 a20, v88
    v_accvgpr_write_b32 a21, v89
    v_accvgpr_write_b32 a22, v90
    v_accvgpr_write_b32 a23, v91
    v_accvgpr_write_b32 a28, v92
    v_accvgpr_write_b32 a29, v93
    v_accvgpr_write_b32 a30, v94
    v_accvgpr_write_b32 a31, v95
    v_mfma_f32_16x16x32_bf16 v[48:51], a[36:39], v[8:11], 0
    v_mfma_f32_16x16x32_bf16 v[52:55], a[36:39], v[12:15], 0
    v_mfma_f32_16x16x32_bf16 v[56:59], a[44:47], v[8:11], 0
    v_mfma_f32_16x16x32_bf16 v[60:63], a[44:47], v[12:15], 0
    v_cvt_pk_bf16_f32 v88, v32, v33
    v_cvt_pk_bf16_f32 v89, v34, v35
    v_cvt_pk_bf16_f32 v90, v40, v41
    v_cvt_pk_bf16_f32 v91, v42, v43
    v_cvt_pk_bf16_f32 v92, v36, v37
    v_cvt_pk_bf16_f32 v93, v38, v39
    v_cvt_pk_bf16_f32 v94, v44, v45
    v_cvt_pk_bf16_f32 v95, v46, v47
    s_nop 0
    v_accvgpr_write_b32 a32, v88
    v_accvgpr_write_b32 a33, v89
    v_accvgpr_write_b32 a34, v90
    v_accvgpr_write_b32 a35, v91
    v_accvgpr_write_b32 a40, v92
    v_accvgpr_write_b32 a41, v93
    v_accvgpr_write_b32 a42, v94
    v_accvgpr_write_b32 a43, v95
    v_mfma_f32_16x16x32_bf16 v[32:35], a[48:51], v[8:11], 0
    v_mfma_f32_16x16x32_bf16 v[36:39], a[48:51], v[12:15], 0
    v_mfma_f32_16x16x32_bf16 v[40:43], a[56:59], v[8:11], 0
    v_mfma_f32_16x16x32_bf16 v[44:47], a[56:59], v[12:15], 0
    v_cvt_pk_bf16_f32 v88, v48, v49
    v_cvt_pk_bf16_f32 v89, v50, v51
    v_cvt_pk_bf16_f32 v90, v56, v57
    v_cvt_pk_bf16_f32 v91, v58, v59
    v_cvt_pk_bf16_f32 v92, v52, v53
    v_cvt_pk_bf16_f32 v93, v54, v55
    v_cvt_pk_bf16_f32 v94, v60, v61
    v_cvt_pk_bf16_f32 v95, v62, v63
    s_nop 0
    v_accvgpr_write_b32 a36, v88
    v_accvgpr_write_b32 a37, v89
    v_accvgpr_write_b32 a38, v90
    v_accvgpr_write_b32 a39, v91
    v_accvgpr_write_b32 a44, v92
    v_accvgpr_write_b32 a45, v93
    v_accvgpr_write_b32 a46, v94
    v_accvgpr_write_b32 a47, v95
    v_mfma_f32_16x16x32_bf16 v[48:51], a[52:55], v[8:11], 0
    v_mfma_f32_16x16x32_bf16 v[52:55], a[52:55], v[12:15], 0
    v_mfma_f32_16x16x32_bf16 v[56:59], a[60:63], v[8:11], 0
    v_mfma_f32_16x16x32_bf16 v[60:63], a[60:63], v[12:15], 0
    v_cvt_pk_bf16_f32 v88, v32, v33
    v_cvt_pk_bf16_f32 v89, v34, v35
    v_cvt_pk_bf16_f32 v90, v40, v41
    v_cvt_pk_bf16_f32 v91, v42, v43
    v_cvt_pk_bf16_f32 v92, v36, v37
    v_cvt_pk_bf16_f32 v93, v38, v39
    v_cvt_pk_bf16_f32 v94, v44, v45
    v_cvt_pk_bf16_f32 v95, v46, v47
    s_nop 0
    v_accvgpr_write_b32 a48, v88
    v_accvgpr_write_b32 a49, v89
    v_accvgpr_write_b32 a50, v90
    v_accvgpr_write_b32 a51, v91
    v_accvgpr_write_b32 a56, v92
    v_accvgpr_write_b32 a57, v93
    v_accvgpr_write_b32 a58, v94
    v_accvgpr_write_b32 a59, v95
    v_mfma_f32_16x16x32_bf16 v[32:35], a[64:67], v[8:11], 0
    v_mfma_f32_16x16x32_bf16 v[36:39], a[64:67], v[12:15], 0
    v_mfma_f32_16x16x32_bf16 v[40:43], a[72:75], v[8:11], 0
    v_mfma_f32_16x16x32_bf16 v[44:47], a[72:75], v[12:15], 0
    v_cvt_pk_bf16_f32 v88, v48, v49
    v_cvt_pk_bf16_f32 v89, v50, v51
    v_cvt_pk_bf16_f32 v90, v56, v57
    v_cvt_pk_bf16_f32 v91, v58, v59
    v_cvt_pk_bf16_f32 v92, v52, v53
    v_cvt_pk_bf16_f32 v93, v54, v55
    v_cvt_pk_bf16_f32 v94, v60, v61
    v_cvt_pk_bf16_f32 v95, v62, v63
    s_nop 0
    v_accvgpr_write_b32 a52, v88
    v_accvgpr_write_b32 a53, v89
    v_accvgpr_write_b32 a54, v90
    v_accvgpr_write_b32 a55, v91
    v_accvgpr_write_b32 a60, v92
    v_accvgpr_write_b32 a61, v93
    v_accvgpr_write_b32 a62, v94
    v_accvgpr_write_b32 a63, v95
    v_mov_b32 v64, 128
    global_load_dword v65, v64, s[28:29] sc0 sc1
    v_mfma_f32_16x16x32_bf16 v[48:51], a[68:71], v[8:11], 0
    v_mfma_f32_16x16x32_bf16 v[52:55], a[68:71], v[12:15], 0
    v_mfma_f32_16x16x32_bf16 v[56:59], a[76:79], v[8:11], 0
    v_mfma_f32_16x16x32_bf16 v[60:63], a[76:79], v[12:15], 0
    v_cvt_pk_bf16_f32 v88, v32, v33
    v_cvt_pk_bf16_f32 v89, v34, v35
    v_cvt_pk_bf16_f32 v90, v40, v41
    v_cvt_pk_bf16_f32 v91, v42, v43
    v_cvt_pk_bf16_f32 v92, v36, v37
    v_cvt_pk_bf16_f32 v93, v38, v39
    v_cvt_pk_bf16_f32 v94, v44, v45
    v_cvt_pk_bf16_f32 v95, v46, v47
    s_nop 0
    v_accvgpr_write_b32 a64, v88
    v_accvgpr_write_b32 a65, v89
    v_accvgpr_write_b32 a66, v90
    v_accvgpr_write_b32 a67, v91
    v_accvgpr_write_b32 a72, v92
    v_accvgpr_write_b32 a73, v93
    v_accvgpr_write_b32 a74, v94
    v_accvgpr_write_b32 a75, v95
    s_waitcnt vmcnt(35)
    v_mfma_f32_16x16x32_bf16 v[32:35], a[80:83], v[8:11], 0
    v_mfma_f32_16x16x32_bf16 v[36:39], a[80:83], v[12:15], 0
    v_mfma_f32_16x16x32_bf16 v[40:43], a[88:91], v[8:11], 0
    v_mfma_f32_16x16x32_bf16 v[44:47], a[88:91], v[12:15], 0
    v_cvt_pk_bf16_f32 v88, v48, v49
    v_cvt_pk_bf16_f32 v89, v50, v51
    v_cvt_pk_bf16_f32 v90, v56, v57
    v_cvt_pk_bf16_f32 v91, v58, v59
    v_cvt_pk_bf16_f32 v92, v52, v53
    v_cvt_pk_bf16_f32 v93, v54, v55
    v_cvt_pk_bf16_f32 v94, v60, v61
    v_cvt_pk_bf16_f32 v95, v62, v63
    s_nop 0
    v_accvgpr_write_b32 a68, v88
    v_accvgpr_write_b32 a69, v89
    v_accvgpr_write_b32 a70, v90
    v_accvgpr_write_b32 a71, v91
    v_accvgpr_write_b32 a76, v92
    v_accvgpr_write_b32 a77, v93
    v_accvgpr_write_b32 a78, v94
    v_accvgpr_write_b32 a79, v95
    s_waitcnt vmcnt(33)
    v_mfma_f32_16x16x32_bf16 v[48:51], a[84:87], v[8:11], 0
    v_mfma_f32_16x16x32_bf16 v[52:55], a[84:87], v[12:15], 0
    v_mfma_f32_16x16x32_bf16 v[56:59], a[92:95], v[8:11], 0
    v_mfma_f32_16x16x32_bf16 v[60:63], a[92:95], v[12:15], 0
    v_cvt_pk_bf16_f32 v88, v32, v33
    v_cvt_pk_bf16_f32 v89, v34, v35
    v_cvt_pk_bf16_f32 v90, v40, v41
    v_cvt_pk_bf16_f32 v91, v42, v43
    v_cvt_pk_bf16_f32 v92, v36, v37
    v_cvt_pk_bf16_f32 v93, v38, v39
    v_cvt_pk_bf16_f32 v94, v44, v45
    v_cvt_pk_bf16_f32 v95, v46, v47
    s_nop 0
    v_accvgpr_write_b32 a80, v88
    v_accvgpr_write_b32 a81, v89
    v_accvgpr_write_b32 a82, v90
    v_accvgpr_write_b32 a83, v91
    v_accvgpr_write_b32 a88, v92
    v_accvgpr_write_b32 a89, v93
    v_accvgpr_write_b32 a90, v94
    v_accvgpr_write_b32 a91, v95
    s_xor_b32 s37, s48, 3145728
    s_add_u32 s36, s14, s37
    s_addc_u32 s37, s15, 0
    global_load_dwordx4 a[224:227], v4, s[36:37]
    global_load_dwordx4 a[232:235], v5, s[36:37]
    s_waitcnt vmcnt(33)
    v_mfma_f32_16x16x32_bf16 v[32:35], a[96:99], v[8:11], 0
    v_mfma_f32_16x16x32_bf16 v[36:39], a[96:99], v[12:15], 0
    v_mfma_f32_16x16x32_bf16 v[40:43], a[104:107], v[8:11], 0
    v_mfma_f32_16x16x32_bf16 v[44:47], a[104:107], v[12:15], 0
    v_cvt_pk_bf16_f32 v88, v48, v49
    v_cvt_pk_bf16_f32 v89, v50, v51
    v_cvt_pk_bf16_f32 v90, v56, v57
    v_cvt_pk_bf16_f32 v91, v58, v59
    v_cvt_pk_bf16_f32 v92, v52, v53
    v_cvt_pk_bf16_f32 v93, v54, v55
    v_cvt_pk_bf16_f32 v94, v60, v61
    v_cvt_pk_bf16_f32 v95, v62, v63
    s_nop 0
    v_accvgpr_write_b32 a84, v88
    v_accvgpr_write_b32 a85, v89
    v_accvgpr_write_b32 a86, v90
    v_accvgpr_write_b32 a87, v91
    v_accvgpr_write_b32 a92, v92
    v_accvgpr_write_b32 a93, v93
    v_accvgpr_write_b32 a94, v94
    v_accvgpr_write_b32 a95, v95
    s_xor_b32 s37, s48, 3407872
    s_add_u32 s36, s14, s37
    s_addc_u32 s37, s15, 0
    global_load_dwordx4 a[228:231], v4, s[36:37]
    global_load_dwordx4 a[236:239], v5, s[36:37]
    s_waitcnt vmcnt(33)
    v_mfma_f32_16x16x32_bf16 v[48:51], a[100:103], v[8:11], 0
    v_mfma_f32_16x16x32_bf16 v[52:55], a[100:103], v[12:15], 0
    v_mfma_f32_16x16x32_bf16 v[56:59], a[108:111], v[8:11], 0
    v_mfma_f32_16x16x32_bf16 v[60:63], a[108:111], v[12:15], 0
    v_cvt_pk_bf16_f32 v88, v32, v33
    v_cvt_pk_bf16_f32 v89, v34, v35
    v_cvt_pk_bf16_f32 v90, v40, v41
    v_cvt_pk_bf16_f32 v91, v42, v43
    v_cvt_pk_bf16_f32 v92, v36, v37
    v_cvt_pk_bf16_f32 v93, v38, v39
    v_cvt_pk_bf16_f32 v94, v44, v45
    v_cvt_pk_bf16_f32 v95, v46, v47
    s_nop 0
    v_accvgpr_write_b32 a96, v88
    v_accvgpr_write_b32 a97, v89
    v_accvgpr_write_b32 a98, v90
    v_accvgpr_write_b32 a99, v91
    v_accvgpr_write_b32 a104, v92
    v_accvgpr_write_b32 a105, v93
    v_accvgpr_write_b32 a106, v94
    v_accvgpr_write_b32 a107, v95
    s_xor_b32 s37, s48, 3670016
    s_add_u32 s36, s14, s37
    s_addc_u32 s37, s15, 0
    global_load_dwordx4 a[240:243], v4, s[36:37]
    global_load_dwordx4 a[248:251], v5, s[36:37]
    s_waitcnt vmcnt(33)
    v_mfma_f32_16x16x32_bf16 v[32:35], a[112:115], v[8:11], 0
    v_mfma_f32_16x16x32_bf16 v[36:39], a[112:115], v[12:15], 0
    v_mfma_f32_16x16x32_bf16 v[40:43], a[120:123], v[8:11], 0
    v_mfma_f32_16x16x32_bf16 v[44:47], a[120:123], v[12:15], 0
    v_cvt_pk_bf16_f32 v88, v48, v49
    v_cvt_pk_bf16_f32 v89, v50, v51
    v_cvt_pk_bf16_f32 v90, v56, v57
    v_cvt_pk_bf16_f32 v91, v58, v59
    v_cvt_pk_bf16_f32 v92, v52, v53
    v_cvt_pk_bf16_f32 v93, v54, v55
    v_cvt_pk_bf16_f32 v94, v60, v61
    v_cvt_pk_bf16_f32 v95, v62, v63
    s_nop 0
    v_accvgpr_write_b32 a100, v88
    v_accvgpr_write_b32 a101, v89
    v_accvgpr_write_b32 a102, v90
    v_accvgpr_write_b32 a103, v91
    v_accvgpr_write_b32 a108, v92
    v_accvgpr_write_b32 a109, v93
    v_accvgpr_write_b32 a110, v94
    v_accvgpr_write_b32 a111, v95
    s_xor_b32 s37, s48, 3932160
    s_add_u32 s36, s14, s37
    s_addc_u32 s37, s15, 0
    global_load_dwordx4 a[244:247], v4, s[36:37]
    global_load_dwordx4 a[252:255], v5, s[36:37]
    s_waitcnt vmcnt(33)
    v_mfma_f32_16x16x32_bf16 v[48:51], a[116:119], v[8:11], 0
    v_mfma_f32_16x16x32_bf16 v[52:55], a[116:119], v[12:15], 0
    v_mfma_f32_16x16x32_bf16 v[56:59], a[124:127], v[8:11], 0
    v_mfma_f32_16x16x32_bf16 v[60:63], a[124:127], v[12:15], 0
    v_cvt_pk_bf16_f32 v88, v32, v33
    v_cvt_pk_bf16_f32 v89, v34, v35
    v_cvt_pk_bf16_f32 v90, v40, v41
    v_cvt_pk_bf16_f32 v91, v42, v43
    v_cvt_pk_bf16_f32 v92, v36, v37
    v_cvt_pk_bf16_f32 v93, v38, v39
    v_cvt_pk_bf16_f32 v94, v44, v45
    v_cvt_pk_bf16_f32 v95, v46, v47
    s_nop 0
    v_accvgpr_write_b32 a112, v88
    v_accvgpr_write_b32 a113, v89
    v_accvgpr_write_b32 a114, v90
    v_accvgpr_write_b32 a115, v91
    v_accvgpr_write_b32 a120, v92
    v_accvgpr_write_b32 a121, v93
    v_accvgpr_write_b32 a122, v94
    v_accvgpr_write_b32 a123, v95
    s_xor_b32 s37, s48, 0
    s_add_u32 s36, s16, s37
    s_addc_u32 s37, s17, 0
    global_load_dwordx4 v[128:131], v4, s[36:37]
    global_load_dwordx4 v[136:139], v5, s[36:37]
    s_waitcnt vmcnt(33)
    v_mfma_f32_16x16x32_bf16 v[32:35], a[128:131], v[8:11], 0
    v_mfma_f32_16x16x32_bf16 v[36:39], a[128:131], v[12:15], 0
    v_mfma_f32_16x16x32_bf16 v[40:43], a[136:139], v[8:11], 0
    v_mfma_f32_16x16x32_bf16 v[44:47], a[136:139], v[12:15], 0
    v_cvt_pk_bf16_f32 v88, v48, v49
    v_cvt_pk_bf16_f32 v89, v50, v51
    v_cvt_pk_bf16_f32 v90, v56, v57
    v_cvt_pk_bf16_f32 v91, v58, v59
    v_cvt_pk_bf16_f32 v92, v52, v53
    v_cvt_pk_bf16_f32 v93, v54, v55
    v_cvt_pk_bf16_f32 v94, v60, v61
    v_cvt_pk_bf16_f32 v95, v62, v63
    s_nop 0
    v_accvgpr_write_b32 a116, v88
    v_accvgpr_write_b32 a117, v89
    v_accvgpr_write_b32 a118, v90
    v_accvgpr_write_b32 a119, v91
    v_accvgpr_write_b32 a124, v92
    v_accvgpr_write_b32 a125, v93
    v_accvgpr_write_b32 a126, v94
    v_accvgpr_write_b32 a127, v95
    s_xor_b32 s37, s48, 262144
    s_add_u32 s36, s16, s37
    s_addc_u32 s37, s17, 0
    global_load_dwordx4 v[132:135], v4, s[36:37]
    global_load_dwordx4 v[140:143], v5, s[36:37]
    s_waitcnt vmcnt(33)
    v_mfma_f32_16x16x32_bf16 v[48:51], a[132:135], v[8:11], 0
    v_mfma_f32_16x16x32_bf16 v[52:55], a[132:135], v[12:15], 0
    v_mfma_f32_16x16x32_bf16 v[56:59], a[140:143], v[8:11], 0
    v_mfma_f32_16x16x32_bf16 v[60:63], a[140:143], v[12:15], 0
    v_cvt_pk_bf16_f32 v88, v32, v33
    v_cvt_pk_bf16_f32 v89, v34, v35
    v_cvt_pk_bf16_f32 v90, v40, v41
    v_cvt_pk_bf16_f32 v91, v42, v43
    v_cvt_pk_bf16_f32 v92, v36, v37
    v_cvt_pk_bf16_f32 v93, v38, v39
    v_cvt_pk_bf16_f32 v94, v44, v45
    v_cvt_pk_bf16_f32 v95, v46, v47
    s_nop 0
    v_accvgpr_write_b32 a128, v88
    v_accvgpr_write_b32 a129, v89
    v_accvgpr_write_b32 a130, v90
    v_accvgpr_write_b32 a131, v91
    v_accvgpr_write_b32 a136, v92
    v_accvgpr_write_b32 a137, v93
    v_accvgpr_write_b32 a138, v94
    v_accvgpr_write_b32 a139, v95
    s_xor_b32 s37, s48, 524288
    s_add_u32 s36, s16, s37
    s_addc_u32 s37, s17, 0
    global_load_dwordx4 v[144:147], v4, s[36:37]
    global_load_dwordx4 v[152:155], v5, s[36:37]
    s_waitcnt vmcnt(33)
    v_mfma_f32_16x16x32_bf16 v[32:35], a[144:147], v[8:11], 0
    v_mfma_f32_16x16x32_bf16 v[36:39], a[144:147], v[12:15], 0
    v_mfma_f32_16x16x32_bf16 v[40:43], a[152:155], v[8:11], 0
    v_mfma_f32_16x16x32_bf16 v[44:47], a[152:155], v[12:15], 0
    v_cvt_pk_bf16_f32 v88, v48, v49
    v_cvt_pk_bf16_f32 v89, v50, v51
    v_cvt_pk_bf16_f32 v90, v56, v57
    v_cvt_pk_bf16_f32 v91, v58, v59
    v_cvt_pk_bf16_f32 v92, v52, v53
    v_cvt_pk_bf16_f32 v93, v54, v55
    v_cvt_pk_bf16_f32 v94, v60, v61
    v_cvt_pk_bf16_f32 v95, v62, v63
    s_nop 0
    v_accvgpr_write_b32 a132, v88
    v_accvgpr_write_b32 a133, v89
    v_accvgpr_write_b32 a134, v90
    v_accvgpr_write_b32 a135, v91
    v_accvgpr_write_b32 a140, v92
    v_accvgpr_write_b32 a141, v93
    v_accvgpr_write_b32 a142, v94
    v_accvgpr_write_b32 a143, v95
    s_xor_b32 s37, s48, 786432
    s_add_u32 s36, s16, s37
    s_addc_u32 s37, s17, 0
    global_load_dwordx4 v[148:151], v4, s[36:37]
    global_load_dwordx4 v[156:159], v5, s[36:37]
    s_waitcnt vmcnt(33)
    v_mfma_f32_16x16x32_bf16 v[48:51], a[148:151], v[8:11], 0
    v_mfma_f32_16x16x32_bf16 v[52:55], a[148:151], v[12:15], 0
    v_mfma_f32_16x16x32_bf16 v[56:59], a[156:159], v[8:11], 0
    v_mfma_f32_16x16x32_bf16 v[60:63], a[156:159], v[12:15], 0
    v_cvt_pk_bf16_f32 v88, v32, v33
    v_cvt_pk_bf16_f32 v89, v34, v35
    v_cvt_pk_bf16_f32 v90, v40, v41
    v_cvt_pk_bf16_f32 v91, v42, v43
    v_cvt_pk_bf16_f32 v92, v36, v37
    v_cvt_pk_bf16_f32 v93, v38, v39
    v_cvt_pk_bf16_f32 v94, v44, v45
    v_cvt_pk_bf16_f32 v95, v46, v47
    s_nop 0
    v_accvgpr_write_b32 a144, v88
    v_accvgpr_write_b32 a145, v89
    v_accvgpr_write_b32 a146, v90
    v_accvgpr_write_b32 a147, v91
    v_accvgpr_write_b32 a152, v92
    v_accvgpr_write_b32 a153, v93
    v_accvgpr_write_b32 a154, v94
    v_accvgpr_write_b32 a155, v95
    s_xor_b32 s37, s48, 1048576
    s_add_u32 s36, s16, s37
    s_addc_u32 s37, s17, 0
    global_load_dwordx4 v[160:163], v4, s[36:37]
    global_load_dwordx4 v[168:171], v5, s[36:37]
    s_waitcnt vmcnt(33)
    v_mfma_f32_16x16x32_bf16 v[32:35], a[160:163], v[8:11], 0
    v_mfma_f32_16x16x32_bf16 v[36:39], a[160:163], v[12:15], 0
    v_mfma_f32_16x16x32_bf16 v[40:43], a[168:171], v[8:11], 0
    v_mfma_f32_16x16x32_bf16 v[44:47], a[168:171], v[12:15], 0
    v_cvt_pk_bf16_f32 v88, v48, v49
    v_cvt_pk_bf16_f32 v89, v50, v51
    v_cvt_pk_bf16_f32 v90, v56, v57
    v_cvt_pk_bf16_f32 v91, v58, v59
    v_cvt_pk_bf16_f32 v92, v52, v53
    v_cvt_pk_bf16_f32 v93, v54, v55
    v_cvt_pk_bf16_f32 v94, v60, v61
    v_cvt_pk_bf16_f32 v95, v62, v63
    s_nop 0
    v_accvgpr_write_b32 a148, v88
    v_accvgpr_write_b32 a149, v89
    v_accvgpr_write_b32 a150, v90
    v_accvgpr_write_b32 a151, v91
    v_accvgpr_write_b32 a156, v92
    v_accvgpr_write_b32 a157, v93
    v_accvgpr_write_b32 a158, v94
    v_accvgpr_write_b32 a159, v95
    s_xor_b32 s37, s48, 1310720
    s_add_u32 s36, s16, s37
    s_addc_u32 s37, s17, 0
    global_load_dwordx4 v[164:167], v4, s[36:37]
    global_load_dwordx4 v[172:175], v5, s[36:37]
    s_waitcnt vmcnt(33)
    v_mfma_f32_16x16x32_bf16 v[48:51], a[164:167], v[8:11], 0
    v_mfma_f32_16x16x32_bf16 v[52:55], a[164:167], v[12:15], 0
    v_mfma_f32_16x16x32_bf16 v[56:59], a[172:175], v[8:11], 0
    v_mfma_f32_16x16x32_bf16 v[60:63], a[172:175], v[12:15], 0
    v_cvt_pk_bf16_f32 v88, v32, v33
    v_cvt_pk_bf16_f32 v89, v34, v35
    v_cvt_pk_bf16_f32 v90, v40, v41
    v_cvt_pk_bf16_f32 v91, v42, v43
    v_cvt_pk_bf16_f32 v92, v36, v37
    v_cvt_pk_bf16_f32 v93, v38, v39
    v_cvt_pk_bf16_f32 v94, v44, v45
    v_cvt_pk_bf16_f32 v95, v46, v47
    s_nop 0
    v_accvgpr_write_b32 a160, v88
    v_accvgpr_write_b32 a161, v89
    v_accvgpr_write_b32 a162, v90
    v_accvgpr_write_b32 a163, v91
    v_accvgpr_write_b32 a168, v92
    v_accvgpr_write_b32 a169, v93
    v_accvgpr_write_b32 a170, v94
    v_accvgpr_write_b32 a171, v95
    s_xor_b32 s37, s48, 1572864
    s_add_u32 s36, s16, s37
    s_addc_u32 s37, s17, 0
    global_load_dwordx4 v[176:179], v4, s[36:37]
    global_load_dwordx4 v[184:187], v5, s[36:37]
    s_waitcnt vmcnt(33)
    v_mfma_f32_16x16x32_bf16 v[32:35], a[176:179], v[8:11], 0
    v_mfma_f32_16x16x32_bf16 v[36:39], a[176:179], v[12:15], 0
    v_mfma_f32_16x16x32_bf16 v[40:43], a[184:187], v[8:11], 0
    v_mfma_f32_16x16x32_bf16 v[44:47], a[184:187], v[12:15], 0
    v_cvt_pk_bf16_f32 v88, v48, v49
    v_cvt_pk_bf16_f32 v89, v50, v51
    v_cvt_pk_bf16_f32 v90, v56, v57
    v_cvt_pk_bf16_f32 v91, v58, v59
    v_cvt_pk_bf16_f32 v92, v52, v53
    v_cvt_pk_bf16_f32 v93, v54, v55
    v_cvt_pk_bf16_f32 v94, v60, v61
    v_cvt_pk_bf16_f32 v95, v62, v63
    s_nop 0
    v_accvgpr_write_b32 a164, v88
    v_accvgpr_write_b32 a165, v89
    v_accvgpr_write_b32 a166, v90
    v_accvgpr_write_b32 a167, v91
    v_accvgpr_write_b32 a172, v92
    v_accvgpr_write_b32 a173, v93
    v_accvgpr_write_b32 a174, v94
    v_accvgpr_write_b32 a175, v95
    s_xor_b32 s37, s48, 1835008
    s_add_u32 s36, s16, s37
    s_addc_u32 s37, s17, 0
    global_load_dwordx4 v[180:183], v4, s[36:37]
    global_load_dwordx4 v[188:191], v5, s[36:37]
    s_waitcnt vmcnt(33)
    v_mfma_f32_16x16x32_bf16 v[48:51], a[180:183], v[8:11], 0
    v_mfma_f32_16x16x32_bf16 v[52:55], a[180:183], v[12:15], 0
    v_mfma_f32_16x16x32_bf16 v[56:59], a[188:191], v[8:11], 0
    v_mfma_f32_16x16x32_bf16 v[60:63], a[188:191], v[12:15], 0
    v_cvt_pk_bf16_f32 v88, v32, v33
    v_cvt_pk_bf16_f32 v89, v34, v35
    v_cvt_pk_bf16_f32 v90, v40, v41
    v_cvt_pk_bf16_f32 v91, v42, v43
    v_cvt_pk_bf16_f32 v92, v36, v37
    v_cvt_pk_bf16_f32 v93, v38, v39
    v_cvt_pk_bf16_f32 v94, v44, v45
    v_cvt_pk_bf16_f32 v95, v46, v47
    s_nop 0
    v_accvgpr_write_b32 a176, v88
    v_accvgpr_write_b32 a177, v89
    v_accvgpr_write_b32 a178, v90
    v_accvgpr_write_b32 a179, v91
    v_accvgpr_write_b32 a184, v92
    v_accvgpr_write_b32 a185, v93
    v_accvgpr_write_b32 a186, v94
    v_accvgpr_write_b32 a187, v95
    s_xor_b32 s37, s48, 2097152
    s_add_u32 s36, s16, s37
    s_addc_u32 s37, s17, 0
    global_load_dwordx4 v[192:195], v4, s[36:37]
    global_load_dwordx4 v[200:203], v5, s[36:37]
    s_waitcnt vmcnt(33)
    v_mfma_f32_16x16x32_bf16 v[32:35], a[192:195], v[8:11], 0
    v_mfma_f32_16x16x32_bf16 v[36:39], a[192:195], v[12:15], 0
    v_mfma_f32_16x16x32_bf16 v[40:43], a[200:203], v[8:11], 0
    v_mfma_f32_16x16x32_bf16 v[44:47], a[200:203], v[12:15], 0
    v_cvt_pk_bf16_f32 v88, v48, v49
    v_cvt_pk_bf16_f32 v89, v50, v51
    v_cvt_pk_bf16_f32 v90, v56, v57
    v_cvt_pk_bf16_f32 v91, v58, v59
    v_cvt_pk_bf16_f32 v92, v52, v53
    v_cvt_pk_bf16_f32 v93, v54, v55
    v_cvt_pk_bf16_f32 v94, v60, v61
    v_cvt_pk_bf16_f32 v95, v62, v63
    s_nop 0
    v_accvgpr_write_b32 a180, v88
    v_accvgpr_write_b32 a181, v89
    v_accvgpr_write_b32 a182, v90
    v_accvgpr_write_b32 a183, v91
    v_accvgpr_write_b32 a188, v92
    v_accvgpr_write_b32 a189, v93
    v_accvgpr_write_b32 a190, v94
    v_accvgpr_write_b32 a191, v95
    v_bfe_u32 v125, v2, 2, 2
    v_lshlrev_b32 v125, 1, v125
    v_and_b32 v126, 1, v2
    v_add_u32 v125, v125, v126
    v_lshlrev_b32 v125, 10, v125
    v_lshrrev_b32 v126, 4, v2
    v_lshlrev_b32 v126, 5, v126
    v_add_u32 v125, v125, v126
    v_bfe_u32 v126, v2, 1, 1
    v_lshlrev_b32 v126, 2, v126
    v_add_u32 v125, v125, v126
    s_lshl_b32 s25, s3, 8
    v_add_u32 v125, s25, v125
    global_load_dword v112, v125, s[8:9] offset:0
    global_load_dword v113, v125, s[8:9] offset:8
    global_load_dword v114, v125, s[8:9] offset:16
    global_load_dword v115, v125, s[8:9] offset:24
    global_load_dword v116, v125, s[8:9] offset:128
    global_load_dword v117, v125, s[8:9] offset:136
    global_load_dword v118, v125, s[8:9] offset:144
    global_load_dword v119, v125, s[8:9] offset:152
    s_waitcnt vmcnt(39)
    v_mfma_f32_16x16x32_bf16 v[48:51], a[196:199], v[8:11], 0
    v_mfma_f32_16x16x32_bf16 v[52:55], a[196:199], v[12:15], 0
    v_mfma_f32_16x16x32_bf16 v[56:59], a[204:207], v[8:11], 0
    v_mfma_f32_16x16x32_bf16 v[60:63], a[204:207], v[12:15], 0
    v_cvt_pk_bf16_f32 v88, v32, v33
    v_cvt_pk_bf16_f32 v89, v34, v35
    v_cvt_pk_bf16_f32 v90, v40, v41
    v_cvt_pk_bf16_f32 v91, v42, v43
    v_cvt_pk_bf16_f32 v92, v36, v37
    v_cvt_pk_bf16_f32 v93, v38, v39
    v_cvt_pk_bf16_f32 v94, v44, v45
    v_cvt_pk_bf16_f32 v95, v46, v47
    s_nop 0
    v_accvgpr_write_b32 a192, v88
    v_accvgpr_write_b32 a193, v89
    v_accvgpr_write_b32 a194, v90
    v_accvgpr_write_b32 a195, v91
    v_accvgpr_write_b32 a200, v92
    v_accvgpr_write_b32 a201, v93
    v_accvgpr_write_b32 a202, v94
    v_accvgpr_write_b32 a203, v95
    s_waitcnt vmcnt(37)
    v_mfma_f32_16x16x32_bf16 v[32:35], a[208:211], v[8:11], 0
    v_mfma_f32_16x16x32_bf16 v[36:39], a[208:211], v[12:15], 0
    v_mfma_f32_16x16x32_bf16 v[40:43], a[216:219], v[8:11], 0
    v_mfma_f32_16x16x32_bf16 v[44:47], a[216:219], v[12:15], 0
    v_cvt_pk_bf16_f32 v88, v48, v49
    v_cvt_pk_bf16_f32 v89, v50, v51
    v_cvt_pk_bf16_f32 v90, v56, v57
    v_cvt_pk_bf16_f32 v91, v58, v59
    v_cvt_pk_bf16_f32 v92, v52, v53
    v_cvt_pk_bf16_f32 v93, v54, v55
    v_cvt_pk_bf16_f32 v94, v60, v61
    v_cvt_pk_bf16_f32 v95, v62, v63
    s_nop 0
    v_accvgpr_write_b32 a196, v88
    v_accvgpr_write_b32 a197, v89
    v_accvgpr_write_b32 a198, v90
    v_accvgpr_write_b32 a199, v91
    v_accvgpr_write_b32 a204, v92
    v_accvgpr_write_b32 a205, v93
    v_accvgpr_write_b32 a206, v94
    v_accvgpr_write_b32 a207, v95
    s_waitcnt vmcnt(35)
    v_mfma_f32_16x16x32_bf16 v[48:51], a[212:215], v[8:11], 0
    v_mfma_f32_16x16x32_bf16 v[52:55], a[212:215], v[12:15], 0
    v_mfma_f32_16x16x32_bf16 v[56:59], a[220:223], v[8:11], 0
    v_mfma_f32_16x16x32_bf16 v[60:63], a[220:223], v[12:15], 0
    v_cvt_pk_bf16_f32 v88, v32, v33
    v_cvt_pk_bf16_f32 v89, v34, v35
    v_cvt_pk_bf16_f32 v90, v40, v41
    v_cvt_pk_bf16_f32 v91, v42, v43
    v_cvt_pk_bf16_f32 v92, v36, v37
    v_cvt_pk_bf16_f32 v93, v38, v39
    v_cvt_pk_bf16_f32 v94, v44, v45
    v_cvt_pk_bf16_f32 v95, v46, v47
    s_nop 0
    v_accvgpr_write_b32 a208, v88
    v_accvgpr_write_b32 a209, v89
    v_accvgpr_write_b32 a210, v90
    v_accvgpr_write_b32 a211, v91
    v_accvgpr_write_b32 a216, v92
    v_accvgpr_write_b32 a217, v93
    v_accvgpr_write_b32 a218, v94
    v_accvgpr_write_b32 a219, v95
    s_waitcnt vmcnt(32)
    v_mfma_f32_16x16x32_bf16 v[32:35], a[224:227], v[8:11], 0
    v_mfma_f32_16x16x32_bf16 v[36:39], a[224:227], v[12:15], 0
    v_mfma_f32_16x16x32_bf16 v[40:43], a[232:235], v[8:11], 0
    v_mfma_f32_16x16x32_bf16 v[44:47], a[232:235], v[12:15], 0
    v_cvt_pk_bf16_f32 v88, v48, v49
    v_cvt_pk_bf16_f32 v89, v50, v51
    v_cvt_pk_bf16_f32 v90, v56, v57
    v_cvt_pk_bf16_f32 v91, v58, v59
    v_cvt_pk_bf16_f32 v92, v52, v53
    v_cvt_pk_bf16_f32 v93, v54, v55
    v_cvt_pk_bf16_f32 v94, v60, v61
    v_cvt_pk_bf16_f32 v95, v62, v63
    s_nop 0
    v_accvgpr_write_b32 a212, v88
    v_accvgpr_write_b32 a213, v89
    v_accvgpr_write_b32 a214, v90
    v_accvgpr_write_b32 a215, v91
    v_accvgpr_write_b32 a220, v92
    v_accvgpr_write_b32 a221, v93
    v_accvgpr_write_b32 a222, v94
    v_accvgpr_write_b32 a223, v95
    s_xor_b32 s37, s48, 2359296
    s_add_u32 s36, s16, s37
    s_addc_u32 s37, s17, 0
    global_load_dwordx4 v[196:199], v4, s[36:37]
    global_load_dwordx4 v[204:207], v5, s[36:37]
    s_xor_b32 s37, s48, 2621440
    s_add_u32 s36, s16, s37
    s_addc_u32 s37, s17, 0
    global_load_dwordx4 v[208:211], v4, s[36:37]
    global_load_dwordx4 v[216:219], v5, s[36:37]
    s_waitcnt vmcnt(34)
    v_mfma_f32_16x16x32_bf16 v[48:51], a[228:231], v[8:11], 0
    v_mfma_f32_16x16x32_bf16 v[52:55], a[228:231], v[12:15], 0
    v_mfma_f32_16x16x32_bf16 v[56:59], a[236:239], v[8:11], 0
    v_mfma_f32_16x16x32_bf16 v[60:63], a[236:239], v[12:15], 0
    v_cvt_pk_bf16_f32 v88, v32, v33
    v_cvt_pk_bf16_f32 v89, v34, v35
    v_cvt_pk_bf16_f32 v90, v40, v41
    v_cvt_pk_bf16_f32 v91, v42, v43
    v_cvt_pk_bf16_f32 v92, v36, v37
    v_cvt_pk_bf16_f32 v93, v38, v39
    v_cvt_pk_bf16_f32 v94, v44, v45
    v_cvt_pk_bf16_f32 v95, v46, v47
    s_nop 0
    v_accvgpr_write_b32 a224, v88
    v_accvgpr_write_b32 a225, v89
    v_accvgpr_write_b32 a226, v90
    v_accvgpr_write_b32 a227, v91
    v_accvgpr_write_b32 a232, v92
    v_accvgpr_write_b32 a233, v93
    v_accvgpr_write_b32 a234, v94
    v_accvgpr_write_b32 a235, v95
    s_xor_b32 s37, s48, 2883584
    s_add_u32 s36, s16, s37
    s_addc_u32 s37, s17, 0
    global_load_dwordx4 v[212:215], v4, s[36:37]
    global_load_dwordx4 v[220:223], v5, s[36:37]
    s_waitcnt vmcnt(34)
    v_mfma_f32_16x16x32_bf16 v[32:35], a[240:243], v[8:11], 0
    v_mfma_f32_16x16x32_bf16 v[36:39], a[240:243], v[12:15], 0
    v_mfma_f32_16x16x32_bf16 v[40:43], a[248:251], v[8:11], 0
    v_mfma_f32_16x16x32_bf16 v[44:47], a[248:251], v[12:15], 0
    v_cvt_pk_bf16_f32 v88, v48, v49
    v_cvt_pk_bf16_f32 v89, v50, v51
    v_cvt_pk_bf16_f32 v90, v56, v57
    v_cvt_pk_bf16_f32 v91, v58, v59
    v_cvt_pk_bf16_f32 v92, v52, v53
    v_cvt_pk_bf16_f32 v93, v54, v55
    v_cvt_pk_bf16_f32 v94, v60, v61
    v_cvt_pk_bf16_f32 v95, v62, v63
    s_nop 0
    v_accvgpr_write_b32 a228, v88
    v_accvgpr_write_b32 a229, v89
    v_accvgpr_write_b32 a230, v90
    v_accvgpr_write_b32 a231, v91
    v_accvgpr_write_b32 a236, v92
    v_accvgpr_write_b32 a237, v93
    v_accvgpr_write_b32 a238, v94
    v_accvgpr_write_b32 a239, v95
    s_xor_b32 s37, s48, 3145728
    s_add_u32 s36, s16, s37
    s_addc_u32 s37, s17, 0
    global_load_dwordx4 v[224:227], v4, s[36:37]
    global_load_dwordx4 v[232:235], v5, s[36:37]
    s_waitcnt vmcnt(34)
    v_mfma_f32_16x16x32_bf16 v[48:51], a[244:247], v[8:11], 0
    v_mfma_f32_16x16x32_bf16 v[52:55], a[244:247], v[12:15], 0
    v_mfma_f32_16x16x32_bf16 v[56:59], a[252:255], v[8:11], 0
    v_mfma_f32_16x16x32_bf16 v[60:63], a[252:255], v[12:15], 0
    v_cvt_pk_bf16_f32 v88, v32, v33
    v_cvt_pk_bf16_f32 v89, v34, v35
    v_cvt_pk_bf16_f32 v90, v40, v41
    v_cvt_pk_bf16_f32 v91, v42, v43
    v_cvt_pk_bf16_f32 v92, v36, v37
    v_cvt_pk_bf16_f32 v93, v38, v39
    v_cvt_pk_bf16_f32 v94, v44, v45
    v_cvt_pk_bf16_f32 v95, v46, v47
    s_nop 0
    v_accvgpr_write_b32 a240, v88
    v_accvgpr_write_b32 a241, v89
    v_accvgpr_write_b32 a242, v90
    v_accvgpr_write_b32 a243, v91
    v_accvgpr_write_b32 a248, v92
    v_accvgpr_write_b32 a249, v93
    v_accvgpr_write_b32 a250, v94
    v_accvgpr_write_b32 a251, v95
    s_xor_b32 s37, s48, 3407872
    s_add_u32 s36, s16, s37
    s_addc_u32 s37, s17, 0
    global_load_dwordx4 v[228:231], v4, s[36:37]
    global_load_dwordx4 v[236:239], v5, s[36:37]
    s_waitcnt vmcnt(34)
    v_mfma_f32_16x16x32_bf16 v[32:35], v[128:131], v[8:11], 0
    v_mfma_f32_16x16x32_bf16 v[36:39], v[128:131], v[12:15], 0
    v_mfma_f32_16x16x32_bf16 v[40:43], v[136:139], v[8:11], 0
    v_mfma_f32_16x16x32_bf16 v[44:47], v[136:139], v[12:15], 0
    v_cvt_pk_bf16_f32 v88, v48, v49
    v_cvt_pk_bf16_f32 v89, v50, v51
    v_cvt_pk_bf16_f32 v90, v56, v57
    v_cvt_pk_bf16_f32 v91, v58, v59
    v_cvt_pk_bf16_f32 v92, v52, v53
    v_cvt_pk_bf16_f32 v93, v54, v55
    v_cvt_pk_bf16_f32 v94, v60, v61
    v_cvt_pk_bf16_f32 v95, v62, v63
    s_nop 0
    v_accvgpr_write_b32 a244, v88
    v_accvgpr_write_b32 a245, v89
    v_accvgpr_write_b32 a246, v90
    v_accvgpr_write_b32 a247, v91
    v_accvgpr_write_b32 a252, v92
    v_accvgpr_write_b32 a253, v93
    v_accvgpr_write_b32 a254, v94
    v_accvgpr_write_b32 a255, v95
    s_xor_b32 s37, s48, 3670016
    s_add_u32 s36, s16, s37
    s_addc_u32 s37, s17, 0
    global_load_dwordx4 v[240:243], v4, s[36:37]
    global_load_dwordx4 v[248:251], v5, s[36:37]
    s_waitcnt vmcnt(34)
    v_mfma_f32_16x16x32_bf16 v[48:51], v[132:135], v[8:11], 0
    v_mfma_f32_16x16x32_bf16 v[52:55], v[132:135], v[12:15], 0
    v_mfma_f32_16x16x32_bf16 v[56:59], v[140:143], v[8:11], 0
    v_mfma_f32_16x16x32_bf16 v[60:63], v[140:143], v[12:15], 0
    v_cvt_pk_bf16_f32 v128, v32, v33
    v_cvt_pk_bf16_f32 v129, v34, v35
    v_cvt_pk_bf16_f32 v130, v40, v41
    v_cvt_pk_bf16_f32 v131, v42, v43
    v_cvt_pk_bf16_f32 v136, v36, v37
    v_cvt_pk_bf16_f32 v137, v38, v39
    v_cvt_pk_bf16_f32 v138, v44, v45
    v_cvt_pk_bf16_f32 v139, v46, v47
    s_xor_b32 s37, s48, 3932160
    s_add_u32 s36, s16, s37
    s_addc_u32 s37, s17, 0
    global_load_dwordx4 v[244:247], v4, s[36:37]
    global_load_dwordx4 v[252:255], v5, s[36:37]
    s_waitcnt vmcnt(34)
    v_mfma_f32_16x16x32_bf16 v[32:35], v[144:147], v[8:11], 0
    v_mfma_f32_16x16x32_bf16 v[36:39], v[144:147], v[12:15], 0
    v_mfma_f32_16x16x32_bf16 v[40:43], v[152:155], v[8:11], 0
    v_mfma_f32_16x16x32_bf16 v[44:47], v[152:155], v[12:15], 0
    v_cvt_pk_bf16_f32 v132, v48, v49
    v_cvt_pk_bf16_f32 v133, v50, v51
    v_cvt_pk_bf16_f32 v134, v56, v57
    v_cvt_pk_bf16_f32 v135, v58, v59
    v_cvt_pk_bf16_f32 v140, v52, v53
    v_cvt_pk_bf16_f32 v141, v54, v55
    v_cvt_pk_bf16_f32 v142, v60, v61
    v_cvt_pk_bf16_f32 v143, v62, v63
    s_waitcnt vmcnt(32)
    v_mfma_f32_16x16x32_bf16 v[48:51], v[148:151], v[8:11], 0
    v_mfma_f32_16x16x32_bf16 v[52:55], v[148:151], v[12:15], 0
    v_mfma_f32_16x16x32_bf16 v[56:59], v[156:159], v[8:11], 0
    v_mfma_f32_16x16x32_bf16 v[60:63], v[156:159], v[12:15], 0
    v_cvt_pk_bf16_f32 v144, v32, v33
    v_cvt_pk_bf16_f32 v145, v34, v35
    v_cvt_pk_bf16_f32 v146, v40, v41
    v_cvt_pk_bf16_f32 v147, v42, v43
    v_cvt_pk_bf16_f32 v152, v36, v37
    v_cvt_pk_bf16_f32 v153, v38, v39
    v_cvt_pk_bf16_f32 v154, v44, v45
    v_cvt_pk_bf16_f32 v155, v46, v47
    s_waitcnt vmcnt(30)
    v_mfma_f32_16x16x32_bf16 v[32:35], v[160:163], v[8:11], 0
    v_mfma_f32_16x16x32_bf16 v[36:39], v[160:163], v[12:15], 0
    v_mfma_f32_16x16x32_bf16 v[40:43], v[168:171], v[8:11], 0
    v_mfma_f32_16x16x32_bf16 v[44:47], v[168:171], v[12:15], 0
    v_cvt_pk_bf16_f32 v148, v48, v49
    v_cvt_pk_bf16_f32 v149, v50, v51
    v_cvt_pk_bf16_f32 v150, v56, v57
    v_cvt_pk_bf16_f32 v151, v58, v59
    v_cvt_pk_bf16_f32 v156, v52, v53
    v_cvt_pk_bf16_f32 v157, v54, v55
    v_cvt_pk_bf16_f32 v158, v60, v61
    v_cvt_pk_bf16_f32 v159, v62, v63
    s_waitcnt vmcnt(28)
    v_mfma_f32_16x16x32_bf16 v[48:51], v[164:167], v[8:11], 0
    v_mfma_f32_16x16x32_bf16 v[52:55], v[164:167], v[12:15], 0
    v_mfma_f32_16x16x32_bf16 v[56:59], v[172:175], v[8:11], 0
    v_mfma_f32_16x16x32_bf16 v[60:63], v[172:175], v[12:15], 0
    v_cvt_pk_bf16_f32 v160, v32, v33
    v_cvt_pk_bf16_f32 v161, v34, v35
    v_cvt_pk_bf16_f32 v162, v40, v41
    v_cvt_pk_bf16_f32 v163, v42, v43
    v_cvt_pk_bf16_f32 v168, v36, v37
    v_cvt_pk_bf16_f32 v169, v38, v39
    v_cvt_pk_bf16_f32 v170, v44, v45
    v_cvt_pk_bf16_f32 v171, v46, v47
    s_waitcnt vmcnt(26)
    v_mfma_f32_16x16x32_bf16 v[32:35], v[176:179], v[8:11], 0
    v_mfma_f32_16x16x32_bf16 v[36:39], v[176:179], v[12:15], 0
    v_mfma_f32_16x16x32_bf16 v[40:43], v[184:187], v[8:11], 0
    v_mfma_f32_16x16x32_bf16 v[44:47], v[184:187], v[12:15], 0
    v_cvt_pk_bf16_f32 v164, v48, v49
    v_cvt_pk_bf16_f32 v165, v50, v51
    v_cvt_pk_bf16_f32 v166, v56, v57
    v_cvt_pk_bf16_f32 v167, v58, v59
    v_cvt_pk_bf16_f32 v172, v52, v53
    v_cvt_pk_bf16_f32 v173, v54, v55
    v_cvt_pk_bf16_f32 v174, v60, v61
    v_cvt_pk_bf16_f32 v175, v62, v63
    s_waitcnt vmcnt(24)
    v_mfma_f32_16x16x32_bf16 v[48:51], v[180:183], v[8:11], 0
    v_mfma_f32_16x16x32_bf16 v[52:55], v[180:183], v[12:15], 0
    v_mfma_f32_16x16x32_bf16 v[56:59], v[188:191], v[8:11], 0
    v_mfma_f32_16x16x32_bf16 v[60:63], v[188:191], v[12:15], 0
    v_cvt_pk_bf16_f32 v176, v32, v33
    v_cvt_pk_bf16_f32 v177, v34, v35
    v_cvt_pk_bf16_f32 v178, v40, v41
    v_cvt_pk_bf16_f32 v179, v42, v43
    v_cvt_pk_bf16_f32 v184, v36, v37
    v_cvt_pk_bf16_f32 v185, v38, v39
    v_cvt_pk_bf16_f32 v186, v44, v45
    v_cvt_pk_bf16_f32 v187, v46, v47
    s_waitcnt vmcnt(22)
    v_mfma_f32_16x16x32_bf16 v[32:35], v[192:195], v[8:11], 0
    v_mfma_f32_16x16x32_bf16 v[36:39], v[192:195], v[12:15], 0
    v_mfma_f32_16x16x32_bf16 v[40:43], v[200:203], v[8:11], 0
    v_mfma_f32_16x16x32_bf16 v[44:47], v[200:203], v[12:15], 0
    v_cvt_pk_bf16_f32 v180, v48, v49
    v_cvt_pk_bf16_f32 v181, v50, v51
    v_cvt_pk_bf16_f32 v182, v56, v57
    v_cvt_pk_bf16_f32 v183, v58, v59
    v_cvt_pk_bf16_f32 v188, v52, v53
    v_cvt_pk_bf16_f32 v189, v54, v55
    v_cvt_pk_bf16_f32 v190, v60, v61
    v_cvt_pk_bf16_f32 v191, v62, v63
    v_readfirstlane_b32 s46, v65
    v_and_b32 v64, 31, v2
    v_lshlrev_b32 v64, 2, v64
    global_load_dword v66, v64, s[28:29] sc0 sc1
    v_and_b32 v67, 15, v2
    v_lshlrev_b32 v67, 2, v67
    v_add_u32 v67, s34, v67
    global_load_dword v68, v67, s[4:5] sc1
    v_min_u32 v67, 47, v2
    v_lshlrev_b32 v67, 3, v67
    v_add_u32 v67, 4530176, v67
    global_load_dwordx2 v[70:71], v67, s[4:5] sc1
    s_waitcnt vmcnt(15)
    v_mfma_f32_16x16x32_bf16 v[48:51], v[196:199], v[8:11], 0
    v_mfma_f32_16x16x32_bf16 v[52:55], v[196:199], v[12:15], 0
    v_mfma_f32_16x16x32_bf16 v[56:59], v[204:207], v[8:11], 0
    v_mfma_f32_16x16x32_bf16 v[60:63], v[204:207], v[12:15], 0
    v_cvt_pk_bf16_f32 v192, v32, v33
    v_cvt_pk_bf16_f32 v193, v34, v35
    v_cvt_pk_bf16_f32 v194, v40, v41
    v_cvt_pk_bf16_f32 v195, v42, v43
    v_cvt_pk_bf16_f32 v200, v36, v37
    v_cvt_pk_bf16_f32 v201, v38, v39
    v_cvt_pk_bf16_f32 v202, v44, v45
    v_cvt_pk_bf16_f32 v203, v46, v47
    s_waitcnt vmcnt(13)
    v_mfma_f32_16x16x32_bf16 v[32:35], v[208:211], v[8:11], 0
    v_mfma_f32_16x16x32_bf16 v[36:39], v[208:211], v[12:15], 0
    v_mfma_f32_16x16x32_bf16 v[40:43], v[216:219], v[8:11], 0
    v_mfma_f32_16x16x32_bf16 v[44:47], v[216:219], v[12:15], 0
    v_cvt_pk_bf16_f32 v196, v48, v49
    v_cvt_pk_bf16_f32 v197, v50, v51
    v_cvt_pk_bf16_f32 v198, v56, v57
    v_cvt_pk_bf16_f32 v199, v58, v59
    v_cvt_pk_bf16_f32 v204, v52, v53
    v_cvt_pk_bf16_f32 v205, v54, v55
    v_cvt_pk_bf16_f32 v206, v60, v61
    v_cvt_pk_bf16_f32 v207, v62, v63
    s_waitcnt vmcnt(11)
    v_mfma_f32_16x16x32_bf16 v[48:51], v[212:215], v[8:11], 0
    v_mfma_f32_16x16x32_bf16 v[52:55], v[212:215], v[12:15], 0
    v_mfma_f32_16x16x32_bf16 v[56:59], v[220:223], v[8:11], 0
    v_mfma_f32_16x16x32_bf16 v[60:63], v[220:223], v[12:15], 0
    v_cvt_pk_bf16_f32 v208, v32, v33
    v_cvt_pk_bf16_f32 v209, v34, v35
    v_cvt_pk_bf16_f32 v210, v40, v41
    v_cvt_pk_bf16_f32 v211, v42, v43
    v_cvt_pk_bf16_f32 v216, v36, v37
    v_cvt_pk_bf16_f32 v217, v38, v39
    v_cvt_pk_bf16_f32 v218, v44, v45
    v_cvt_pk_bf16_f32 v219, v46, v47
    s_waitcnt vmcnt(9)
    v_mfma_f32_16x16x32_bf16 v[32:35], v[224:227], v[8:11], 0
    v_mfma_f32_16x16x32_bf16 v[36:39], v[224:227], v[12:15], 0
    v_mfma_f32_16x16x32_bf16 v[40:43], v[232:235], v[8:11], 0
    v_mfma_f32_16x16x32_bf16 v[44:47], v[232:235], v[12:15], 0
    v_cvt_pk_bf16_f32 v212, v48, v49
    v_cvt_pk_bf16_f32 v213, v50, v51
    v_cvt_pk_bf16_f32 v214, v56, v57
    v_cvt_pk_bf16_f32 v215, v58, v59
    v_cvt_pk_bf16_f32 v220, v52, v53
    v_cvt_pk_bf16_f32 v221, v54, v55
    v_cvt_pk_bf16_f32 v222, v60, v61
    v_cvt_pk_bf16_f32 v223, v62, v63
    s_waitcnt vmcnt(7)
    v_mfma_f32_16x16x32_bf16 v[48:51], v[228:231], v[8:11], 0
    v_mfma_f32_16x16x32_bf16 v[52:55], v[228:231], v[12:15], 0
    v_mfma_f32_16x16x32_bf16 v[56:59], v[236:239], v[8:11], 0
    v_mfma_f32_16x16x32_bf16 v[60:63], v[236:239], v[12:15], 0
    v_cvt_pk_bf16_f32 v224, v32, v33
    v_cvt_pk_bf16_f32 v225, v34, v35
    v_cvt_pk_bf16_f32 v226, v40, v41
    v_cvt_pk_bf16_f32 v227, v42, v43
    v_cvt_pk_bf16_f32 v232, v36, v37
    v_cvt_pk_bf16_f32 v233, v38, v39
    v_cvt_pk_bf16_f32 v234, v44, v45
    v_cvt_pk_bf16_f32 v235, v46, v47
    s_waitcnt vmcnt(0)
    s_mul_i32 s25, s24, 0x01010101
    v_cmp_ne_u32 vcc, s25, v66
    s_or_b32 s47, vcc_lo, vcc_hi
    v_cmp_ne_u32 vcc, s46, v68
    s_and_b32 s25, vcc_lo, 0x6666
    s_or_b32 s47, s47, s25
    v_xor_b32 v70, s46, v70
    v_xor_b32 v71, s46, v71
    v_or_b32 v70, v70, v71
    v_cmp_ne_u32 vcc, 0, v70
    s_or_b32 s47, s47, vcc_lo
    s_or_b32 s47, s47, vcc_hi
    s_cmp_eq_u32 s46, 0
    s_cselect_b32 s47, 1, s47
    global_load_dwordx4 v[96:99], v3, s[72:73] sc1
    global_load_dwordx4 v[100:103], v3, s[72:73] offset:1024 sc1
    global_load_lds_dwordx4 v3, s[74:75] sc1
    global_load_lds_dwordx4 v3, s[74:75] offset:1024 sc1
    v_mfma_f32_16x16x32_bf16 v[32:35], v[240:243], v[8:11], 0
    v_mfma_f32_16x16x32_bf16 v[36:39], v[240:243], v[12:15], 0
    v_mfma_f32_16x16x32_bf16 v[40:43], v[248:251], v[8:11], 0
    v_mfma_f32_16x16x32_bf16 v[44:47], v[248:251], v[12:15], 0
    v_cvt_pk_bf16_f32 v228, v48, v49
    v_cvt_pk_bf16_f32 v229, v50, v51
    v_cvt_pk_bf16_f32 v230, v56, v57
    v_cvt_pk_bf16_f32 v231, v58, v59
    v_cvt_pk_bf16_f32 v236, v52, v53
    v_cvt_pk_bf16_f32 v237, v54, v55
    v_cvt_pk_bf16_f32 v238, v60, v61
    v_cvt_pk_bf16_f32 v239, v62, v63
    v_mfma_f32_16x16x32_bf16 v[48:51], v[244:247], v[8:11], 0
    v_mfma_f32_16x16x32_bf16 v[52:55], v[244:247], v[12:15], 0
    v_mfma_f32_16x16x32_bf16 v[56:59], v[252:255], v[8:11], 0
    v_mfma_f32_16x16x32_bf16 v[60:63], v[252:255], v[12:15], 0
    v_cvt_pk_bf16_f32 v240, v32, v33
    v_cvt_pk_bf16_f32 v241, v34, v35
    v_cvt_pk_bf16_f32 v242, v40, v41
    v_cvt_pk_bf16_f32 v243, v42, v43
    v_cvt_pk_bf16_f32 v248, v36, v37
    v_cvt_pk_bf16_f32 v249, v38, v39
    v_cvt_pk_bf16_f32 v250, v44, v45
    v_cvt_pk_bf16_f32 v251, v46, v47
    s_nop 7
    v_cvt_pk_bf16_f32 v244, v48, v49
    v_cvt_pk_bf16_f32 v245, v50, v51
    v_cvt_pk_bf16_f32 v246, v56, v57
    v_cvt_pk_bf16_f32 v247, v58, v59
    v_cvt_pk_bf16_f32 v252, v52, v53
    v_cvt_pk_bf16_f32 v253, v54, v55
    v_cvt_pk_bf16_f32 v254, v60, v61
    v_cvt_pk_bf16_f32 v255, v62, v63
    s_mov_b32 s20, 0x00ff00ff
    s_mov_b32 s21, 0x00ff00ff
    s_mov_b32 s22, 0x0ffc0ffc
    s_mov_b32 s23, 0x0ffc0ffc
    s_mov_b32 s32, 0x0ffc0ffc
    s_mov_b32 s33, 0
    s_mov_b32 s44, 0xff00ff00
    s_mov_b32 s45, 0xff00ff00
    s_lshl_b32 s25, s3, 11
    v_add_u32 v4, s25, v3
    s_add_u32 s25, s25, 0
    v_add_u32 v5, s25, v3
    v_add_u32 v6, 0, v3
    v_lshrrev_b32 v7, 4, v2
    v_mul_u32_u24 v7, 144, v7
    v_and_b32 v8, 15, v2
    v_lshlrev_b32 v8, 4, v8
    v_add_u32 v7, v7, v8
    s_mul_i32 s25, s3, 2304
    s_add_u32 s25, s25, 147456
    v_add_u32 v7, s25, v7
    v_bfe_u32 v16, v2, 2, 2
    v_and_b32 v17, 3, v2
    v_bfe_u32 v18, v2, 4, 1
    s_lshl_b32 s25, s3, 1
    v_add_u32 v18, s25, v18
    v_cmp_eq_u32 vcc, 3, v16
    s_nop 1
    v_cndmask_b32 v19, v16, 0, vcc
    v_mul_u32_u24 v19, 576, v19
    v_mul_u32_u24 v20, 144, v17
    v_add_u32 v19, v19, v20
    v_lshlrev_b32 v20, 4, v18
    v_add_u32 v19, v19, v20
    v_add_u32 v8, 147456, v19
    v_add_u32 v19, -1, v16
    v_lshlrev_b32 v19, 3, v19
    v_and_b32 v19, 31, v19
    v_lshlrev_b32 v20, 5, v17
    v_add_u32 v19, v19, v20
    v_and_b32 v20, 1, v17
    v_lshlrev_b32 v20, 3, v20
    v_add_u32 v20, 128, v20
    v_cmp_eq_u32 vcc, 0, v16
    s_nop 1
    v_cndmask_b32 v19, v19, v20, vcc
    v_mul_u32_u24 v20, 144, v18
    v_add_u32 v19, v19, v20
    v_add_u32 v0, 156672, v19
    v_and_b32 v19, 7, v2
    v_mul_u32_u24 v19, 144, v19
    v_lshrrev_b32 v20, 4, v2
    v_lshlrev_b32 v20, 5, v20
    v_add_u32 v19, v19, v20
    v_add_u32 v15, 156672, v19
    v_and_b32 v19, 7, v2
    v_mul_u32_u24 v19, 144, v19
    v_lshrrev_b32 v20, 4, v2
    v_lshlrev_b32 v20, 2, v20
    v_add_u32 v19, v19, v20
    v_add_u32 v77, 156800, v19
    v_lshrrev_b32 v19, 5, v2
    v_lshlrev_b32 v19, 8, v19
    v_and_b32 v20, 7, v2
    v_lshlrev_b32 v20, 5, v20
    v_add_u32 v19, v19, v20
    v_bfe_u32 v20, v2, 4, 1
    v_lshlrev_b32 v20, 3, v20
    v_add_u32 v19, v19, v20
    s_lshl_b32 s25, s3, 9
    s_add_u32 s25, s25, 158720
    v_add_u32 v9, s25, v19
    v_bfe_u32 v21, v2, 2, 2
    v_lshlrev_b32 v21, 1, v21
    v_and_b32 v20, 1, v2
    v_add_u32 v21, v21, v20
    v_bfe_u32 v22, v2, 1, 1
    v_lshrrev_b32 v19, 5, v2
    v_lshlrev_b32 v19, 9, v19
    v_bfe_u32 v20, v2, 4, 1
    v_lshlrev_b32 v20, 8, v20
    v_add_u32 v19, v19, v20
    v_lshlrev_b32 v20, 5, v21
    v_add_u32 v19, v19, v20
    v_lshlrev_b32 v20, 4, v22
    v_add_u32 v19, v19, v20
    v_add_u32 v10, 158720, v19
    v_mov_b32 v74, 0x44444444
    v_mov_b32 v20, 0xeeeeeeee
    v_cmp_eq_u32 vcc, 1, v22
    s_nop 1
    v_cndmask_b32 v74, v74, v20, vcc
    v_bfe_u32 v19, v2, 1, 2
    v_lshrrev_b32 v20, 4, v2
    v_and_b32 v23, 1, v2
    v_lshlrev_b32 v23, 4, v23
    v_mov_b32 v24, 0x3f80
    v_lshlrev_b32 v24, v23, v24
    v_cmp_eq_u32 vcc, v19, v20
    s_nop 1
    v_cndmask_b32 v24, 0, v24, vcc
    v_bfe_u32 v19, v2, 3, 1
    v_cmp_eq_u32 vcc, 0, v19
    s_nop 1
    v_cndmask_b32 v72, 0, v24, vcc
    v_cndmask_b32 v73, v24, 0, vcc
    v_lshrrev_b32 v19, 4, v2
    v_lshlrev_b32 v19, 8, v19
    v_and_b32 v20, 7, v2
    v_lshlrev_b32 v20, 4, v20
    v_add_u32 v75, v19, v20
    v_lshrrev_b32 v19, 5, v2
    v_lshlrev_b32 v19, 7, v19
    v_and_b32 v20, 15, v2
    v_lshlrev_b32 v20, 3, v20
    v_add_u32 v19, v19, v20
    v_bfe_u32 v20, v2, 4, 1
    v_lshlrev_b32 v20, 2, v20
    v_add_u32 v76, v19, v20
    s_lshl_b32 s25, s3, 13
    s_add_u32 s25, s25, 16384
    v_add_u32 v11, s25, v3
    v_add_u32 v1, 65536, v11
    v_lshrrev_b32 v12, 3, v2
    v_lshlrev_b32 v12, 14, v12
    v_and_b32 v13, 7, v2
    v_lshlrev_b32 v13, 4, v13
    v_add_u32 v12, v12, v13
    s_lshl_b32 s25, s6, 7
    s_lshl_b32 s26, s3, 17
    s_add_u32 s25, s25, s26
    v_add_u32 v12, s25, v12
    s_lshl_b32 s25, s6, 14
    s_lshl_b32 s26, s3, 12
    s_add_u32 s25, s25, s26
    v_add_u32 v13, s25, v3
    v_lshrrev_b32 v14, 5, v2
    v_lshlrev_b32 v14, 8, v14
    v_bfe_u32 v16, v2, 1, 1
    v_lshlrev_b32 v16, 5, v16
    v_add_u32 v14, v14, v16
    v_bfe_u32 v16, v2, 4, 1
    v_lshlrev_b32 v16, 4, v16
    v_add_u32 v14, v14, v16
    v_bfe_u32 v16, v2, 2, 1
    v_lshlrev_b32 v16, 2, v16
    v_add_u32 v14, v14, v16
    s_lshr_b32 s25, s6, 3
    s_lshl_b32 s25, s25, 11
    s_lshl_b32 s26, s3, 9
    s_add_u32 s25, s25, s26
    s_bfe_u32 s26, s6, 0x20001
    s_lshl_b32 s26, s26, 6
    s_add_u32 s25, s25, s26
    s_and_b32 s26, s6, 1
    s_lshl_b32 s26, s26, 3
    s_add_u32 s25, s25, s26
    v_add_u32 v14, s25, v14
    v_lshlrev_b32 v78, 10, v21
    v_lshrrev_b32 v19, 4, v2
    v_lshlrev_b32 v19, 5, v19
    v_add_u32 v78, v78, v19
    v_lshlrev_b32 v19, 2, v22
    v_add_u32 v78, v78, v19
    s_lshl_b32 s25, s3, 8
    v_add_u32 v78, s25, v78
    v_and_b32 v79, 31, v2
    v_lshlrev_b32 v79, 6, v79
    v_lshrrev_b32 v19, 5, v2
    v_mul_u32_u24 v19, 65536, v19
    v_lshlrev_b32 v19, 8, v19
    v_add_u32 v79, v79, v19
    s_lshl_b32 s25, s6, 19
    s_lshl_b32 s26, s3, 11
    s_add_u32 s25, s25, s26
    s_add_u32 s25, s25, 50339840
    v_add_u32 v79, s25, v79
    s_mov_b32 s38, 0x00550055
    s_mov_b32 s39, 0x00550055
    s_lshl_b32 s25, s6, 19
    s_lshl_b32 s26, s3, 11
    s_add_u32 s25, s25, s26
    s_add_u32 s26, s25, 50331648
    s_add_u32 s12, s4, s26
    s_addc_u32 s13, s5, 0
    s_add_u32 s26, s25, 67108864
    s_add_u32 s14, s4, s26
    s_addc_u32 s15, s5, 0
    s_lshl_b32 s25, s6, 18
    s_lshl_b32 s26, s3, 10
    s_add_u32 s25, s25, s26
    s_add_u32 s26, s25, 83886080
    s_add_u32 s16, s4, s26
    s_addc_u32 s17, s5, 0
    s_add_u32 s26, s25, 92274688
    s_add_u32 s18, s4, s26
    s_addc_u32 s19, s5, 0
    s_add_u32 s26, s4, 5251072
    s_addc_u32 s27, s5, 0
    s_mov_b32 s64, 0x3db504f3
    s_mov_b32 s65, 0x3db504f3
    s_mov_b32 s66, 0x3fb8aa3b
    s_mov_b32 s67, 0x3fb8aa3b
    s_add_u32 s10, s4, 6291456
    s_addc_u32 s11, s5, 0
    s_mov_b32 s68, 6
    s_cmp_eq_u32 s3, 1
    s_cselect_b32 s68, 6, s68
    s_cmp_eq_u32 s3, 2
    s_cselect_b32 s68, 6, s68
    s_cmp_eq_u32 s3, 3
    s_cselect_b32 s68, 7, s68
    s_add_u32 s96, s4, 6295552
    s_addc_u32 s97, s5, 0
    s_add_u32 s98, s4, 6299648
    s_addc_u32 s99, s5, 0
    s_add_u32 s100, s4, 6303744
    s_addc_u32 s101, s5, 0
    s_mul_i32 s25, s3, 2304
    s_add_u32 s25, s25, 147584
    v_mov_b32 v16, s25
    v_mov_b32 v19, 0xff800000
    v_mov_b32 v18, 0xff800000
    ds_write_b64 v16, v[18:19]
    ds_write_b64 v16, v[18:19] offset:8
    v_mov_b32 v16, 147584
    v_cndmask_b32 v8, v16, v8, s[22:23]
    v_bfe_u32 v16, v2, 3, 1
    v_lshrrev_b32 v17, 4, v2
    v_and_b32 v18, 7, v2
    v_lshlrev_b32 v18, 4, v18
    v_mul_u32_u24 v20, 144, v17
    v_add_u32 v19, v20, v18
    s_mul_i32 s25, s3, 2304
    s_add_u32 s25, s25, 147456
    v_add_u32 v7, s25, v19
    v_mul_u32_u24 v19, 640, v16
    v_add_u32 v19, v19, v20
    v_add_u32 v19, v19, v18
    v_add_u32 v8, 148096, v19
    v_lshrrev_b32 v19, 5, v2
    v_mul_u32_u24 v19, 144, v19
    v_add_u32 v19, v19, v18
    v_and_b32 v20, 1, v17
    v_lshlrev_b32 v20, 3, v20
    v_add_u32 v19, v19, v20
    v_lshlrev_b32 v20, 2, v16
    v_add_u32 v19, v19, v20
    v_add_u32 v0, 147744, v19
    v_mul_u32_u24 v19, 144, v17
    v_add_u32 v19, v19, v18
    v_add_u32 v19, 156672, v19
    v_cndmask_b32 v7, v19, v7, s[20:21]
    v_xor_b32 v19, 8, v2
    v_lshlrev_b32 v75, 4, v19
    s_lshl_b32 s35, s6, 8
    s_lshl_b32 s25, s3, 6
    s_add_u32 s35, s35, s25
    s_add_u32 s35, s35, 7340032
    s_mov_b32 s7, 0
    s_waitcnt vmcnt(0) lgkmcnt(0)
    s_cmp_lg_u32 s47, 0
    s_cbranch_scc1 CH_SLOWSTART
    s_add_u32 s34, s34, 64
    s_add_u32 s12, s12, 8192
    s_addc_u32 s13, s13, 0
    s_add_u32 s14, s14, 8192
    s_addc_u32 s15, s15, 0
    s_barrier
    s_branch CH_FAST_LOOP
CH_SLOWSTART:
    v_mov_b32 v16, 128
CH_NONW:
    global_load_dword v17, v16, s[28:29] sc0 sc1
    s_waitcnt vmcnt(0)
    v_readfirstlane_b32 s46, v17
    s_cmp_eq_u32 s46, 0
    s_cbranch_scc1 CH_NONW
    v_min_u32 v16, 47, v2
    v_lshlrev_b32 v16, 3, v16
    v_add_u32 v16, 4530176, v16
CH_INITW:
    global_load_dwordx2 v[18:19], v16, s[4:5] sc1
    s_waitcnt vmcnt(0)
    v_xor_b32 v18, s46, v18
    v_xor_b32 v19, s46, v19
    v_or_b32 v18, v18, v19
    v_cmp_ne_u32 vcc, 0, v18
    s_cbranch_vccnz CH_INITW
    v_and_b32 v120, 15, v2
    v_lshlrev_b32 v120, 2, v120
    v_add_u32 v120, s34, v120
CH_KVF0:
    global_load_dword v121, v120, s[4:5] sc1
    s_waitcnt vmcnt(0)
    v_cmp_ne_u32 vcc, s46, v121
    s_and_b32 s25, vcc_lo, 0x6666
    s_cbranch_scc1 CH_KVF0
    s_add_u32 s34, s34, 64
    global_load_dwordx4 v[96:99], v3, s[12:13] sc1
    global_load_dwordx4 v[100:103], v3, s[12:13] offset:1024 sc1
    s_add_u32 s12, s12, 8192
    s_addc_u32 s13, s13, 0
    global_load_lds_dwordx4 v3, s[14:15] sc1
    global_load_lds_dwordx4 v3, s[14:15] offset:1024 sc1
    s_add_u32 s14, s14, 8192
    s_addc_u32 s15, s15, 0
    v_add_u32 v18, 64, v2
CH_MODE:
    global_load_ubyte v17, v2, s[28:29] sc0 sc1
    global_load_ubyte v19, v18, s[28:29] sc0 sc1
    s_waitcnt vmcnt(0)
    v_min_u32 v16, v17, v19
    v_cmp_eq_u32 vcc, 0, v16
    s_cbranch_vccnz CH_MODE
    v_cmp_ne_u32 vcc, s24, v17
    s_or_b32 s25, vcc_lo, vcc_hi
    v_cmp_ne_u32 vcc, s24, v19
    s_or_b32 s25, s25, vcc_lo
    s_or_b32 s25, s25, vcc_hi
    s_barrier
    s_cmp_lg_u32 s25, 0
    s_cbranch_scc1 CH_SLOW_LOOP
CH_FAST_LOOP:
    v_mov_b32 v78, s46
    v_and_b32 v2, 15, v2
    v_lshlrev_b32 v2, 2, v2
    v_add_u32 v15, s35, v2
    v_add_u32 v15, -8192, v15
    s_add_u32 s35, s35, 516096
    v_add_u32 v77, s34, v2
    v_mov_b64 v[48:49], 0
    v_mov_b64 v[50:51], 0
    v_mov_b64 v[52:53], 0
    v_mov_b64 v[54:55], 0
    v_mov_b64 v[56:57], 0
    v_mov_b64 v[58:59], 0
    v_mov_b64 v[60:61], 0
    v_mov_b64 v[62:63], 0
    v_mov_b64 v[64:65], 0
    v_mov_b64 v[66:67], 0
    v_mov_b64 v[68:69], 0
    v_mov_b64 v[70:71], 0
    s_mov_b32 s30, 0
    s_mov_b32 s31, 0
    s_waitcnt vmcnt(0)
    ds_write_b128 v5, v[112:115]
    ds_write_b128 v5, v[116:119] offset:1024
    v_xor_b32 v86, 2048, v5
    v_xor_b32 v87, 4096, v5
    v_xor_b32 v88, 6144, v5
    v_mov_b64 v[16:17], v[112:113]
    v_mov_b64 v[18:19], v[114:115]
    v_mov_b64 v[20:21], v[116:117]
    v_mov_b64 v[22:23], v[118:119]
    s_branch CH_FAST_GOT
CH_FAST_MPOLL:
    s_nop 15
    s_nop 11
    global_load_dwordx4 v[112:115], v4, s[8:9] sc1
    global_load_dwordx4 v[116:119], v4, s[8:9] offset:1024 sc1
    v_mov_b64 v[48:49], 0
    v_mov_b64 v[50:51], 0
    v_mov_b64 v[52:53], 0
    v_mov_b64 v[54:55], 0
    v_mov_b64 v[56:57], 0
    v_mov_b64 v[58:59], 0
    v_mov_b64 v[60:61], 0
    v_mov_b64 v[62:63], 0
    v_mov_b64 v[64:65], 0
    v_mov_b64 v[66:67], 0
    v_mov_b64 v[68:69], 0
    v_mov_b64 v[70:71], 0
    v_xor_b32 v86, 2048, v5
    v_xor_b32 v87, 4096, v5
    v_xor_b32 v88, 6144, v5
    s_nop 15
    global_load_dwordx4 v[120:123], v4, s[8:9] sc1
    global_load_dwordx4 v[124:127], v4, s[8:9] offset:1024 sc1
    s_nop 15
    s_nop 11
    global_load_dwordx4 v[104:107], v4, s[8:9] sc1
    global_load_dwordx4 v[108:111], v4, s[8:9] offset:1024 sc1
CH_FAST_MPL:
    s_waitcnt vmcnt(4)
    ds_write_b128 v5, v[112:115]
    v_max3_u32 v84, v112, v113, v114
    v_max3_u32 v85, v115, v116, v117
    v_max3_u32 v84, v84, v118, v119
    ds_write_b128 v5, v[116:119] offset:1024
    v_max_u32 v84, v84, v85
    v_cmp_eq_u32 vcc, -1, v84
    v_mov_b64 v[16:17], v[112:113]
    v_mov_b64 v[18:19], v[114:115]
    v_mov_b64 v[20:21], v[116:117]
    v_mov_b64 v[22:23], v[118:119]
    s_cbranch_vccz CH_FAST_GOT
    global_load_dwordx4 v[112:115], v4, s[8:9] sc1
    global_load_dwordx4 v[116:119], v4, s[8:9] offset:1024 sc1
    s_waitcnt vmcnt(4)
    ds_write_b128 v5, v[120:123]
    v_max3_u32 v84, v120, v121, v122
    v_max3_u32 v85, v123, v124, v125
    v_max3_u32 v84, v84, v126, v127
    ds_write_b128 v5, v[124:127] offset:1024
    v_max_u32 v84, v84, v85
    v_cmp_eq_u32 vcc, -1, v84
    v_mov_b64 v[16:17], v[120:121]
    v_mov_b64 v[18:19], v[122:123]
    v_mov_b64 v[20:21], v[124:125]
    v_mov_b64 v[22:23], v[126:127]
    s_cbranch_vccz CH_FAST_GOT
    global_load_dwordx4 v[120:123], v4, s[8:9] sc1
    global_load_dwordx4 v[124:127], v4, s[8:9] offset:1024 sc1
    s_waitcnt vmcnt(4)
    ds_write_b128 v5, v[104:107]
    v_max3_u32 v84, v104, v105, v106
    v_max3_u32 v85, v107, v108, v109
    v_max3_u32 v84, v84, v110, v111
    ds_write_b128 v5, v[108:111] offset:1024
    v_max_u32 v84, v84, v85
    v_cmp_eq_u32 vcc, -1, v84
    v_mov_b64 v[16:17], v[104:105]
    v_mov_b64 v[18:19], v[106:107]
    v_mov_b64 v[20:21], v[108:109]
    v_mov_b64 v[22:23], v[110:111]
    s_cbranch_vccz CH_FAST_GOT
    global_load_dwordx4 v[104:107], v4, s[8:9] sc1
    global_load_dwordx4 v[108:111], v4, s[8:9] offset:1024 sc1
    s_branch CH_FAST_MPL
    .p2align 6
CH_FAST_GOT:
    v_smfmac_f32_16x16x64_bf16 v[48:51], v[16:19], a[0:7], v74
    v_smfmac_f32_16x16x64_bf16 v[52:55], v[16:19], a[8:15], v74
    v_smfmac_f32_16x16x64_bf16 v[56:59], v[16:19], a[128:135], v74
    s_waitcnt lgkmcnt(0)
    s_barrier
    ds_read_b128 v[24:27], v86 offset:0
    ds_read_b128 v[28:31], v86 offset:1024
    v_smfmac_f32_16x16x64_bf16 v[60:63], v[16:19], a[136:143], v74
    ds_read_b128 v[32:35], v87 offset:0
    v_smfmac_f32_16x16x64_bf16 v[48:51], v[20:23], a[16:23], v74
    ds_read_b128 v[36:39], v87 offset:1024
    v_smfmac_f32_16x16x64_bf16 v[52:55], v[20:23], a[24:31], v74
    ds_read_b128 v[40:43], v88 offset:0
    v_smfmac_f32_16x16x64_bf16 v[56:59], v[20:23], a[144:151], v74
    ds_read_b128 v[44:47], v88 offset:1024
    v_smfmac_f32_16x16x64_bf16 v[60:63], v[20:23], a[152:159], v74
    s_waitcnt lgkmcnt(5)
    v_smfmac_f32_16x16x64_bf16 v[48:51], v[24:27], a[32:39], v74
    v_smfmac_f32_16x16x64_bf16 v[52:55], v[24:27], a[40:47], v74
    v_smfmac_f32_16x16x64_bf16 v[56:59], v[24:27], a[160:167], v74
    v_smfmac_f32_16x16x64_bf16 v[60:63], v[24:27], a[168:175], v74
    s_waitcnt lgkmcnt(4)
    v_smfmac_f32_16x16x64_bf16 v[48:51], v[28:31], a[48:55], v74
    v_smfmac_f32_16x16x64_bf16 v[52:55], v[28:31], a[56:63], v74
    v_smfmac_f32_16x16x64_bf16 v[56:59], v[28:31], a[176:183], v74
    v_smfmac_f32_16x16x64_bf16 v[60:63], v[28:31], a[184:191], v74
    s_waitcnt vmcnt(0)
    global_store_dword v15, v78, s[4:5] sc1
    s_waitcnt lgkmcnt(3)
    v_smfmac_f32_16x16x64_bf16 v[48:51], v[32:35], a[64:71], v74
    ds_read_b128 v[104:107], v5 offset:8192
    v_smfmac_f32_16x16x64_bf16 v[52:55], v[32:35], a[72:79], v74
    ds_read_b128 v[108:111], v5 offset:9216
    global_load_dword v79, v77, s[4:5] sc1
    v_smfmac_f32_16x16x64_bf16 v[56:59], v[32:35], a[192:199], v74
    v_smfmac_f32_16x16x64_bf16 v[60:63], v[32:35], a[200:207], v74
    s_waitcnt lgkmcnt(4)
    v_smfmac_f32_16x16x64_bf16 v[48:51], v[36:39], a[80:87], v74
    v_smfmac_f32_16x16x64_bf16 v[52:55], v[36:39], a[88:95], v74
    v_smfmac_f32_16x16x64_bf16 v[56:59], v[36:39], a[208:215], v74
    v_smfmac_f32_16x16x64_bf16 v[60:63], v[36:39], a[216:223], v74
    s_waitcnt lgkmcnt(0)
    global_load_lds_dwordx4 v3, s[14:15]
    global_load_lds_dwordx4 v3, s[14:15] offset:1024
    v_smfmac_f32_16x16x64_bf16 v[48:51], v[40:43], a[96:103], v74
    v_smfmac_f32_16x16x64_bf16 v[52:55], v[40:43], a[104:111], v74
    v_smfmac_f32_16x16x64_bf16 v[56:59], v[40:43], a[224:231], v74
    v_smfmac_f32_16x16x64_bf16 v[60:63], v[40:43], a[232:239], v74
    v_smfmac_f32_16x16x64_bf16 v[48:51], v[44:47], a[112:119], v74
    v_smfmac_f32_16x16x64_bf16 v[52:55], v[44:47], a[120:127], v74
    v_smfmac_f32_16x16x64_bf16 v[56:59], v[44:47], a[240:247], v74
    v_smfmac_f32_16x16x64_bf16 v[60:63], v[44:47], a[248:255], v74
    v_smfmac_f32_16x16x64_bf16 v[64:67], v[16:19], v[128:135], v74
    s_nop 1
    v_pk_add_f32 v[48:49], v[48:49], v[50:51]
    v_pk_add_f32 v[56:57], v[56:57], v[58:59]
    v_cvt_pk_bf16_f32 v80, v48, v49
    v_cvt_pk_bf16_f32 v81, v56, v57
    v_pk_add_f32 v[52:53], v[52:53], v[54:55]
    v_pk_add_f32 v[60:61], v[60:61], v[62:63]
    v_cvt_pk_bf16_f32 v82, v52, v53
    v_cvt_pk_bf16_f32 v83, v60, v61
    s_nop 1
    v_mfma_f32_16x16x16_bf16 v[84:87], v[80:81], v[72:73], 0
    ds_read_b128 v[48:51], v11 offset:0
    v_mfma_f32_16x16x16_bf16 v[88:91], v[82:83], v[72:73], 0
    ds_read_b128 v[52:55], v11 offset:32768
    v_smfmac_f32_16x16x64_bf16 v[68:71], v[16:19], v[136:143], v74
    s_nop 1
    v_cvt_pk_bf16_f32 v92, v84, v85
    v_cvt_pk_bf16_f32 v93, v86, v87
    v_cvt_pk_bf16_f32 v94, v88, v89
    v_cvt_pk_bf16_f32 v95, v90, v91
    s_nop 1
    v_mfma_f32_16x16x32_bf16 v[112:115], v[92:95], v[92:95], 0
    ds_read_b128 v[56:59], v11 offset:1024
    v_mfma_f32_16x16x32_bf16 v[116:119], v[96:99], v[92:95], 0
    ds_read_b128 v[60:63], v11 offset:33792
    v_mfma_f32_16x16x32_bf16 v[120:123], v[100:103], v[92:95], 0
    s_cmp_eq_u32 s7, 63
    s_cbranch_scc1 CH_FAST_LAST
    global_store_dwordx4 v75, v[92:95], s[16:17] sc1
    v_smfmac_f32_16x16x64_bf16 v[64:67], v[20:23], v[144:151], v74
    ds_write_b128 v7, v[112:115]
    ds_write_b128 v7, v[116:119] offset:640
    ds_write_b128 v7, v[120:123] offset:1280
    global_load_dwordx4 v[96:99], v3, s[12:13]
    global_load_dwordx4 v[100:103], v3, s[12:13] offset:1024
    v_smfmac_f32_16x16x64_bf16 v[68:71], v[20:23], v[152:159], v74
    v_smfmac_f32_16x16x64_bf16 v[64:67], v[24:27], v[160:167], v74
    v_smfmac_f32_16x16x64_bf16 v[68:71], v[24:27], v[168:175], v74
    s_waitcnt lgkmcnt(0)
    s_barrier
    ds_read_b128 v[112:115], v8 offset:0
    ds_read_b32 v84, v0 offset:0
    v_smfmac_f32_16x16x64_bf16 v[64:67], v[28:31], v[176:183], v74
    ds_read_b128 v[116:119], v8 offset:2304
    ds_read_b32 v86, v0 offset:2304
    v_smfmac_f32_16x16x64_bf16 v[68:71], v[28:31], v[184:191], v74
    ds_read_b128 v[120:123], v8 offset:4608
    ds_read_b32 v85, v0 offset:4608
    v_smfmac_f32_16x16x64_bf16 v[64:67], v[32:35], v[192:199], v74
    ds_read_b128 v[124:127], v8 offset:6912
    ds_read_b32 v87, v0 offset:6912
    v_smfmac_f32_16x16x64_bf16 v[68:71], v[32:35], v[200:207], v74
    ds_read_b128 v[88:91], v1 offset:1024
    v_smfmac_f32_16x16x64_bf16 v[64:67], v[36:39], v[208:215], v74
    ds_read_b128 v[92:95], v1 offset:33792
    v_smfmac_f32_16x16x64_bf16 v[68:71], v[36:39], v[216:223], v74
    v_smfmac_f32_16x16x64_bf16 v[64:67], v[40:43], v[224:231], v74
    v_smfmac_f32_16x16x64_bf16 v[68:71], v[40:43], v[232:239], v74
    v_smfmac_f32_16x16x64_bf16 v[64:67], v[44:47], v[240:247], v74
    v_smfmac_f32_16x16x64_bf16 v[68:71], v[44:47], v[248:255], v74
    s_waitcnt lgkmcnt(2)
    v_pk_add_f32 v[112:113], v[112:113], v[116:117]
    v_pk_add_f32 v[114:115], v[114:115], v[118:119]
    v_pk_add_f32 v[120:121], v[120:121], v[124:125]
    v_pk_add_f32 v[122:123], v[122:123], v[126:127]
    v_pk_add_f32 v[84:85], v[84:85], v[86:87]
    v_pk_add_f32 v[112:113], v[112:113], v[120:121]
    v_pk_add_f32 v[114:115], v[114:115], v[122:123]
    v_add_f32 v116, v84, v85
    v_cvt_pk_bf16_f32 v112, 0, v112
    v_cvt_pk_bf16_f32 v113, 0, v113
    v_cvt_pk_bf16_f32 v114, 0, v114
    v_cvt_pk_bf16_f32 v115, 0, v115
    v_cvt_pk_bf16_f32 v116, 0, v116
    v_max3_f32 v126, v112, v113, v114
    v_max3_f32 v126, v126, v115, v116
    v_pk_mul_f32 v[112:113], v[112:113], s[64:65]
    v_pk_mul_f32 v[114:115], v[114:115], s[64:65]
    v_max_f32_dpp v126, v126, v126 row_ror:8 row_mask:0xf bank_mask:0xf
    v_mov_b32 v127, v126
    v_mul_f32 v116, s64, v116
    v_cvt_pk_bf16_f32 v112, 0, v112
    v_permlane16_swap_b32 v126, v127
    v_cvt_pk_bf16_f32 v113, 0, v113
    v_cvt_pk_bf16_f32 v114, 0, v114
    v_max_f32 v126, v126, v127
    v_mov_b32 v127, v126
    v_cvt_pk_bf16_f32 v115, 0, v115
    v_cvt_pk_bf16_f32 v116, 0, v116
    v_permlane32_swap_b32 v126, v127
    v_add_f32 v64, v64, v66
    v_add_f32 v65, v65, v67
    v_max_f32 v126, v126, v127
    v_mul_f32 v126, s64, v126
    v_cvt_pk_bf16_f32 v126, 0, v126
    v_mul_f32 v126, s66, v126
    v_pk_fma_f32 v[112:113], v[112:113], s[66:67], v[126:127] op_sel_hi:[1,1,0] neg_lo:[0,0,1] neg_hi:[0,0,1]
    v_pk_fma_f32 v[114:115], v[114:115], s[66:67], v[126:127] op_sel_hi:[1,1,0] neg_lo:[0,0,1] neg_hi:[0,0,1]
    v_fma_f32 v116, v116, s66, -v126
    v_exp_f32 v112, v112
    v_exp_f32 v113, v113
    v_exp_f32 v114, v114
    v_exp_f32 v115, v115
    v_exp_f32 v116, v116
    v_add_f32 v68, v68, v70
    v_pk_add_f32 v[126:127], v[112:113], v[114:115]
    v_add_f32 v126, v126, v127
    v_add_f32 v126, v126, v116
    v_add_f32 v69, v69, v71
    v_cvt_pk_bf16_f32 v80, v64, v65
    v_add_f32_dpp v126, v126, v126 row_ror:8 row_mask:0xf bank_mask:0xf
    v_mov_b32 v127, v126
    v_mov_b32 v81, 0
    v_cvt_pk_bf16_f32 v82, v68, v69
    v_permlane16_swap_b32 v126, v127
    v_mov_b32 v83, 0
    v_mov_b64 v[16:17], 0
    v_add_f32 v126, v126, v127
    ds_read_b128 v[64:67], v1 offset:0
    v_mov_b32 v127, v126
    v_mov_b64 v[18:19], 0
    v_mov_b64 v[20:21], 0
    v_permlane32_swap_b32 v126, v127
    ds_read_b128 v[68:71], v1 offset:32768
    v_mov_b64 v[22:23], 0
    s_nop 0
    v_add_f32 v126, v126, v127
    v_rcp_f32 v126, v126
    s_nop 0
    v_pk_mul_f32 v[112:113], v[112:113], v[126:127] op_sel_hi:[1,0]
    v_pk_mul_f32 v[114:115], v[114:115], v[126:127] op_sel_hi:[1,0]
    v_mul_f32 v116, v116, v126
    v_cvt_pk_bf16_f32 v112, v112, v113
    v_cvt_pk_bf16_f32 v113, v114, v115
    v_mov_b32_dpp v122, v116 row_ror:8 row_mask:0xf bank_mask:0xf
    v_mov_b32_dpp v114, v112 row_ror:8 row_mask:0xf bank_mask:0xf
    v_mov_b32_dpp v115, v113 row_ror:8 row_mask:0xf bank_mask:0xf
    v_cvt_pk_bf16_f32 v116, v116, v122
    v_mov_b32 v117, 0
    s_nop 1
    v_mfma_f32_16x16x32_bf16 v[120:123], v[104:107], v[112:115], 0
    v_mfma_f32_16x16x32_bf16 v[124:127], v[108:111], v[112:115], 0
    v_mfma_f32_16x16x16_bf16 v[120:123], v[80:81], v[116:117], v[120:123]
    v_mfma_f32_16x16x16_bf16 v[124:127], v[82:83], v[116:117], v[124:127]
    v_mov_b64 v[24:25], 0
    v_mov_b64 v[26:27], 0
    v_mov_b64 v[28:29], 0
    v_mov_b64 v[30:31], 0
    v_mov_b64 v[32:33], 0
    v_mov_b64 v[34:35], 0
    v_mov_b64 v[36:37], 0
    v_cvt_pk_bf16_f32 v112, v120, v121
    v_cvt_pk_bf16_f32 v114, v122, v123
    v_cvt_pk_bf16_f32 v113, v124, v125
    v_cvt_pk_bf16_f32 v115, v126, v127
    s_mov_b64 exec, s[20:21]
    ds_write2_b64 v9, v[112:113], v[114:115] offset0:0 offset1:2
    s_mov_b64 exec, -1
    global_store_dword v76, v80, s[18:19] sc1
    global_store_dword v76, v82, s[18:19] offset:512 sc1
    ds_read_b128 v[104:107], v11 offset:3072
    ds_read_b128 v[108:111], v11 offset:35840
    v_mov_b64 v[38:39], 0
    v_mov_b64 v[40:41], 0
    v_mov_b64 v[42:43], 0
    v_mov_b64 v[44:45], 0
    v_mov_b64 v[46:47], 0
    ds_read_b128 v[80:83], v11 offset:2048
    ds_read_b128 v[84:87], v11 offset:34816
    s_waitcnt lgkmcnt(4)
    s_barrier
    ds_read_b128 v[112:115], v10 offset:0
    ds_read_b128 v[116:119], v10 offset:1024
    ds_read_b128 v[120:123], v1 offset:2048
    ds_read_b128 v[124:127], v1 offset:34816
    s_waitcnt lgkmcnt(3)
    v_smfmac_f32_16x16x64_bf16 v[16:19], v[112:115], v[48:55], v74
    ds_read_b128 v[48:51], v1 offset:3072
    ds_read_b128 v[52:55], v1 offset:35840
    v_smfmac_f32_16x16x64_bf16 v[20:23], v[112:115], v[56:63], v74
    ds_read_b128 v[56:59], v11 offset:4096
    ds_read_b128 v[60:63], v11 offset:36864
    s_waitcnt lgkmcnt(6)
    v_smfmac_f32_16x16x64_bf16 v[16:19], v[116:119], v[64:71], v74
    ds_read_b128 v[64:67], v11 offset:5120
    ds_read_b128 v[68:71], v11 offset:37888
    v_smfmac_f32_16x16x64_bf16 v[20:23], v[116:119], v[88:95], v74
    ds_read_b128 v[88:91], v1 offset:4096
    ds_read_b128 v[92:95], v1 offset:36864
    v_smfmac_f32_16x16x64_bf16 v[24:27], v[112:115], v[80:87], v74
    ds_read_b128 v[80:83], v1 offset:5120
    ds_read_b128 v[84:87], v1 offset:37888
    v_smfmac_f32_16x16x64_bf16 v[28:31], v[112:115], v[104:111], v74
    ds_read_b128 v[104:107], v11 offset:6144
    ds_read_b128 v[108:111], v11 offset:38912
    v_pk_add_f32 v[16:17], v[16:17], v[18:19]
    v_pk_add_f32 v[18:19], v[20:21], v[22:23]
    v_and_or_b32 v16, v16, -2, s30
    global_store_dwordx4 v12, v[16:19], s[10:11]
    s_waitcnt lgkmcnt(12)
    v_smfmac_f32_16x16x64_bf16 v[24:27], v[116:119], v[120:127], v74
    ds_read_b128 v[120:123], v11 offset:7168
    ds_read_b128 v[124:127], v11 offset:39936
    s_waitcnt lgkmcnt(12)
    v_smfmac_f32_16x16x64_bf16 v[28:31], v[116:119], v[48:55], v74
    ds_read_b128 v[48:51], v1 offset:6144
    ds_read_b128 v[52:55], v1 offset:38912
    s_waitcnt lgkmcnt(12)
    v_smfmac_f32_16x16x64_bf16 v[32:35], v[112:115], v[56:63], v74
    ds_read_b128 v[56:59], v1 offset:7168
    ds_read_b128 v[60:63], v1 offset:39936
    s_waitcnt lgkmcnt(12)
    v_smfmac_f32_16x16x64_bf16 v[36:39], v[112:115], v[64:71], v74
    v_pk_add_f32 v[24:25], v[24:25], v[26:27]
    v_pk_add_f32 v[26:27], v[28:29], v[30:31]
    v_and_or_b32 v24, v24, -2, s30
    global_store_dwordx4 v12, v[24:27], s[96:97]
    s_waitcnt lgkmcnt(10)
    v_smfmac_f32_16x16x64_bf16 v[32:35], v[116:119], v[88:95], v74
    s_waitcnt lgkmcnt(8)
    v_smfmac_f32_16x16x64_bf16 v[36:39], v[116:119], v[80:87], v74
    s_waitcnt lgkmcnt(6)
    v_smfmac_f32_16x16x64_bf16 v[40:43], v[112:115], v[104:111], v74
    s_waitcnt lgkmcnt(4)
    v_smfmac_f32_16x16x64_bf16 v[44:47], v[112:115], v[120:127], v74
    v_pk_add_f32 v[32:33], v[32:33], v[34:35]
    v_pk_add_f32 v[34:35], v[36:37], v[38:39]
    v_and_or_b32 v32, v32, -2, s30
    global_store_dwordx4 v12, v[32:35], s[98:99]
    s_waitcnt lgkmcnt(2)
    v_smfmac_f32_16x16x64_bf16 v[40:43], v[116:119], v[48:55], v74
    s_waitcnt lgkmcnt(0)
    v_smfmac_f32_16x16x64_bf16 v[44:47], v[116:119], v[56:63], v74
    s_nop 7
    v_pk_add_f32 v[40:41], v[40:41], v[42:43]
    v_pk_add_f32 v[42:43], v[44:45], v[46:47]
    v_and_or_b32 v40, v40, -2, s30
    global_store_dwordx4 v12, v[40:43], s[100:101]
    s_nop 15
    s_nop 15
    s_nop 15
    s_nop 15
    s_nop 15
    s_nop 15
    s_cmp_le_u32 s68, 6
    s_cbranch_scc1 CH_FAST_PPOLL
    s_nop 13
CH_FAST_PPOLL:
    global_load_dwordx4 v[16:19], v13, s[10:11] offset:0 sc1
    global_load_dwordx4 v[20:23], v13, s[10:11] offset:1024 sc1
    global_load_dwordx4 v[24:27], v13, s[10:11] offset:2048 sc1
    global_load_dwordx4 v[28:31], v13, s[10:11] offset:3072 sc1
    s_waitcnt vmcnt(0)
    v_bitop3_b32 v56, v16, v20, s31 bitop3:0x7e
    v_bitop3_b32 v57, v24, v28, s31 bitop3:0x7e
    v_pk_add_f32 v[48:49], v[16:17], v[20:21]
    v_bitop3_b32 v56, v56, v57, 1 bitop3:0xa8
    v_pk_add_f32 v[50:51], v[18:19], v[22:23]
    v_cmp_ne_u32 vcc, 0, v56
    v_pk_add_f32 v[52:53], v[24:25], v[28:29]
    v_pk_add_f32 v[54:55], v[26:27], v[30:31]
    s_cbranch_vccnz CH_FAST_PPOLL
    v_pk_add_f32 v[48:49], v[48:49], v[52:53]
    v_pk_add_f32 v[50:51], v[50:51], v[54:55]
    s_nop 1
    v_permlane32_swap_b32 v48, v50
    v_permlane32_swap_b32 v49, v51
    s_nop 0
    v_pk_add_f32 v[48:49], v[48:49], v[50:51]
    s_nop 1
    v_permlane16_swap_b32 v48, v49
    s_nop 0
    v_add_f32 v48, v48, v49
    s_nop 1
    v_add_f32_dpp v48, v48, v48 row_ror:8 row_mask:0xf bank_mask:0xf
    s_nop 1
    v_mov_b32_dpp v49, v48 quad_perm:[1,1,3,3] row_mask:0xf bank_mask:0xf
    v_cvt_pk_bf16_f32 v48, v48, v49
    v_min_u32 v48, -2, v48
    s_mov_b64 exec, s[38:39]
    global_store_dword v14, v48, s[26:27]
    s_add_u32 s25, s7, 3
    s_and_b32 s25, s25, 3
    s_lshl_b32 s25, s25, 13
    s_add_u32 s25, s25, 5242880
    s_add_u32 s36, s4, s25
    s_addc_u32 s37, s5, 0
    v_mov_b32 v120, -1
    global_store_dword v14, v120, s[36:37]
    s_mov_b64 exec, -1
    s_and_b32 s25, s7, 7
    s_cmp_lg_u32 s25, 5
    s_cbranch_scc1 CH_FAST_KVOK
    s_cmp_ge_u32 s7, 56
    s_cbranch_scc1 CH_FAST_KVOK
CH_FAST_KVE:
    v_cmp_ne_u32 vcc, s46, v79
    s_and_b32 s25, vcc_lo, 0x6666
    s_cbranch_scc0 CH_FAST_KVP
    s_add_u32 s48, s4, s34
    s_addc_u32 s49, s5, 0
    global_load_dword v79, v2, s[48:49] sc1
    s_waitcnt vmcnt(0)
    s_branch CH_FAST_KVE
CH_FAST_KVP:
    s_add_u32 s34, s34, 64
    v_add_u32 v77, 64, v77
CH_FAST_KVOK:
    v_add_u32 v15, 8192, v15
    s_add_u32 s16, s16, 4096
    s_addc_u32 s17, s17, 0
    s_add_u32 s18, s18, 4096
    s_addc_u32 s19, s19, 0
    s_add_u32 s14, s14, 8192
    s_addc_u32 s15, s15, 0
    s_add_u32 s12, s12, 8192
    s_addc_u32 s13, s13, 0
    s_mov_b64 s[8:9], s[26:27]
    s_add_u32 s7, s7, 1
    s_add_u32 s25, s7, 1
    s_and_b32 s25, s25, 3
    s_lshl_b32 s25, s25, 13
    s_add_u32 s25, s25, 5242880
    s_add_u32 s26, s4, s25
    s_addc_u32 s27, s5, 0
    s_and_b32 s30, s7, 1
    s_sub_u32 s31, 0, s30
    s_branch CH_FAST_MPOLL
CH_FAST_LAST:
    v_min_u32 v124, -2, v92
    v_min_u32 v125, -2, v93
    v_min_u32 v126, -2, v94
    v_min_u32 v127, -2, v95
    s_mov_b64 exec, s[44:45]
    global_store_dwordx4 v75, v[124:127], s[16:17] sc1
    s_mov_b64 exec, -1
    v_smfmac_f32_16x16x64_bf16 v[64:67], v[20:23], v[144:151], v74
    v_smfmac_f32_16x16x64_bf16 v[68:71], v[20:23], v[152:159], v74
    v_smfmac_f32_16x16x64_bf16 v[64:67], v[24:27], v[160:167], v74
    v_smfmac_f32_16x16x64_bf16 v[68:71], v[24:27], v[168:175], v74
    v_smfmac_f32_16x16x64_bf16 v[64:67], v[28:31], v[176:183], v74
    v_smfmac_f32_16x16x64_bf16 v[68:71], v[28:31], v[184:191], v74
    v_smfmac_f32_16x16x64_bf16 v[64:67], v[32:35], v[192:199], v74
    v_smfmac_f32_16x16x64_bf16 v[68:71], v[32:35], v[200:207], v74
    v_smfmac_f32_16x16x64_bf16 v[64:67], v[36:39], v[208:215], v74
    v_smfmac_f32_16x16x64_bf16 v[68:71], v[36:39], v[216:223], v74
    v_smfmac_f32_16x16x64_bf16 v[64:67], v[40:43], v[224:231], v74
    v_smfmac_f32_16x16x64_bf16 v[68:71], v[40:43], v[232:239], v74
    v_smfmac_f32_16x16x64_bf16 v[64:67], v[44:47], v[240:247], v74
    v_smfmac_f32_16x16x64_bf16 v[68:71], v[44:47], v[248:255], v74
    s_nop 7
    v_add_f32 v64, v64, v66
    v_add_f32 v65, v65, v67
    v_add_f32 v68, v68, v70
    v_add_f32 v69, v69, v71
    v_cvt_pk_bf16_f32 v80, v64, v65
    v_min_u32 v80, -2, v80
    v_cvt_pk_bf16_f32 v82, v68, v69
    v_min_u32 v82, -2, v82
    global_store_dword v76, v80, s[18:19] sc1
    global_store_dword v76, v82, s[18:19] offset:512 sc1
    s_branch CH_FIN
CH_SLOW_LOOP:
    v_mov_b32 v78, s46
    v_and_b32 v2, 15, v2
    v_lshlrev_b32 v2, 2, v2
    v_add_u32 v15, s35, v2
    v_add_u32 v15, -8192, v15
    s_add_u32 s35, s35, 516096
    v_add_u32 v77, s34, v2
    v_mov_b64 v[48:49], 0
    v_mov_b64 v[50:51], 0
    v_mov_b64 v[52:53], 0
    v_mov_b64 v[54:55], 0
    v_mov_b64 v[56:57], 0
    v_mov_b64 v[58:59], 0
    v_mov_b64 v[60:61], 0
    v_mov_b64 v[62:63], 0
    v_mov_b64 v[64:65], 0
    v_mov_b64 v[66:67], 0
    v_mov_b64 v[68:69], 0
    v_mov_b64 v[70:71], 0
    s_mov_b32 s30, 0
    s_mov_b32 s31, 0
    s_waitcnt vmcnt(0)
    ds_write_b128 v5, v[112:115]
    ds_write_b128 v5, v[116:119] offset:1024
    v_xor_b32 v86, 2048, v5
    v_xor_b32 v87, 4096, v5
    v_xor_b32 v88, 6144, v5
    v_mov_b64 v[16:17], v[112:113]
    v_mov_b64 v[18:19], v[114:115]
    v_mov_b64 v[20:21], v[116:117]
    v_mov_b64 v[22:23], v[118:119]
    s_branch CH_SLOW_GOT
CH_SLOW_MPOLL:
    s_nop 15
    s_nop 11
    global_load_dwordx4 v[112:115], v4, s[8:9] sc1
    global_load_dwordx4 v[116:119], v4, s[8:9] offset:1024 sc1
    v_mov_b64 v[48:49], 0
    v_mov_b64 v[50:51], 0
    v_mov_b64 v[52:53], 0
    v_mov_b64 v[54:55], 0
    v_mov_b64 v[56:57], 0
    v_mov_b64 v[58:59], 0
    v_mov_b64 v[60:61], 0
    v_mov_b64 v[62:63], 0
    v_mov_b64 v[64:65], 0
    v_mov_b64 v[66:67], 0
    v_mov_b64 v[68:69], 0
    v_mov_b64 v[70:71], 0
    v_xor_b32 v86, 2048, v5
    v_xor_b32 v87, 4096, v5
    v_xor_b32 v88, 6144, v5
    s_nop 15
    global_load_dwordx4 v[120:123], v4, s[8:9] sc1
    global_load_dwordx4 v[124:127], v4, s[8:9] offset:1024 sc1
    s_nop 15
    s_nop 11
    global_load_dwordx4 v[104:107], v4, s[8:9] sc1
    global_load_dwordx4 v[108:111], v4, s[8:9] offset:1024 sc1
CH_SLOW_MPL:
    s_waitcnt vmcnt(4)
    ds_write_b128 v5, v[112:115]
    v_max3_u32 v84, v112, v113, v114
    v_max3_u32 v85, v115, v116, v117
    v_max3_u32 v84, v84, v118, v119
    ds_write_b128 v5, v[116:119] offset:1024
    v_max_u32 v84, v84, v85
    v_cmp_eq_u32 vcc, -1, v84
    v_mov_b64 v[16:17], v[112:113]
    v_mov_b64 v[18:19], v[114:115]
    v_mov_b64 v[20:21], v[116:117]
    v_mov_b64 v[22:23], v[118:119]
    s_cbranch_vccz CH_SLOW_GOT
    global_load_dwordx4 v[112:115], v4, s[8:9] sc1
    global_load_dwordx4 v[116:119], v4, s[8:9] offset:1024 sc1
    s_waitcnt vmcnt(4)
    ds_write_b128 v5, v[120:123]
    v_max3_u32 v84, v120, v121, v122
    v_max3_u32 v85, v123, v124, v125
    v_max3_u32 v84, v84, v126, v127
    ds_write_b128 v5, v[124:127] offset:1024
    v_max_u32 v84, v84, v85
    v_cmp_eq_u32 vcc, -1, v84
    v_mov_b64 v[16:17], v[120:121]
    v_mov_b64 v[18:19], v[122:123]
    v_mov_b64 v[20:21], v[124:125]
    v_mov_b64 v[22:23], v[126:127]
    s_cbranch_vccz CH_SLOW_GOT
    global_load_dwordx4 v[120:123], v4, s[8:9] sc1
    global_load_dwordx4 v[124:127], v4, s[8:9] offset:1024 sc1
    s_waitcnt vmcnt(4)
    ds_write_b128 v5, v[104:107]
    v_max3_u32 v84, v104, v105, v106
    v_max3_u32 v85, v107, v108, v109
    v_max3_u32 v84, v84, v110, v111
    ds_write_b128 v5, v[108:111] offset:1024
    v_max_u32 v84, v84, v85
    v_cmp_eq_u32 vcc, -1, v84
    v_mov_b64 v[16:17], v[104:105]
    v_mov_b64 v[18:19], v[106:107]
    v_mov_b64 v[20:21], v[108:109]
    v_mov_b64 v[22:23], v[110:111]
    s_cbranch_vccz CH_SLOW_GOT
    global_load_dwordx4 v[104:107], v4, s[8:9] sc1
    global_load_dwordx4 v[108:111], v4, s[8:9] offset:1024 sc1
    s_branch CH_SLOW_MPL
    .p2align 6
CH_SLOW_GOT:
    v_smfmac_f32_16x16x64_bf16 v[48:51], v[16:19], a[0:7], v74
    v_smfmac_f32_16x16x64_bf16 v[52:55], v[16:19], a[8:15], v74
    v_smfmac_f32_16x16x64_bf16 v[56:59], v[16:19], a[128:135], v74
    s_waitcnt lgkmcnt(0)
    s_barrier
    ds_read_b128 v[24:27], v86 offset:0
    ds_read_b128 v[28:31], v86 offset:1024
    v_smfmac_f32_16x16x64_bf16 v[60:63], v[16:19], a[136:143], v74
    ds_read_b128 v[32:35], v87 offset:0
    v_smfmac_f32_16x16x64_bf16 v[48:51], v[20:23], a[16:23], v74
    ds_read_b128 v[36:39], v87 offset:1024
    v_smfmac_f32_16x16x64_bf16 v[52:55], v[20:23], a[24:31], v74
    ds_read_b128 v[40:43], v88 offset:0
    v_smfmac_f32_16x16x64_bf16 v[56:59], v[20:23], a[144:151], v74
    ds_read_b128 v[44:47], v88 offset:1024
    v_smfmac_f32_16x16x64_bf16 v[60:63], v[20:23], a[152:159], v74
    s_waitcnt lgkmcnt(5)
    v_smfmac_f32_16x16x64_bf16 v[48:51], v[24:27], a[32:39], v74
    v_smfmac_f32_16x16x64_bf16 v[52:55], v[24:27], a[40:47], v74
    v_smfmac_f32_16x16x64_bf16 v[56:59], v[24:27], a[160:167], v74
    v_smfmac_f32_16x16x64_bf16 v[60:63], v[24:27], a[168:175], v74
    s_waitcnt lgkmcnt(4)
    v_smfmac_f32_16x16x64_bf16 v[48:51], v[28:31], a[48:55], v74
    v_smfmac_f32_16x16x64_bf16 v[52:55], v[28:31], a[56:63], v74
    v_smfmac_f32_16x16x64_bf16 v[56:59], v[28:31], a[176:183], v74
    v_smfmac_f32_16x16x64_bf16 v[60:63], v[28:31], a[184:191], v74
    s_waitcnt vmcnt(0)
    global_store_dword v15, v78, s[4:5] sc1
    s_waitcnt lgkmcnt(3)
    v_smfmac_f32_16x16x64_bf16 v[48:51], v[32:35], a[64:71], v74
    ds_read_b128 v[104:107], v5 offset:8192
    v_smfmac_f32_16x16x64_bf16 v[52:55], v[32:35], a[72:79], v74
    ds_read_b128 v[108:111], v5 offset:9216
    global_load_dword v79, v77, s[4:5] sc1
    v_smfmac_f32_16x16x64_bf16 v[56:59], v[32:35], a[192:199], v74
    v_smfmac_f32_16x16x64_bf16 v[60:63], v[32:35], a[200:207], v74
    s_waitcnt lgkmcnt(4)
    v_smfmac_f32_16x16x64_bf16 v[48:51], v[36:39], a[80:87], v74
    v_smfmac_f32_16x16x64_bf16 v[52:55], v[36:39], a[88:95], v74
    v_smfmac_f32_16x16x64_bf16 v[56:59], v[36:39], a[208:215], v74
    v_smfmac_f32_16x16x64_bf16 v[60:63], v[36:39], a[216:223], v74
    s_waitcnt lgkmcnt(0)
    global_load_lds_dwordx4 v3, s[14:15]
    global_load_lds_dwordx4 v3, s[14:15] offset:1024
    v_smfmac_f32_16x16x64_bf16 v[48:51], v[40:43], a[96:103], v74
    v_smfmac_f32_16x16x64_bf16 v[52:55], v[40:43], a[104:111], v74
    v_smfmac_f32_16x16x64_bf16 v[56:59], v[40:43], a[224:231], v74
    v_smfmac_f32_16x16x64_bf16 v[60:63], v[40:43], a[232:239], v74
    v_smfmac_f32_16x16x64_bf16 v[48:51], v[44:47], a[112:119], v74
    v_smfmac_f32_16x16x64_bf16 v[52:55], v[44:47], a[120:127], v74
    v_smfmac_f32_16x16x64_bf16 v[56:59], v[44:47], a[240:247], v74
    v_smfmac_f32_16x16x64_bf16 v[60:63], v[44:47], a[248:255], v74
    v_smfmac_f32_16x16x64_bf16 v[64:67], v[16:19], v[128:135], v74
    s_nop 1
    v_pk_add_f32 v[48:49], v[48:49], v[50:51]
    v_pk_add_f32 v[56:57], v[56:57], v[58:59]
    v_cvt_pk_bf16_f32 v80, v48, v49
    v_cvt_pk_bf16_f32 v81, v56, v57
    v_pk_add_f32 v[52:53], v[52:53], v[54:55]
    v_pk_add_f32 v[60:61], v[60:61], v[62:63]
    v_cvt_pk_bf16_f32 v82, v52, v53
    v_cvt_pk_bf16_f32 v83, v60, v61
    s_nop 1
    v_mfma_f32_16x16x16_bf16 v[84:87], v[80:81], v[72:73], 0
    ds_read_b128 v[48:51], v11 offset:0
    v_mfma_f32_16x16x16_bf16 v[88:91], v[82:83], v[72:73], 0
    ds_read_b128 v[52:55], v11 offset:32768
    v_smfmac_f32_16x16x64_bf16 v[68:71], v[16:19], v[136:143], v74
    s_nop 1
    v_cvt_pk_bf16_f32 v92, v84, v85
    v_cvt_pk_bf16_f32 v93, v86, v87
    v_cvt_pk_bf16_f32 v94, v88, v89
    v_cvt_pk_bf16_f32 v95, v90, v91
    s_nop 1
    v_mfma_f32_16x16x32_bf16 v[112:115], v[92:95], v[92:95], 0
    ds_read_b128 v[56:59], v11 offset:1024
    v_mfma_f32_16x16x32_bf16 v[116:119], v[96:99], v[92:95], 0
    ds_read_b128 v[60:63], v11 offset:33792
    v_mfma_f32_16x16x32_bf16 v[120:123], v[100:103], v[92:95], 0
    s_cmp_eq_u32 s7, 63
    s_cbranch_scc1 CH_SLOW_LAST
    global_store_dwordx4 v75, v[92:95], s[16:17] sc1
    v_smfmac_f32_16x16x64_bf16 v[64:67], v[20:23], v[144:151], v74
    ds_write_b128 v7, v[112:115]
    ds_write_b128 v7, v[116:119] offset:640
    ds_write_b128 v7, v[120:123] offset:1280
    global_load_dwordx4 v[96:99], v3, s[12:13]
    global_load_dwordx4 v[100:103], v3, s[12:13] offset:1024
    v_smfmac_f32_16x16x64_bf16 v[68:71], v[20:23], v[152:159], v74
    v_smfmac_f32_16x16x64_bf16 v[64:67], v[24:27], v[160:167], v74
    v_smfmac_f32_16x16x64_bf16 v[68:71], v[24:27], v[168:175], v74
    s_waitcnt lgkmcnt(0)
    s_barrier
    ds_read_b128 v[112:115], v8 offset:0
    ds_read_b32 v84, v0 offset:0
    v_smfmac_f32_16x16x64_bf16 v[64:67], v[28:31], v[176:183], v74
    ds_read_b128 v[116:119], v8 offset:2304
    ds_read_b32 v86, v0 offset:2304
    v_smfmac_f32_16x16x64_bf16 v[68:71], v[28:31], v[184:191], v74
    ds_read_b128 v[120:123], v8 offset:4608
    ds_read_b32 v85, v0 offset:4608
    v_smfmac_f32_16x16x64_bf16 v[64:67], v[32:35], v[192:199], v74
    ds_read_b128 v[124:127], v8 offset:6912
    ds_read_b32 v87, v0 offset:6912
    v_smfmac_f32_16x16x64_bf16 v[68:71], v[32:35], v[200:207], v74
    ds_read_b128 v[88:91], v1 offset:1024
    v_smfmac_f32_16x16x64_bf16 v[64:67], v[36:39], v[208:215], v74
    ds_read_b128 v[92:95], v1 offset:33792
    v_smfmac_f32_16x16x64_bf16 v[68:71], v[36:39], v[216:223], v74
    v_smfmac_f32_16x16x64_bf16 v[64:67], v[40:43], v[224:231], v74
    v_smfmac_f32_16x16x64_bf16 v[68:71], v[40:43], v[232:239], v74
    v_smfmac_f32_16x16x64_bf16 v[64:67], v[44:47], v[240:247], v74
    v_smfmac_f32_16x16x64_bf16 v[68:71], v[44:47], v[248:255], v74
    s_waitcnt lgkmcnt(2)
    v_pk_add_f32 v[112:113], v[112:113], v[116:117]
    v_pk_add_f32 v[114:115], v[114:115], v[118:119]
    v_pk_add_f32 v[120:121], v[120:121], v[124:125]
    v_pk_add_f32 v[122:123], v[122:123], v[126:127]
    v_pk_add_f32 v[84:85], v[84:85], v[86:87]
    v_pk_add_f32 v[112:113], v[112:113], v[120:121]
    v_pk_add_f32 v[114:115], v[114:115], v[122:123]
    v_add_f32 v116, v84, v85
    v_cvt_pk_bf16_f32 v112, 0, v112
    v_cvt_pk_bf16_f32 v113, 0, v113
    v_cvt_pk_bf16_f32 v114, 0, v114
    v_cvt_pk_bf16_f32 v115, 0, v115
    v_cvt_pk_bf16_f32 v116, 0, v116
    v_max3_f32 v126, v112, v113, v114
    v_max3_f32 v126, v126, v115, v116
    v_pk_mul_f32 v[112:113], v[112:113], s[64:65]
    v_pk_mul_f32 v[114:115], v[114:115], s[64:65]
    v_max_f32_dpp v126, v126, v126 row_ror:8 row_mask:0xf bank_mask:0xf
    v_mov_b32 v127, v126
    v_mul_f32 v116, s64, v116
    v_cvt_pk_bf16_f32 v112, 0, v112
    v_permlane16_swap_b32 v126, v127
    v_cvt_pk_bf16_f32 v113, 0, v113
    v_cvt_pk_bf16_f32 v114, 0, v114
    v_max_f32 v126, v126, v127
    v_mov_b32 v127, v126
    v_cvt_pk_bf16_f32 v115, 0, v115
    v_cvt_pk_bf16_f32 v116, 0, v116
    v_permlane32_swap_b32 v126, v127
    v_add_f32 v64, v64, v66
    v_add_f32 v65, v65, v67
    v_max_f32 v126, v126, v127
    v_mul_f32 v126, s64, v126
    v_cvt_pk_bf16_f32 v126, 0, v126
    v_mul_f32 v126, s66, v126
    v_pk_fma_f32 v[112:113], v[112:113], s[66:67], v[126:127] op_sel_hi:[1,1,0] neg_lo:[0,0,1] neg_hi:[0,0,1]
    v_pk_fma_f32 v[114:115], v[114:115], s[66:67], v[126:127] op_sel_hi:[1,1,0] neg_lo:[0,0,1] neg_hi:[0,0,1]
    v_fma_f32 v116, v116, s66, -v126
    v_exp_f32 v112, v112
    v_exp_f32 v113, v113
    v_exp_f32 v114, v114
    v_exp_f32 v115, v115
    v_exp_f32 v116, v116
    v_add_f32 v68, v68, v70
    v_pk_add_f32 v[126:127], v[112:113], v[114:115]
    v_add_f32 v126, v126, v127
    v_add_f32 v126, v126, v116
    v_add_f32 v69, v69, v71
    v_cvt_pk_bf16_f32 v80, v64, v65
    v_add_f32_dpp v126, v126, v126 row_ror:8 row_mask:0xf bank_mask:0xf
    v_mov_b32 v127, v126
    v_mov_b32 v81, 0
    v_cvt_pk_bf16_f32 v82, v68, v69
    v_permlane16_swap_b32 v126, v127
    v_mov_b32 v83, 0
    v_mov_b64 v[16:17], 0
    v_add_f32 v126, v126, v127
    ds_read_b128 v[64:67], v1 offset:0
    v_mov_b32 v127, v126
    v_mov_b64 v[18:19], 0
    v_mov_b64 v[20:21], 0
    v_permlane32_swap_b32 v126, v127
    ds_read_b128 v[68:71], v1 offset:32768
    v_mov_b64 v[22:23], 0
    s_nop 0
    v_add_f32 v126, v126, v127
    v_rcp_f32 v126, v126
    s_nop 0
    v_pk_mul_f32 v[112:113], v[112:113], v[126:127] op_sel_hi:[1,0]
    v_pk_mul_f32 v[114:115], v[114:115], v[126:127] op_sel_hi:[1,0]
    v_mul_f32 v116, v116, v126
    v_cvt_pk_bf16_f32 v112, v112, v113
    v_cvt_pk_bf16_f32 v113, v114, v115
    v_mov_b32_dpp v122, v116 row_ror:8 row_mask:0xf bank_mask:0xf
    v_mov_b32_dpp v114, v112 row_ror:8 row_mask:0xf bank_mask:0xf
    v_mov_b32_dpp v115, v113 row_ror:8 row_mask:0xf bank_mask:0xf
    v_cvt_pk_bf16_f32 v116, v116, v122
    v_mov_b32 v117, 0
    s_nop 1
    v_mfma_f32_16x16x32_bf16 v[120:123], v[104:107], v[112:115], 0
    v_mfma_f32_16x16x32_bf16 v[124:127], v[108:111], v[112:115], 0
    v_mfma_f32_16x16x16_bf16 v[120:123], v[80:81], v[116:117], v[120:123]
    v_mfma_f32_16x16x16_bf16 v[124:127], v[82:83], v[116:117], v[124:127]
    v_mov_b64 v[24:25], 0
    v_mov_b64 v[26:27], 0
    v_mov_b64 v[28:29], 0
    v_mov_b64 v[30:31], 0
    v_mov_b64 v[32:33], 0
    v_mov_b64 v[34:35], 0
    v_mov_b64 v[36:37], 0
    v_cvt_pk_bf16_f32 v112, v120, v121
    v_cvt_pk_bf16_f32 v114, v122, v123
    v_cvt_pk_bf16_f32 v113, v124, v125
    v_cvt_pk_bf16_f32 v115, v126, v127
    s_mov_b64 exec, s[20:21]
    ds_write2_b64 v9, v[112:113], v[114:115] offset0:0 offset1:2
    s_mov_b64 exec, -1
    global_store_dword v76, v80, s[18:19] sc1
    global_store_dword v76, v82, s[18:19] offset:512 sc1
    ds_read_b128 v[104:107], v11 offset:3072
    ds_read_b128 v[108:111], v11 offset:35840
    v_mov_b64 v[38:39], 0
    v_mov_b64 v[40:41], 0
    v_mov_b64 v[42:43], 0
    v_mov_b64 v[44:45], 0
    v_mov_b64 v[46:47], 0
    ds_read_b128 v[80:83], v11 offset:2048
    ds_read_b128 v[84:87], v11 offset:34816
    s_waitcnt lgkmcnt(4)
    s_barrier
    ds_read_b128 v[112:115], v10 offset:0
    ds_read_b128 v[116:119], v10 offset:1024
    ds_read_b128 v[120:123], v1 offset:2048
    ds_read_b128 v[124:127], v1 offset:34816
    s_waitcnt lgkmcnt(3)
    v_smfmac_f32_16x16x64_bf16 v[16:19], v[112:115], v[48:55], v74
    ds_read_b128 v[48:51], v1 offset:3072
    ds_read_b128 v[52:55], v1 offset:35840
    v_smfmac_f32_16x16x64_bf16 v[20:23], v[112:115], v[56:63], v74
    ds_read_b128 v[56:59], v11 offset:4096
    ds_read_b128 v[60:63], v11 offset:36864
    s_waitcnt lgkmcnt(6)
    v_smfmac_f32_16x16x64_bf16 v[16:19], v[116:119], v[64:71], v74
    ds_read_b128 v[64:67], v11 offset:5120
    ds_read_b128 v[68:71], v11 offset:37888
    v_smfmac_f32_16x16x64_bf16 v[20:23], v[116:119], v[88:95], v74
    ds_read_b128 v[88:91], v1 offset:4096
    ds_read_b128 v[92:95], v1 offset:36864
    v_smfmac_f32_16x16x64_bf16 v[24:27], v[112:115], v[80:87], v74
    ds_read_b128 v[80:83], v1 offset:5120
    ds_read_b128 v[84:87], v1 offset:37888
    v_smfmac_f32_16x16x64_bf16 v[28:31], v[112:115], v[104:111], v74
    ds_read_b128 v[104:107], v11 offset:6144
    ds_read_b128 v[108:111], v11 offset:38912
    v_pk_add_f32 v[16:17], v[16:17], v[18:19]
    v_pk_add_f32 v[18:19], v[20:21], v[22:23]
    v_and_or_b32 v16, v16, -2, s30
    global_store_dwordx4 v12, v[16:19], s[10:11] sc1
    s_waitcnt lgkmcnt(12)
    v_smfmac_f32_16x16x64_bf16 v[24:27], v[116:119], v[120:127], v74
    ds_read_b128 v[120:123], v11 offset:7168
    ds_read_b128 v[124:127], v11 offset:39936
    s_waitcnt lgkmcnt(12)
    v_smfmac_f32_16x16x64_bf16 v[28:31], v[116:119], v[48:55], v74
    ds_read_b128 v[48:51], v1 offset:6144
    ds_read_b128 v[52:55], v1 offset:38912
    s_waitcnt lgkmcnt(12)
    v_smfmac_f32_16x16x64_bf16 v[32:35], v[112:115], v[56:63], v74
    ds_read_b128 v[56:59], v1 offset:7168
    ds_read_b128 v[60:63], v1 offset:39936
    s_waitcnt lgkmcnt(12)
    v_smfmac_f32_16x16x64_bf16 v[36:39], v[112:115], v[64:71], v74
    v_pk_add_f32 v[24:25], v[24:25], v[26:27]
    v_pk_add_f32 v[26:27], v[28:29], v[30:31]
    v_and_or_b32 v24, v24, -2, s30
    global_store_dwordx4 v12, v[24:27], s[96:97] sc1
    s_waitcnt lgkmcnt(10)
    v_smfmac_f32_16x16x64_bf16 v[32:35], v[116:119], v[88:95], v74
    s_waitcnt lgkmcnt(8)
    v_smfmac_f32_16x16x64_bf16 v[36:39], v[116:119], v[80:87], v74
    s_waitcnt lgkmcnt(6)
    v_smfmac_f32_16x16x64_bf16 v[40:43], v[112:115], v[104:111], v74
    s_waitcnt lgkmcnt(4)
    v_smfmac_f32_16x16x64_bf16 v[44:47], v[112:115], v[120:127], v74
    v_pk_add_f32 v[32:33], v[32:33], v[34:35]
    v_pk_add_f32 v[34:35], v[36:37], v[38:39]
    v_and_or_b32 v32, v32, -2, s30
    global_store_dwordx4 v12, v[32:35], s[98:99] sc1
    s_waitcnt lgkmcnt(2)
    v_smfmac_f32_16x16x64_bf16 v[40:43], v[116:119], v[48:55], v74
    s_waitcnt lgkmcnt(0)
    v_smfmac_f32_16x16x64_bf16 v[44:47], v[116:119], v[56:63], v74
    s_nop 7
    v_pk_add_f32 v[40:41], v[40:41], v[42:43]
    v_pk_add_f32 v[42:43], v[44:45], v[46:47]
    v_and_or_b32 v40, v40, -2, s30
    global_store_dwordx4 v12, v[40:43], s[100:101] sc1
    s_nop 15
    s_nop 15
    s_nop 15
    s_nop 15
    s_nop 15
    s_nop 15
    s_cmp_le_u32 s68, 6
    s_cbranch_scc1 CH_SLOW_PPOLL
    s_nop 13
CH_SLOW_PPOLL:
    global_load_dwordx4 v[16:19], v13, s[10:11] offset:0 sc1
    global_load_dwordx4 v[20:23], v13, s[10:11] offset:1024 sc1
    global_load_dwordx4 v[24:27], v13, s[10:11] offset:2048 sc1
    global_load_dwordx4 v[28:31], v13, s[10:11] offset:3072 sc1
    s_waitcnt vmcnt(0)
    v_bitop3_b32 v56, v16, v20, s31 bitop3:0x7e
    v_bitop3_b32 v57, v24, v28, s31 bitop3:0x7e
    v_pk_add_f32 v[48:49], v[16:17], v[20:21]
    v_bitop3_b32 v56, v56, v57, 1 bitop3:0xa8
    v_pk_add_f32 v[50:51], v[18:19], v[22:23]
    v_cmp_ne_u32 vcc, 0, v56
    v_pk_add_f32 v[52:53], v[24:25], v[28:29]
    v_pk_add_f32 v[54:55], v[26:27], v[30:31]
    s_cbranch_vccnz CH_SLOW_PPOLL
    v_pk_add_f32 v[48:49], v[48:49], v[52:53]
    v_pk_add_f32 v[50:51], v[50:51], v[54:55]
    s_nop 1
    v_permlane32_swap_b32 v48, v50
    v_permlane32_swap_b32 v49, v51
    s_nop 0
    v_pk_add_f32 v[48:49], v[48:49], v[50:51]
    s_nop 1
    v_permlane16_swap_b32 v48, v49
    s_nop 0
    v_add_f32 v48, v48, v49
    s_nop 1
    v_add_f32_dpp v48, v48, v48 row_ror:8 row_mask:0xf bank_mask:0xf
    s_nop 1
    v_mov_b32_dpp v49, v48 quad_perm:[1,1,3,3] row_mask:0xf bank_mask:0xf
    v_cvt_pk_bf16_f32 v48, v48, v49
    v_min_u32 v48, -2, v48
    s_mov_b64 exec, s[38:39]
    global_store_dword v14, v48, s[26:27] sc1
    s_add_u32 s25, s7, 3
    s_and_b32 s25, s25, 3
    s_lshl_b32 s25, s25, 13
    s_add_u32 s25, s25, 5242880
    s_add_u32 s36, s4, s25
    s_addc_u32 s37, s5, 0
    v_mov_b32 v120, -1
    global_store_dword v14, v120, s[36:37] sc1
    s_mov_b64 exec, -1
    s_and_b32 s25, s7, 7
    s_cmp_lg_u32 s25, 5
    s_cbranch_scc1 CH_SLOW_KVOK
    s_cmp_ge_u32 s7, 56
    s_cbranch_scc1 CH_SLOW_KVOK
CH_SLOW_KVE:
    v_cmp_ne_u32 vcc, s46, v79
    s_and_b32 s25, vcc_lo, 0x6666
    s_cbranch_scc0 CH_SLOW_KVP
    s_add_u32 s48, s4, s34
    s_addc_u32 s49, s5, 0
    global_load_dword v79, v2, s[48:49] sc1
    s_waitcnt vmcnt(0)
    s_branch CH_SLOW_KVE
CH_SLOW_KVP:
    s_add_u32 s34, s34, 64
    v_add_u32 v77, 64, v77
CH_SLOW_KVOK:
    v_add_u32 v15, 8192, v15
    s_add_u32 s16, s16, 4096
    s_addc_u32 s17, s17, 0
    s_add_u32 s18, s18, 4096
    s_addc_u32 s19, s19, 0
    s_add_u32 s14, s14, 8192
    s_addc_u32 s15, s15, 0
    s_add_u32 s12, s12, 8192
    s_addc_u32 s13, s13, 0
    s_mov_b64 s[8:9], s[26:27]
    s_add_u32 s7, s7, 1
    s_add_u32 s25, s7, 1
    s_and_b32 s25, s25, 3
    s_lshl_b32 s25, s25, 13
    s_add_u32 s25, s25, 5242880
    s_add_u32 s26, s4, s25
    s_addc_u32 s27, s5, 0
    s_and_b32 s30, s7, 1
    s_sub_u32 s31, 0, s30
    s_branch CH_SLOW_MPOLL
CH_SLOW_LAST:
    v_min_u32 v124, -2, v92
    v_min_u32 v125, -2, v93
    v_min_u32 v126, -2, v94
    v_min_u32 v127, -2, v95
    s_mov_b64 exec, s[44:45]
    global_store_dwordx4 v75, v[124:127], s[16:17] sc1
    s_mov_b64 exec, -1
    v_smfmac_f32_16x16x64_bf16 v[64:67], v[20:23], v[144:151], v74
    v_smfmac_f32_16x16x64_bf16 v[68:71], v[20:23], v[152:159], v74
    v_smfmac_f32_16x16x64_bf16 v[64:67], v[24:27], v[160:167], v74
    v_smfmac_f32_16x16x64_bf16 v[68:71], v[24:27], v[168:175], v74
    v_smfmac_f32_16x16x64_bf16 v[64:67], v[28:31], v[176:183], v74
    v_smfmac_f32_16x16x64_bf16 v[68:71], v[28:31], v[184:191], v74
    v_smfmac_f32_16x16x64_bf16 v[64:67], v[32:35], v[192:199], v74
    v_smfmac_f32_16x16x64_bf16 v[68:71], v[32:35], v[200:207], v74
    v_smfmac_f32_16x16x64_bf16 v[64:67], v[36:39], v[208:215], v74
    v_smfmac_f32_16x16x64_bf16 v[68:71], v[36:39], v[216:223], v74
    v_smfmac_f32_16x16x64_bf16 v[64:67], v[40:43], v[224:231], v74
    v_smfmac_f32_16x16x64_bf16 v[68:71], v[40:43], v[232:239], v74
    v_smfmac_f32_16x16x64_bf16 v[64:67], v[44:47], v[240:247], v74
    v_smfmac_f32_16x16x64_bf16 v[68:71], v[44:47], v[248:255], v74
    s_nop 7
    v_add_f32 v64, v64, v66
    v_add_f32 v65, v65, v67
    v_add_f32 v68, v68, v70
    v_add_f32 v69, v69, v71
    v_cvt_pk_bf16_f32 v80, v64, v65
    v_min_u32 v80, -2, v80
    v_cvt_pk_bf16_f32 v82, v68, v69
    v_min_u32 v82, -2, v82
    global_store_dword v76, v80, s[18:19] sc1
    global_store_dword v76, v82, s[18:19] offset:512 sc1
    s_branch CH_FIN
CH_FIN:
    s_waitcnt vmcnt(0)
    v_add_u32 v112, s35, v2
    v_mov_b32 v113, s46
    s_mov_b64 exec, 0xffff
    global_store_dword v112, v113, s[4:5] sc1
    s_mov_b64 exec, -1
    s_add_u32 s35, s35, 8192
    s_endpgm
WK_START:
    s_load_dwordx2 s[4:5], s[0:1], 112
    v_lshrrev_b32 v1, 6, v0
    v_and_b32 v2, 63, v0
    s_nop 0
    v_readfirstlane_b32 s3, v1
    s_lshr_b32 s40, s2, 3
    s_mul_i32 s40, s40, 7
    s_and_b32 s41, s2, 7
    s_add_u32 s40, s40, s41
    s_sub_u32 s40, s40, 1
    s_waitcnt lgkmcnt(0)
    s_load_dwordx2 s[8:9], s[0:1], 0
    s_load_dwordx2 s[50:51], s[0:1], 64
    s_lshl_b32 s52, s40, 4
    s_lshl_b32 s10, s3, 2
    s_add_u32 s52, s52, s10
    v_lshlrev_b32 v192, 4, v2
    s_lshl_b32 s10, s52, 10
    v_add_u32 v193, s10, v192
    s_waitcnt lgkmcnt(0)
    s_cmp_ge_u32 s40, 128
    s_cbranch_scc1 PRE_NOLD
    global_load_dwordx4 v[212:215], v192, s[50:51]
    global_load_dwordx4 v[196:199], v193, s[8:9] offset:0
    global_load_dwordx4 v[200:203], v193, s[8:9] offset:1024
    global_load_dwordx4 v[204:207], v193, s[8:9] offset:2048
    global_load_dwordx4 v[208:211], v193, s[8:9] offset:3072
PRE_NOLD:
    v_and_b32 v144, 1, v2
    v_lshlrev_b32 v144, 4, v144
    v_mov_b32 v145, 0x3f80
    v_lshlrev_b32 v144, v144, v145
    v_lshrrev_b32 v145, 4, v2
    v_bfe_u32 v146, v2, 3, 1
    v_sub_u32 v145, v145, v146
    v_lshlrev_b32 v145, 2, v145
    v_bfe_u32 v146, v2, 1, 2
    v_add_u32 v145, v145, v146
    v_cmp_eq_u32 vcc, 0, v145
    s_nop 1
    v_cndmask_b32 v224, 0, v144, vcc
    v_cmp_eq_u32 vcc, 1, v145
    s_nop 1
    v_cndmask_b32 v225, 0, v144, vcc
    v_cmp_eq_u32 vcc, 2, v145
    s_nop 1
    v_cndmask_b32 v226, 0, v144, vcc
    v_cmp_eq_u32 vcc, 3, v145
    s_nop 1
    v_cndmask_b32 v227, 0, v144, vcc
    v_cmp_eq_u32 vcc, 8, v145
    s_nop 1
    v_cndmask_b32 v228, 0, v144, vcc
    v_cmp_eq_u32 vcc, 9, v145
    s_nop 1
    v_cndmask_b32 v229, 0, v144, vcc
    v_cmp_eq_u32 vcc, 10, v145
    s_nop 1
    v_cndmask_b32 v230, 0, v144, vcc
    v_cmp_eq_u32 vcc, 11, v145
    s_nop 1
    v_cndmask_b32 v231, 0, v144, vcc
    s_load_dwordx2 s[28:29], s[0:1], 104
    s_mov_b32 s53, 2
    s_mov_b32 s55, 0
    s_lshr_b32 s42, s2, 3
    s_and_b32 s43, s2, 7
    s_sub_u32 s43, s43, 1
WK_GEMM:
    s_cmp_ge_u32 s42, 120
    s_cbranch_scc1 WK_GEMM_DONE
    s_cmp_ge_u32 s42, 80
    s_cbranch_scc1 WK_GEMM_Q
    s_mul_i32 s10, s42, 205
    s_lshr_b32 s10, s10, 11
    s_mul_i32 s11, s10, 10
    s_sub_u32 s11, s42, s11
    s_mul_i32 s11, s11, 7
    s_add_u32 s11, s11, s43
    s_cmp_ge_u32 s11, 64
    s_cbranch_scc1 WK_GEMM_NEXT
    s_add_u32 s11, s11, 32
    s_branch WK_GEMM_GO
WK_GEMM_Q:
    s_sub_u32 s11, s42, 80
    s_mul_i32 s10, s11, 205
    s_lshr_b32 s10, s10, 10
    s_mul_i32 s15, s10, 5
    s_sub_u32 s11, s11, s15
    s_mul_i32 s11, s11, 7
    s_sub_u32 s15, 6, s43
    s_add_u32 s11, s11, s15
    s_cmp_ge_u32 s11, 32
    s_cbranch_scc1 WK_GEMM_NEXT
WK_GEMM_GO:
    s_lshr_b32 s13, s11, 5
    s_and_b32 s14, s11, 31
    s_lshl_b32 s12, s13, 3
    s_add_u32 s12, s12, 16
    s_load_dwordx2 s[6:7], s[0:1], s12
    v_bfe_u32 v4, v2, 2, 2
    v_lshlrev_b32 v4, 3, v4
    v_and_b32 v5, 3, v2
    v_add_u32 v4, v4, v5
    v_lshlrev_b32 v4, 13, v4
    v_lshrrev_b32 v5, 4, v2
    v_lshlrev_b32 v5, 4, v5
    v_add_u32 v4, v4, v5
    v_add_u32 v5, 32768, v4
    s_lshl_b32 s15, s14, 8
    s_lshl_b32 s16, s3, 20
    s_add_u32 s15, s15, s16
    s_waitcnt lgkmcnt(0)
    s_add_u32 s6, s6, s15
    s_addc_u32 s7, s7, 0
    s_cmp_lg_u32 s53, 2
    s_cbranch_scc1 WK_NOPRE
    s_mov_b32 s54, s10
    s_cmp_ge_u32 s40, 128
    s_cbranch_scc1 WK_PRE_I
    global_load_dwordx4 v[16:19], v4, s[6:7] offset:0
    global_load_dwordx4 v[20:23], v5, s[6:7] offset:0
    global_load_dwordx4 v[24:27], v4, s[6:7] offset:64
    global_load_dwordx4 v[28:31], v5, s[6:7] offset:64
    global_load_dwordx4 v[32:35], v4, s[6:7] offset:128
    global_load_dwordx4 v[36:39], v5, s[6:7] offset:128
    global_load_dwordx4 v[40:43], v4, s[6:7] offset:192
    global_load_dwordx4 v[44:47], v5, s[6:7] offset:192
    s_add_u32 s6, s6, 262144
    s_addc_u32 s7, s7, 0
    global_load_dwordx4 v[48:51], v4, s[6:7] offset:0
    global_load_dwordx4 v[52:55], v5, s[6:7] offset:0
    global_load_dwordx4 v[56:59], v4, s[6:7] offset:64
    global_load_dwordx4 v[60:63], v5, s[6:7] offset:64
    global_load_dwordx4 v[64:67], v4, s[6:7] offset:128
    global_load_dwordx4 v[68:71], v5, s[6:7] offset:128
    global_load_dwordx4 v[72:75], v4, s[6:7] offset:192
    global_load_dwordx4 v[76:79], v5, s[6:7] offset:192
    s_add_u32 s6, s6, 262144
    s_addc_u32 s7, s7, 0
    v_lshrrev_b32 v181, 2, v2
    v_lshlrev_b32 v181, 10, v181
    v_and_b32 v182, 3, v2
    v_lshlrev_b32 v182, 8, v182
    v_add_u32 v181, v181, v182
    s_lshl_b32 s10, s3, 6
    s_add_u32 s10, s10, 131072
    v_add_u32 v181, s10, v181
    s_add_u32 s10, s52, 0
    s_waitcnt vmcnt(16)
    v_mov_b32 v152, v196
    v_mov_b32 v156, v212
    v_mov_b32 v153, v197
    v_mov_b32 v157, v213
    v_mov_b32 v154, v198
    v_mov_b32 v158, v214
    v_mov_b32 v155, v199
    v_mov_b32 v159, v215
    v_add_u32 v148, 0, v193
    v_lshlrev_b32 v160, 16, v152
    v_and_b32 v161, 0xffff0000, v152
    v_lshlrev_b32 v168, 16, v156
    v_and_b32 v169, 0xffff0000, v156
    v_lshlrev_b32 v162, 16, v153
    v_and_b32 v163, 0xffff0000, v153
    v_lshlrev_b32 v170, 16, v157
    v_and_b32 v171, 0xffff0000, v157
    v_lshlrev_b32 v164, 16, v154
    v_and_b32 v165, 0xffff0000, v154
    v_lshlrev_b32 v172, 16, v158
    v_and_b32 v173, 0xffff0000, v158
    v_lshlrev_b32 v166, 16, v155
    v_and_b32 v167, 0xffff0000, v155
    v_lshlrev_b32 v174, 16, v159
    v_and_b32 v175, 0xffff0000, v159
    v_add_f32 v176, v160, v161
    v_add_f32 v176, v176, v162
    v_add_f32 v176, v176, v163
    v_add_f32 v176, v176, v164
    v_add_f32 v176, v176, v165
    v_add_f32 v176, v176, v166
    v_add_f32 v176, v176, v167
    s_nop 1
    v_add_f32_dpp v176, v176, v176 quad_perm:[1,0,3,2] row_mask:0xf bank_mask:0xf
    s_nop 1
    v_add_f32_dpp v176, v176, v176 quad_perm:[2,3,0,1] row_mask:0xf bank_mask:0xf
    s_nop 1
    v_add_f32_dpp v176, v176, v176 row_half_mirror row_mask:0xf bank_mask:0xf
    s_nop 1
    v_add_f32_dpp v176, v176, v176 row_mirror row_mask:0xf bank_mask:0xf
    v_mov_b32 v177, v176
    s_nop 1
    v_permlane16_swap_b32 v176, v177
    s_nop 1
    v_add_f32 v176, v176, v177
    v_mov_b32 v177, v176
    s_nop 1
    v_permlane32_swap_b32 v176, v177
    s_nop 1
    v_add_f32 v176, v176, v177
    v_mul_f32 v176, 0x3b000000, v176
    v_sub_f32 v178, v160, v176
    v_mul_f32 v179, v178, v178
    v_sub_f32 v178, v161, v176
    v_fmac_f32 v179, v178, v178
    v_sub_f32 v178, v162, v176
    v_fmac_f32 v179, v178, v178
    v_sub_f32 v178, v163, v176
    v_fmac_f32 v179, v178, v178
    v_sub_f32 v178, v164, v176
    v_fmac_f32 v179, v178, v178
    v_sub_f32 v178, v165, v176
    v_fmac_f32 v179, v178, v178
    v_sub_f32 v178, v166, v176
    v_fmac_f32 v179, v178, v178
    v_sub_f32 v178, v167, v176
    v_fmac_f32 v179, v178, v178
    s_nop 1
    v_add_f32_dpp v179, v179, v179 quad_perm:[1,0,3,2] row_mask:0xf bank_mask:0xf
    s_nop 1
    v_add_f32_dpp v179, v179, v179 quad_perm:[2,3,0,1] row_mask:0xf bank_mask:0xf
    s_nop 1
    v_add_f32_dpp v179, v179, v179 row_half_mirror row_mask:0xf bank_mask:0xf
    s_nop 1
    v_add_f32_dpp v179, v179, v179 row_mirror row_mask:0xf bank_mask:0xf
    v_mov_b32 v177, v179
    s_nop 1
    v_permlane16_swap_b32 v179, v177
    s_nop 1
    v_add_f32 v179, v179, v177
    v_mov_b32 v177, v179
    s_nop 1
    v_permlane32_swap_b32 v179, v177
    s_nop 1
    v_add_f32 v179, v179, v177
    v_mul_f32 v179, 0x3b000000, v179
    v_cvt_pk_bf16_f32 v179, v179, v179
    v_lshlrev_b32 v179, 16, v179
    v_add_f32 v179, 0x3727c5ac, v179
    v_cvt_pk_bf16_f32 v179, v179, v179
    v_lshlrev_b32 v179, 16, v179
    v_sqrt_f32 v179, v179
    s_nop 0
    v_cvt_pk_bf16_f32 v179, v179, v179
    v_lshlrev_b32 v179, 16, v179
    v_rcp_f32 v179, v179
    v_cvt_pk_bf16_f32 v176, v176, v176
    v_lshlrev_b32 v176, 16, v176
    v_sub_f32 v160, v160, v176
    v_sub_f32 v161, v161, v176
    v_sub_f32 v162, v162, v176
    v_sub_f32 v163, v163, v176
    v_sub_f32 v164, v164, v176
    v_sub_f32 v165, v165, v176
    v_sub_f32 v166, v166, v176
    v_sub_f32 v167, v167, v176
    v_cvt_pk_bf16_f32 v152, v160, v161
    v_cvt_pk_bf16_f32 v153, v162, v163
    v_cvt_pk_bf16_f32 v154, v164, v165
    v_cvt_pk_bf16_f32 v155, v166, v167
    v_lshlrev_b32 v160, 16, v152
    v_and_b32 v161, 0xffff0000, v152
    v_lshlrev_b32 v162, 16, v153
    v_and_b32 v163, 0xffff0000, v153
    v_lshlrev_b32 v164, 16, v154
    v_and_b32 v165, 0xffff0000, v154
    v_lshlrev_b32 v166, 16, v155
    v_and_b32 v167, 0xffff0000, v155
    v_mul_f32 v160, v160, v179
    v_mul_f32 v161, v161, v179
    v_mul_f32 v162, v162, v179
    v_mul_f32 v163, v163, v179
    v_mul_f32 v164, v164, v179
    v_mul_f32 v165, v165, v179
    v_mul_f32 v166, v166, v179
    v_mul_f32 v167, v167, v179
    v_cvt_pk_bf16_f32 v152, v160, v161
    v_cvt_pk_bf16_f32 v153, v162, v163
    v_cvt_pk_bf16_f32 v154, v164, v165
    v_cvt_pk_bf16_f32 v155, v166, v167
    v_lshlrev_b32 v160, 16, v152
    v_and_b32 v161, 0xffff0000, v152
    v_lshlrev_b32 v162, 16, v153
    v_and_b32 v163, 0xffff0000, v153
    v_lshlrev_b32 v164, 16, v154
    v_and_b32 v165, 0xffff0000, v154
    v_lshlrev_b32 v166, 16, v155
    v_and_b32 v167, 0xffff0000, v155
    v_mul_f32 v180, v160, v168
    v_fmac_f32 v180, v161, v169
    v_fmac_f32 v180, v162, v170
    v_fmac_f32 v180, v163, v171
    v_fmac_f32 v180, v164, v172
    v_fmac_f32 v180, v165, v173
    v_fmac_f32 v180, v166, v174
    v_fmac_f32 v180, v167, v175
    s_nop 1
    v_add_f32_dpp v180, v180, v180 quad_perm:[1,0,3,2] row_mask:0xf bank_mask:0xf
    s_nop 1
    v_add_f32_dpp v180, v180, v180 quad_perm:[2,3,0,1] row_mask:0xf bank_mask:0xf
    s_nop 1
    v_add_f32_dpp v180, v180, v180 row_half_mirror row_mask:0xf bank_mask:0xf
    s_nop 1
    v_add_f32_dpp v180, v180, v180 row_mirror row_mask:0xf bank_mask:0xf
    v_mov_b32 v177, v180
    s_nop 1
    v_permlane16_swap_b32 v180, v177
    s_nop 1
    v_add_f32 v180, v180, v177
    v_mov_b32 v177, v180
    s_nop 1
    v_permlane32_swap_b32 v180, v177
    s_nop 1
    v_add_f32 v180, v180, v177
    v_cvt_pk_bf16_f32 v180, v180, v180
    v_lshlrev_b32 v180, 16, v180
    v_add_u32 v149, 0, v148
    global_store_dwordx4 v149, v[152:155], s[4:5] sc1
    ds_write_b128 v181, v[152:155]
    s_lshl_b32 s12, s10, 2
    s_add_u32 s12, s12, 4194304
    v_mov_b32 v149, s12
    s_mov_b64 exec, 1
    global_store_dword v149, v180, s[4:5] sc1
    s_mov_b64 exec, -1
    s_add_u32 s10, s52, 1
    v_mov_b32 v152, v200
    v_mov_b32 v156, v212
    v_mov_b32 v153, v201
    v_mov_b32 v157, v213
    v_mov_b32 v154, v202
    v_mov_b32 v158, v214
    v_mov_b32 v155, v203
    v_mov_b32 v159, v215
    v_add_u32 v148, 1024, v193
    v_add_u32 v181, 16, v181
    v_lshlrev_b32 v160, 16, v152
    v_and_b32 v161, 0xffff0000, v152
    v_lshlrev_b32 v168, 16, v156
    v_and_b32 v169, 0xffff0000, v156
    v_lshlrev_b32 v162, 16, v153
    v_and_b32 v163, 0xffff0000, v153
    v_lshlrev_b32 v170, 16, v157
    v_and_b32 v171, 0xffff0000, v157
    v_lshlrev_b32 v164, 16, v154
    v_and_b32 v165, 0xffff0000, v154
    v_lshlrev_b32 v172, 16, v158
    v_and_b32 v173, 0xffff0000, v158
    v_lshlrev_b32 v166, 16, v155
    v_and_b32 v167, 0xffff0000, v155
    v_lshlrev_b32 v174, 16, v159
    v_and_b32 v175, 0xffff0000, v159
    v_add_f32 v176, v160, v161
    v_add_f32 v176, v176, v162
    v_add_f32 v176, v176, v163
    v_add_f32 v176, v176, v164
    v_add_f32 v176, v176, v165
    v_add_f32 v176, v176, v166
    v_add_f32 v176, v176, v167
    s_nop 1
    v_add_f32_dpp v176, v176, v176 quad_perm:[1,0,3,2] row_mask:0xf bank_mask:0xf
    s_nop 1
    v_add_f32_dpp v176, v176, v176 quad_perm:[2,3,0,1] row_mask:0xf bank_mask:0xf
    s_nop 1
    v_add_f32_dpp v176, v176, v176 row_half_mirror row_mask:0xf bank_mask:0xf
    s_nop 1
    v_add_f32_dpp v176, v176, v176 row_mirror row_mask:0xf bank_mask:0xf
    v_mov_b32 v177, v176
    s_nop 1
    v_permlane16_swap_b32 v176, v177
    s_nop 1
    v_add_f32 v176, v176, v177
    v_mov_b32 v177, v176
    s_nop 1
    v_permlane32_swap_b32 v176, v177
    s_nop 1
    v_add_f32 v176, v176, v177
    v_mul_f32 v176, 0x3b000000, v176
    v_sub_f32 v178, v160, v176
    v_mul_f32 v179, v178, v178
    v_sub_f32 v178, v161, v176
    v_fmac_f32 v179, v178, v178
    v_sub_f32 v178, v162, v176
    v_fmac_f32 v179, v178, v178
    v_sub_f32 v178, v163, v176
    v_fmac_f32 v179, v178, v178
    v_sub_f32 v178, v164, v176
    v_fmac_f32 v179, v178, v178
    v_sub_f32 v178, v165, v176
    v_fmac_f32 v179, v178, v178
    v_sub_f32 v178, v166, v176
    v_fmac_f32 v179, v178, v178
    v_sub_f32 v178, v167, v176
    v_fmac_f32 v179, v178, v178
    s_nop 1
    v_add_f32_dpp v179, v179, v179 quad_perm:[1,0,3,2] row_mask:0xf bank_mask:0xf
    s_nop 1
    v_add_f32_dpp v179, v179, v179 quad_perm:[2,3,0,1] row_mask:0xf bank_mask:0xf
    s_nop 1
    v_add_f32_dpp v179, v179, v179 row_half_mirror row_mask:0xf bank_mask:0xf
    s_nop 1
    v_add_f32_dpp v179, v179, v179 row_mirror row_mask:0xf bank_mask:0xf
    v_mov_b32 v177, v179
    s_nop 1
    v_permlane16_swap_b32 v179, v177
    s_nop 1
    v_add_f32 v179, v179, v177
    v_mov_b32 v177, v179
    s_nop 1
    v_permlane32_swap_b32 v179, v177
    s_nop 1
    v_add_f32 v179, v179, v177
    v_mul_f32 v179, 0x3b000000, v179
    v_cvt_pk_bf16_f32 v179, v179, v179
    v_lshlrev_b32 v179, 16, v179
    v_add_f32 v179, 0x3727c5ac, v179
    v_cvt_pk_bf16_f32 v179, v179, v179
    v_lshlrev_b32 v179, 16, v179
    v_sqrt_f32 v179, v179
    s_nop 0
    v_cvt_pk_bf16_f32 v179, v179, v179
    v_lshlrev_b32 v179, 16, v179
    v_rcp_f32 v179, v179
    v_cvt_pk_bf16_f32 v176, v176, v176
    v_lshlrev_b32 v176, 16, v176
    v_sub_f32 v160, v160, v176
    v_sub_f32 v161, v161, v176
    v_sub_f32 v162, v162, v176
    v_sub_f32 v163, v163, v176
    v_sub_f32 v164, v164, v176
    v_sub_f32 v165, v165, v176
    v_sub_f32 v166, v166, v176
    v_sub_f32 v167, v167, v176
    v_cvt_pk_bf16_f32 v152, v160, v161
    v_cvt_pk_bf16_f32 v153, v162, v163
    v_cvt_pk_bf16_f32 v154, v164, v165
    v_cvt_pk_bf16_f32 v155, v166, v167
    v_lshlrev_b32 v160, 16, v152
    v_and_b32 v161, 0xffff0000, v152
    v_lshlrev_b32 v162, 16, v153
    v_and_b32 v163, 0xffff0000, v153
    v_lshlrev_b32 v164, 16, v154
    v_and_b32 v165, 0xffff0000, v154
    v_lshlrev_b32 v166, 16, v155
    v_and_b32 v167, 0xffff0000, v155
    v_mul_f32 v160, v160, v179
    v_mul_f32 v161, v161, v179
    v_mul_f32 v162, v162, v179
    v_mul_f32 v163, v163, v179
    v_mul_f32 v164, v164, v179
    v_mul_f32 v165, v165, v179
    v_mul_f32 v166, v166, v179
    v_mul_f32 v167, v167, v179
    v_cvt_pk_bf16_f32 v152, v160, v161
    v_cvt_pk_bf16_f32 v153, v162, v163
    v_cvt_pk_bf16_f32 v154, v164, v165
    v_cvt_pk_bf16_f32 v155, v166, v167
    v_lshlrev_b32 v160, 16, v152
    v_and_b32 v161, 0xffff0000, v152
    v_lshlrev_b32 v162, 16, v153
    v_and_b32 v163, 0xffff0000, v153
    v_lshlrev_b32 v164, 16, v154
    v_and_b32 v165, 0xffff0000, v154
    v_lshlrev_b32 v166, 16, v155
    v_and_b32 v167, 0xffff0000, v155
    v_mul_f32 v180, v160, v168
    v_fmac_f32 v180, v161, v169
    v_fmac_f32 v180, v162, v170
    v_fmac_f32 v180, v163, v171
    v_fmac_f32 v180, v164, v172
    v_fmac_f32 v180, v165, v173
    v_fmac_f32 v180, v166, v174
    v_fmac_f32 v180, v167, v175
    s_nop 1
    v_add_f32_dpp v180, v180, v180 quad_perm:[1,0,3,2] row_mask:0xf bank_mask:0xf
    s_nop 1
    v_add_f32_dpp v180, v180, v180 quad_perm:[2,3,0,1] row_mask:0xf bank_mask:0xf
    s_nop 1
    v_add_f32_dpp v180, v180, v180 row_half_mirror row_mask:0xf bank_mask:0xf
    s_nop 1
    v_add_f32_dpp v180, v180, v180 row_mirror row_mask:0xf bank_mask:0xf
    v_mov_b32 v177, v180
    s_nop 1
    v_permlane16_swap_b32 v180, v177
    s_nop 1
    v_add_f32 v180, v180, v177
    v_mov_b32 v177, v180
    s_nop 1
    v_permlane32_swap_b32 v180, v177
    s_nop 1
    v_add_f32 v180, v180, v177
    v_cvt_pk_bf16_f32 v180, v180, v180
    v_lshlrev_b32 v180, 16, v180
    v_add_u32 v149, 0, v148
    global_store_dwordx4 v149, v[152:155], s[4:5] sc1
    ds_write_b128 v181, v[152:155]
    s_lshl_b32 s12, s10, 2
    s_add_u32 s12, s12, 4194304
    v_mov_b32 v149, s12
    s_mov_b64 exec, 1
    global_store_dword v149, v180, s[4:5] sc1
    s_mov_b64 exec, -1
    s_add_u32 s10, s52, 2
    v_mov_b32 v152, v204
    v_mov_b32 v156, v212
    v_mov_b32 v153, v205
    v_mov_b32 v157, v213
    v_mov_b32 v154, v206
    v_mov_b32 v158, v214
    v_mov_b32 v155, v207
    v_mov_b32 v159, v215
    v_add_u32 v148, 2048, v193
    v_add_u32 v181, 16, v181
    v_lshlrev_b32 v160, 16, v152
    v_and_b32 v161, 0xffff0000, v152
    v_lshlrev_b32 v168, 16, v156
    v_and_b32 v169, 0xffff0000, v156
    v_lshlrev_b32 v162, 16, v153
    v_and_b32 v163, 0xffff0000, v153
    v_lshlrev_b32 v170, 16, v157
    v_and_b32 v171, 0xffff0000, v157
    v_lshlrev_b32 v164, 16, v154
    v_and_b32 v165, 0xffff0000, v154
    v_lshlrev_b32 v172, 16, v158
    v_and_b32 v173, 0xffff0000, v158
    v_lshlrev_b32 v166, 16, v155
    v_and_b32 v167, 0xffff0000, v155
    v_lshlrev_b32 v174, 16, v159
    v_and_b32 v175, 0xffff0000, v159
    v_add_f32 v176, v160, v161
    v_add_f32 v176, v176, v162
    v_add_f32 v176, v176, v163
    v_add_f32 v176, v176, v164
    v_add_f32 v176, v176, v165
    v_add_f32 v176, v176, v166
    v_add_f32 v176, v176, v167
    s_nop 1
    v_add_f32_dpp v176, v176, v176 quad_perm:[1,0,3,2] row_mask:0xf bank_mask:0xf
    s_nop 1
    v_add_f32_dpp v176, v176, v176 quad_perm:[2,3,0,1] row_mask:0xf bank_mask:0xf
    s_nop 1
    v_add_f32_dpp v176, v176, v176 row_half_mirror row_mask:0xf bank_mask:0xf
    s_nop 1
    v_add_f32_dpp v176, v176, v176 row_mirror row_mask:0xf bank_mask:0xf
    v_mov_b32 v177, v176
    s_nop 1
    v_permlane16_swap_b32 v176, v177
    s_nop 1
    v_add_f32 v176, v176, v177
    v_mov_b32 v177, v176
    s_nop 1
    v_permlane32_swap_b32 v176, v177
    s_nop 1
    v_add_f32 v176, v176, v177
    v_mul_f32 v176, 0x3b000000, v176
    v_sub_f32 v178, v160, v176
    v_mul_f32 v179, v178, v178
    v_sub_f32 v178, v161, v176
    v_fmac_f32 v179, v178, v178
    v_sub_f32 v178, v162, v176
    v_fmac_f32 v179, v178, v178
    v_sub_f32 v178, v163, v176
    v_fmac_f32 v179, v178, v178
    v_sub_f32 v178, v164, v176
    v_fmac_f32 v179, v178, v178
    v_sub_f32 v178, v165, v176
    v_fmac_f32 v179, v178, v178
    v_sub_f32 v178, v166, v176
    v_fmac_f32 v179, v178, v178
    v_sub_f32 v178, v167, v176
    v_fmac_f32 v179, v178, v178
    s_nop 1
    v_add_f32_dpp v179, v179, v179 quad_perm:[1,0,3,2] row_mask:0xf bank_mask:0xf
    s_nop 1
    v_add_f32_dpp v179, v179, v179 quad_perm:[2,3,0,1] row_mask:0xf bank_mask:0xf
    s_nop 1
    v_add_f32_dpp v179, v179, v179 row_half_mirror row_mask:0xf bank_mask:0xf
    s_nop 1
    v_add_f32_dpp v179, v179, v179 row_mirror row_mask:0xf bank_mask:0xf
    v_mov_b32 v177, v179
    s_nop 1
    v_permlane16_swap_b32 v179, v177
    s_nop 1
    v_add_f32 v179, v179, v177
    v_mov_b32 v177, v179
    s_nop 1
    v_permlane32_swap_b32 v179, v177
    s_nop 1
    v_add_f32 v179, v179, v177
    v_mul_f32 v179, 0x3b000000, v179
    v_cvt_pk_bf16_f32 v179, v179, v179
    v_lshlrev_b32 v179, 16, v179
    v_add_f32 v179, 0x3727c5ac, v179
    v_cvt_pk_bf16_f32 v179, v179, v179
    v_lshlrev_b32 v179, 16, v179
    v_sqrt_f32 v179, v179
    s_nop 0
    v_cvt_pk_bf16_f32 v179, v179, v179
    v_lshlrev_b32 v179, 16, v179
    v_rcp_f32 v179, v179
    v_cvt_pk_bf16_f32 v176, v176, v176
    v_lshlrev_b32 v176, 16, v176
    v_sub_f32 v160, v160, v176
    v_sub_f32 v161, v161, v176
    v_sub_f32 v162, v162, v176
    v_sub_f32 v163, v163, v176
    v_sub_f32 v164, v164, v176
    v_sub_f32 v165, v165, v176
    v_sub_f32 v166, v166, v176
    v_sub_f32 v167, v167, v176
    v_cvt_pk_bf16_f32 v152, v160, v161
    v_cvt_pk_bf16_f32 v153, v162, v163
    v_cvt_pk_bf16_f32 v154, v164, v165
    v_cvt_pk_bf16_f32 v155, v166, v167
    v_lshlrev_b32 v160, 16, v152
    v_and_b32 v161, 0xffff0000, v152
    v_lshlrev_b32 v162, 16, v153
    v_and_b32 v163, 0xffff0000, v153
    v_lshlrev_b32 v164, 16, v154
    v_and_b32 v165, 0xffff0000, v154
    v_lshlrev_b32 v166, 16, v155
    v_and_b32 v167, 0xffff0000, v155
    v_mul_f32 v160, v160, v179
    v_mul_f32 v161, v161, v179
    v_mul_f32 v162, v162, v179
    v_mul_f32 v163, v163, v179
    v_mul_f32 v164, v164, v179
    v_mul_f32 v165, v165, v179
    v_mul_f32 v166, v166, v179
    v_mul_f32 v167, v167, v179
    v_cvt_pk_bf16_f32 v152, v160, v161
    v_cvt_pk_bf16_f32 v153, v162, v163
    v_cvt_pk_bf16_f32 v154, v164, v165
    v_cvt_pk_bf16_f32 v155, v166, v167
    v_lshlrev_b32 v160, 16, v152
    v_and_b32 v161, 0xffff0000, v152
    v_lshlrev_b32 v162, 16, v153
    v_and_b32 v163, 0xffff0000, v153
    v_lshlrev_b32 v164, 16, v154
    v_and_b32 v165, 0xffff0000, v154
    v_lshlrev_b32 v166, 16, v155
    v_and_b32 v167, 0xffff0000, v155
    v_mul_f32 v180, v160, v168
    v_fmac_f32 v180, v161, v169
    v_fmac_f32 v180, v162, v170
    v_fmac_f32 v180, v163, v171
    v_fmac_f32 v180, v164, v172
    v_fmac_f32 v180, v165, v173
    v_fmac_f32 v180, v166, v174
    v_fmac_f32 v180, v167, v175
    s_nop 1
    v_add_f32_dpp v180, v180, v180 quad_perm:[1,0,3,2] row_mask:0xf bank_mask:0xf
    s_nop 1
    v_add_f32_dpp v180, v180, v180 quad_perm:[2,3,0,1] row_mask:0xf bank_mask:0xf
    s_nop 1
    v_add_f32_dpp v180, v180, v180 row_half_mirror row_mask:0xf bank_mask:0xf
    s_nop 1
    v_add_f32_dpp v180, v180, v180 row_mirror row_mask:0xf bank_mask:0xf
    v_mov_b32 v177, v180
    s_nop 1
    v_permlane16_swap_b32 v180, v177
    s_nop 1
    v_add_f32 v180, v180, v177
    v_mov_b32 v177, v180
    s_nop 1
    v_permlane32_swap_b32 v180, v177
    s_nop 1
    v_add_f32 v180, v180, v177
    v_cvt_pk_bf16_f32 v180, v180, v180
    v_lshlrev_b32 v180, 16, v180
    v_add_u32 v149, 0, v148
    global_store_dwordx4 v149, v[152:155], s[4:5] sc1
    ds_write_b128 v181, v[152:155]
    s_lshl_b32 s12, s10, 2
    s_add_u32 s12, s12, 4194304
    v_mov_b32 v149, s12
    s_mov_b64 exec, 1
    global_store_dword v149, v180, s[4:5] sc1
    s_mov_b64 exec, -1
    s_add_u32 s10, s52, 3
    v_mov_b32 v152, v208
    v_mov_b32 v156, v212
    v_mov_b32 v153, v209
    v_mov_b32 v157, v213
    v_mov_b32 v154, v210
    v_mov_b32 v158, v214
    v_mov_b32 v155, v211
    v_mov_b32 v159, v215
    v_add_u32 v148, 3072, v193
    v_add_u32 v181, 16, v181
    v_lshlrev_b32 v160, 16, v152
    v_and_b32 v161, 0xffff0000, v152
    v_lshlrev_b32 v168, 16, v156
    v_and_b32 v169, 0xffff0000, v156
    v_lshlrev_b32 v162, 16, v153
    v_and_b32 v163, 0xffff0000, v153
    v_lshlrev_b32 v170, 16, v157
    v_and_b32 v171, 0xffff0000, v157
    v_lshlrev_b32 v164, 16, v154
    v_and_b32 v165, 0xffff0000, v154
    v_lshlrev_b32 v172, 16, v158
    v_and_b32 v173, 0xffff0000, v158
    v_lshlrev_b32 v166, 16, v155
    v_and_b32 v167, 0xffff0000, v155
    v_lshlrev_b32 v174, 16, v159
    v_and_b32 v175, 0xffff0000, v159
    v_add_f32 v176, v160, v161
    v_add_f32 v176, v176, v162
    v_add_f32 v176, v176, v163
    v_add_f32 v176, v176, v164
    v_add_f32 v176, v176, v165
    v_add_f32 v176, v176, v166
    v_add_f32 v176, v176, v167
    s_nop 1
    v_add_f32_dpp v176, v176, v176 quad_perm:[1,0,3,2] row_mask:0xf bank_mask:0xf
    s_nop 1
    v_add_f32_dpp v176, v176, v176 quad_perm:[2,3,0,1] row_mask:0xf bank_mask:0xf
    s_nop 1
    v_add_f32_dpp v176, v176, v176 row_half_mirror row_mask:0xf bank_mask:0xf
    s_nop 1
    v_add_f32_dpp v176, v176, v176 row_mirror row_mask:0xf bank_mask:0xf
    v_mov_b32 v177, v176
    s_nop 1
    v_permlane16_swap_b32 v176, v177
    s_nop 1
    v_add_f32 v176, v176, v177
    v_mov_b32 v177, v176
    s_nop 1
    v_permlane32_swap_b32 v176, v177
    s_nop 1
    v_add_f32 v176, v176, v177
    v_mul_f32 v176, 0x3b000000, v176
    v_sub_f32 v178, v160, v176
    v_mul_f32 v179, v178, v178
    v_sub_f32 v178, v161, v176
    v_fmac_f32 v179, v178, v178
    v_sub_f32 v178, v162, v176
    v_fmac_f32 v179, v178, v178
    v_sub_f32 v178, v163, v176
    v_fmac_f32 v179, v178, v178
    v_sub_f32 v178, v164, v176
    v_fmac_f32 v179, v178, v178
    v_sub_f32 v178, v165, v176
    v_fmac_f32 v179, v178, v178
    v_sub_f32 v178, v166, v176
    v_fmac_f32 v179, v178, v178
    v_sub_f32 v178, v167, v176
    v_fmac_f32 v179, v178, v178
    s_nop 1
    v_add_f32_dpp v179, v179, v179 quad_perm:[1,0,3,2] row_mask:0xf bank_mask:0xf
    s_nop 1
    v_add_f32_dpp v179, v179, v179 quad_perm:[2,3,0,1] row_mask:0xf bank_mask:0xf
    s_nop 1
    v_add_f32_dpp v179, v179, v179 row_half_mirror row_mask:0xf bank_mask:0xf
    s_nop 1
    v_add_f32_dpp v179, v179, v179 row_mirror row_mask:0xf bank_mask:0xf
    v_mov_b32 v177, v179
    s_nop 1
    v_permlane16_swap_b32 v179, v177
    s_nop 1
    v_add_f32 v179, v179, v177
    v_mov_b32 v177, v179
    s_nop 1
    v_permlane32_swap_b32 v179, v177
    s_nop 1
    v_add_f32 v179, v179, v177
    v_mul_f32 v179, 0x3b000000, v179
    v_cvt_pk_bf16_f32 v179, v179, v179
    v_lshlrev_b32 v179, 16, v179
    v_add_f32 v179, 0x3727c5ac, v179
    v_cvt_pk_bf16_f32 v179, v179, v179
    v_lshlrev_b32 v179, 16, v179
    v_sqrt_f32 v179, v179
    s_nop 0
    v_cvt_pk_bf16_f32 v179, v179, v179
    v_lshlrev_b32 v179, 16, v179
    v_rcp_f32 v179, v179
    v_cvt_pk_bf16_f32 v176, v176, v176
    v_lshlrev_b32 v176, 16, v176
    v_sub_f32 v160, v160, v176
    v_sub_f32 v161, v161, v176
    v_sub_f32 v162, v162, v176
    v_sub_f32 v163, v163, v176
    v_sub_f32 v164, v164, v176
    v_sub_f32 v165, v165, v176
    v_sub_f32 v166, v166, v176
    v_sub_f32 v167, v167, v176
    v_cvt_pk_bf16_f32 v152, v160, v161
    v_cvt_pk_bf16_f32 v153, v162, v163
    v_cvt_pk_bf16_f32 v154, v164, v165
    v_cvt_pk_bf16_f32 v155, v166, v167
    v_lshlrev_b32 v160, 16, v152
    v_and_b32 v161, 0xffff0000, v152
    v_lshlrev_b32 v162, 16, v153
    v_and_b32 v163, 0xffff0000, v153
    v_lshlrev_b32 v164, 16, v154
    v_and_b32 v165, 0xffff0000, v154
    v_lshlrev_b32 v166, 16, v155
    v_and_b32 v167, 0xffff0000, v155
    v_mul_f32 v160, v160, v179
    v_mul_f32 v161, v161, v179
    v_mul_f32 v162, v162, v179
    v_mul_f32 v163, v163, v179
    v_mul_f32 v164, v164, v179
    v_mul_f32 v165, v165, v179
    v_mul_f32 v166, v166, v179
    v_mul_f32 v167, v167, v179
    v_cvt_pk_bf16_f32 v152, v160, v161
    v_cvt_pk_bf16_f32 v153, v162, v163
    v_cvt_pk_bf16_f32 v154, v164, v165
    v_cvt_pk_bf16_f32 v155, v166, v167
    v_lshlrev_b32 v160, 16, v152
    v_and_b32 v161, 0xffff0000, v152
    v_lshlrev_b32 v162, 16, v153
    v_and_b32 v163, 0xffff0000, v153
    v_lshlrev_b32 v164, 16, v154
    v_and_b32 v165, 0xffff0000, v154
    v_lshlrev_b32 v166, 16, v155
    v_and_b32 v167, 0xffff0000, v155
    v_mul_f32 v180, v160, v168
    v_fmac_f32 v180, v161, v169
    v_fmac_f32 v180, v162, v170
    v_fmac_f32 v180, v163, v171
    v_fmac_f32 v180, v164, v172
    v_fmac_f32 v180, v165, v173
    v_fmac_f32 v180, v166, v174
    v_fmac_f32 v180, v167, v175
    s_nop 1
    v_add_f32_dpp v180, v180, v180 quad_perm:[1,0,3,2] row_mask:0xf bank_mask:0xf
    s_nop 1
    v_add_f32_dpp v180, v180, v180 quad_perm:[2,3,0,1] row_mask:0xf bank_mask:0xf
    s_nop 1
    v_add_f32_dpp v180, v180, v180 row_half_mirror row_mask:0xf bank_mask:0xf
    s_nop 1
    v_add_f32_dpp v180, v180, v180 row_mirror row_mask:0xf bank_mask:0xf
    v_mov_b32 v177, v180
    s_nop 1
    v_permlane16_swap_b32 v180, v177
    s_nop 1
    v_add_f32 v180, v180, v177
    v_mov_b32 v177, v180
    s_nop 1
    v_permlane32_swap_b32 v180, v177
    s_nop 1
    v_add_f32 v180, v180, v177
    v_cvt_pk_bf16_f32 v180, v180, v180
    v_lshlrev_b32 v180, 16, v180
    v_add_u32 v149, 0, v148
    global_store_dwordx4 v149, v[152:155], s[4:5] sc1
    ds_write_b128 v181, v[152:155]
    s_lshl_b32 s12, s10, 2
    s_add_u32 s12, s12, 4194304
    v_mov_b32 v149, s12
    s_mov_b64 exec, 1
    global_store_dword v149, v180, s[4:5] sc1
    s_mov_b64 exec, -1
    s_waitcnt lgkmcnt(0)
    s_barrier
    s_lshl_b32 s10, s3, 12
    v_add_u32 v181, s10, v192
    v_add_u32 v182, 131072, v181
    ds_read_b128 v[196:199], v182 offset:0
    ds_read_b128 v[200:203], v182 offset:1024
    ds_read_b128 v[204:207], v182 offset:2048
    ds_read_b128 v[208:211], v182 offset:3072
    s_lshl_b32 s10, s40, 14
    s_add_u32 s10, s10, 2097152
    v_add_u32 v181, s10, v181
    s_waitcnt lgkmcnt(3)
    global_store_dwordx4 v181, v[196:199], s[4:5] offset:0 sc1
    s_waitcnt lgkmcnt(2)
    global_store_dwordx4 v181, v[200:203], s[4:5] offset:1024 sc1
    s_waitcnt lgkmcnt(1)
    global_store_dwordx4 v181, v[204:207], s[4:5] offset:2048 sc1
    s_waitcnt lgkmcnt(0)
    global_store_dwordx4 v181, v[208:211], s[4:5] offset:3072 sc1
    s_cmp_lg_u32 s3, 0
    s_cbranch_scc1 WK_PRE_N
    v_mov_b32 v184, 128
    global_load_dword v185, v184, s[28:29] sc0 sc1
WK_PRE_N:
    global_load_dwordx4 v[80:83], v4, s[6:7] offset:0
    global_load_dwordx4 v[84:87], v5, s[6:7] offset:0
    global_load_dwordx4 v[88:91], v4, s[6:7] offset:64
    global_load_dwordx4 v[92:95], v5, s[6:7] offset:64
    global_load_dwordx4 v[96:99], v4, s[6:7] offset:128
    global_load_dwordx4 v[100:103], v5, s[6:7] offset:128
    global_load_dwordx4 v[104:107], v4, s[6:7] offset:192
    global_load_dwordx4 v[108:111], v5, s[6:7] offset:192
    s_add_u32 s6, s6, 262144
    s_addc_u32 s7, s7, 0
    global_load_dwordx4 v[112:115], v4, s[6:7] offset:0
    global_load_dwordx4 v[116:119], v5, s[6:7] offset:0
    global_load_dwordx4 v[120:123], v4, s[6:7] offset:64
    global_load_dwordx4 v[124:127], v5, s[6:7] offset:64
    global_load_dwordx4 v[128:131], v4, s[6:7] offset:128
    global_load_dwordx4 v[132:135], v5, s[6:7] offset:128
    global_load_dwordx4 v[136:139], v4, s[6:7] offset:192
    global_load_dwordx4 v[140:143], v5, s[6:7] offset:192
    s_add_u32 s6, s6, 262144
    s_addc_u32 s7, s7, 0
    s_waitcnt vmcnt(16)
    s_cmp_lg_u32 s3, 0
    s_cbranch_scc1 WK_NB1_B
WK_NB1_L:
    v_readfirstlane_b32 s56, v185
    s_cmp_lg_u32 s56, 0
    s_cbranch_scc1 WK_NB1_G
    s_sleep 4
    v_mov_b32 v184, 128
    global_load_dword v185, v184, s[28:29] sc0 sc1
    s_waitcnt vmcnt(0)
    s_branch WK_NB1_L
WK_NB1_G:
    v_mov_b32 v184, 147456
    ds_write_b32 v184, v185
    s_waitcnt lgkmcnt(0)
WK_NB1_B:
    s_barrier
    v_mov_b32 v184, 147456
    ds_read_b32 v185, v184
    s_waitcnt lgkmcnt(0)
    v_readfirstlane_b32 s56, v185
    s_cmp_lg_u32 s3, 0
    s_cbranch_scc1 WK_PRE_D
    s_lshr_b32 s41, s40, 2
    s_lshl_b32 s41, s41, 7
    s_and_b32 s15, s40, 3
    s_lshl_b32 s15, s15, 2
    s_add_u32 s41, s41, s15
    s_add_u32 s41, s41, 4526080
    v_mov_b32 v184, s41
    v_mov_b32 v185, s56
    s_mov_b64 exec, 1
    global_store_dword v184, v185, s[4:5] sc1
    s_mov_b64 exec, -1
    s_mov_b32 s55, 1
    s_branch WK_PRE_D
WK_PRE_I:
    s_cmp_lg_u32 s3, 0
    s_cbranch_scc1 WK_PRE_N2
    v_mov_b32 v184, 128
    global_load_dword v185, v184, s[28:29] sc0 sc1
WK_PRE_N2:
    s_sub_u32 s52, s40, 128
    s_lshl_b32 s52, s52, 2
    s_add_u32 s52, s52, s3
    v_mov_b32 v212, -1
    v_mov_b32 v213, -1
    v_mov_b32 v214, -1
    v_mov_b32 v215, -1
    s_add_u32 s10, s52, 0
    s_lshl_b32 s10, s10, 10
    s_add_u32 s10, s10, 6291456
    v_add_u32 v216, s10, v192
    global_store_dwordx4 v216, v[212:215], s[4:5] sc1
    s_add_u32 s10, s52, 384
    s_cmp_ge_u32 s10, 512
    s_cbranch_scc1 PRE_NOP2
    s_lshl_b32 s10, s10, 10
    s_add_u32 s10, s10, 6291456
    v_add_u32 v216, s10, v192
    global_store_dwordx4 v216, v[212:215], s[4:5] sc1
PRE_NOP2:
    s_cmp_ge_u32 s52, 32
    s_cbranch_scc1 PRE_NOMEM
    s_lshl_b32 s10, s52, 10
    s_add_u32 s10, s10, 5242880
    v_add_u32 v216, s10, v192
    global_store_dwordx4 v216, v[212:215], s[4:5] sc1
PRE_NOMEM:
    s_add_u32 s10, s52, 0
    s_lshl_b32 s10, s10, 10
    s_add_u32 s10, s10, 116654080
    v_add_u32 v216, s10, v192
    global_store_dwordx4 v216, v[212:215], s[4:5] sc1
    s_add_u32 s10, s52, 384
    s_lshl_b32 s10, s10, 10
    s_add_u32 s10, s10, 116654080
    v_add_u32 v216, s10, v192
    global_store_dwordx4 v216, v[212:215], s[4:5] sc1
PRE_TK:
    s_and_b32 s10, s52, 127
    s_lshr_b32 s15, s10, 2
    s_lshl_b32 s15, s15, 18
    s_and_b32 s10, s10, 3
    s_lshl_b32 s10, s10, 10
    s_add_u32 s10, s10, s15
    s_mov_b32 s41, 92532736
    s_cmp_ge_u32 s52, 256
    s_cselect_b32 s41, 84144128, s41
    s_add_u32 s10, s10, s41
    s_cmp_ge_u32 s52, 256
    s_cbranch_scc1 PRE_TK2
    s_cmp_ge_u32 s52, 128
    s_cbranch_scc1 PRE_TK3
PRE_TK2:
    v_add_u32 v216, s10, v192
    global_store_dwordx4 v216, v[212:215], s[4:5] sc1
PRE_TK3:
    s_waitcnt vmcnt(0)
    s_cmp_lg_u32 s3, 0
    s_cbranch_scc1 WK_NB2_B
WK_NB2_L:
    v_readfirstlane_b32 s56, v185
    s_cmp_lg_u32 s56, 0
    s_cbranch_scc1 WK_NB2_G
    s_sleep 4
    v_mov_b32 v184, 128
    global_load_dword v185, v184, s[28:29] sc0 sc1
    s_waitcnt vmcnt(0)
    s_branch WK_NB2_L
WK_NB2_G:
    v_mov_b32 v184, 147456
    ds_write_b32 v184, v185
    s_waitcnt lgkmcnt(0)
WK_NB2_B:
    s_barrier
    v_mov_b32 v184, 147456
    ds_read_b32 v185, v184
    s_waitcnt lgkmcnt(0)
    v_readfirstlane_b32 s56, v185
    s_cmp_lg_u32 s3, 0
    s_cbranch_scc1 WK_PRE_I2
    s_sub_u32 s41, s40, 128
    s_lshl_b32 s41, s41, 2
    s_add_u32 s41, s41, 4530176
    v_mov_b32 v184, s41
    v_mov_b32 v185, s56
    s_mov_b64 exec, 1
    global_store_dword v184, v185, s[4:5] sc1
    s_mov_b64 exec, -1
WK_PRE_I2:
    global_load_dwordx4 v[16:19], v4, s[6:7] offset:0
    global_load_dwordx4 v[20:23], v5, s[6:7] offset:0
    global_load_dwordx4 v[24:27], v4, s[6:7] offset:64
    global_load_dwordx4 v[28:31], v5, s[6:7] offset:64
    global_load_dwordx4 v[32:35], v4, s[6:7] offset:128
    global_load_dwordx4 v[36:39], v5, s[6:7] offset:128
    global_load_dwordx4 v[40:43], v4, s[6:7] offset:192
    global_load_dwordx4 v[44:47], v5, s[6:7] offset:192
    s_add_u32 s6, s6, 262144
    s_addc_u32 s7, s7, 0
    global_load_dwordx4 v[48:51], v4, s[6:7] offset:0
    global_load_dwordx4 v[52:55], v5, s[6:7] offset:0
    global_load_dwordx4 v[56:59], v4, s[6:7] offset:64
    global_load_dwordx4 v[60:63], v5, s[6:7] offset:64
    global_load_dwordx4 v[64:67], v4, s[6:7] offset:128
    global_load_dwordx4 v[68:71], v5, s[6:7] offset:128
    global_load_dwordx4 v[72:75], v4, s[6:7] offset:192
    global_load_dwordx4 v[76:79], v5, s[6:7] offset:192
    s_add_u32 s6, s6, 262144
    s_addc_u32 s7, s7, 0
    global_load_dwordx4 v[80:83], v4, s[6:7] offset:0
    global_load_dwordx4 v[84:87], v5, s[6:7] offset:0
    global_load_dwordx4 v[88:91], v4, s[6:7] offset:64
    global_load_dwordx4 v[92:95], v5, s[6:7] offset:64
    global_load_dwordx4 v[96:99], v4, s[6:7] offset:128
    global_load_dwordx4 v[100:103], v5, s[6:7] offset:128
    global_load_dwordx4 v[104:107], v4, s[6:7] offset:192
    global_load_dwordx4 v[108:111], v5, s[6:7] offset:192
    s_add_u32 s6, s6, 262144
    s_addc_u32 s7, s7, 0
    global_load_dwordx4 v[112:115], v4, s[6:7] offset:0
    global_load_dwordx4 v[116:119], v5, s[6:7] offset:0
    global_load_dwordx4 v[120:123], v4, s[6:7] offset:64
    global_load_dwordx4 v[124:127], v5, s[6:7] offset:64
    global_load_dwordx4 v[128:131], v4, s[6:7] offset:128
    global_load_dwordx4 v[132:135], v5, s[6:7] offset:128
    global_load_dwordx4 v[136:139], v4, s[6:7] offset:192
    global_load_dwordx4 v[140:143], v5, s[6:7] offset:192
    s_add_u32 s6, s6, 262144
    s_addc_u32 s7, s7, 0
WK_PRE_D:
    s_mov_b32 s10, s54
    s_branch WK_STG
WK_NOPRE:
    s_lshl_b32 s15, s10, 2
    s_add_u32 s15, s15, s3
    s_lshl_b32 s15, s15, 7
    s_add_u32 s15, s15, 4526080
    v_mov_b32 v192, s15
    global_load_dwordx4 v[188:191], v192, s[4:5] sc1
    global_load_dwordx4 v[16:19], v4, s[6:7] offset:0
    global_load_dwordx4 v[20:23], v5, s[6:7] offset:0
    global_load_dwordx4 v[24:27], v4, s[6:7] offset:64
    global_load_dwordx4 v[28:31], v5, s[6:7] offset:64
    global_load_dwordx4 v[32:35], v4, s[6:7] offset:128
    global_load_dwordx4 v[36:39], v5, s[6:7] offset:128
    global_load_dwordx4 v[40:43], v4, s[6:7] offset:192
    global_load_dwordx4 v[44:47], v5, s[6:7] offset:192
    s_add_u32 s6, s6, 262144
    s_addc_u32 s7, s7, 0
    global_load_dwordx4 v[48:51], v4, s[6:7] offset:0
    global_load_dwordx4 v[52:55], v5, s[6:7] offset:0
    global_load_dwordx4 v[56:59], v4, s[6:7] offset:64
    global_load_dwordx4 v[60:63], v5, s[6:7] offset:64
    global_load_dwordx4 v[64:67], v4, s[6:7] offset:128
    global_load_dwordx4 v[68:71], v5, s[6:7] offset:128
    global_load_dwordx4 v[72:75], v4, s[6:7] offset:192
    global_load_dwordx4 v[76:79], v5, s[6:7] offset:192
    s_add_u32 s6, s6, 262144
    s_addc_u32 s7, s7, 0
    global_load_dwordx4 v[80:83], v4, s[6:7] offset:0
    global_load_dwordx4 v[84:87], v5, s[6:7] offset:0
    global_load_dwordx4 v[88:91], v4, s[6:7] offset:64
    global_load_dwordx4 v[92:95], v5, s[6:7] offset:64
    global_load_dwordx4 v[96:99], v4, s[6:7] offset:128
    global_load_dwordx4 v[100:103], v5, s[6:7] offset:128
    global_load_dwordx4 v[104:107], v4, s[6:7] offset:192
    global_load_dwordx4 v[108:111], v5, s[6:7] offset:192
    s_add_u32 s6, s6, 262144
    s_addc_u32 s7, s7, 0
    global_load_dwordx4 v[112:115], v4, s[6:7] offset:0
    global_load_dwordx4 v[116:119], v5, s[6:7] offset:0
    global_load_dwordx4 v[120:123], v4, s[6:7] offset:64
    global_load_dwordx4 v[124:127], v5, s[6:7] offset:64
    global_load_dwordx4 v[128:131], v4, s[6:7] offset:128
    global_load_dwordx4 v[132:135], v5, s[6:7] offset:128
    global_load_dwordx4 v[136:139], v4, s[6:7] offset:192
    global_load_dwordx4 v[140:143], v5, s[6:7] offset:192
    s_add_u32 s6, s6, 262144
    s_addc_u32 s7, s7, 0
    s_barrier
WK_STG:
    s_lshl_b32 s12, s10, 2
    s_add_u32 s12, s12, s3
    v_lshlrev_b32 v3, 4, v2
    s_lshl_b32 s15, s3, 15
    v_add_u32 v4, s15, v3
    s_waitcnt vmcnt(30)
    v_mfma_f32_16x16x32_bf16 v[144:147], v[16:19], v[224:227], 0
    v_mfma_f32_16x16x32_bf16 v[148:151], v[16:19], v[228:231], 0
    v_mfma_f32_16x16x32_bf16 v[152:155], v[20:23], v[224:227], 0
    v_mfma_f32_16x16x32_bf16 v[156:159], v[20:23], v[228:231], 0
    s_waitcnt vmcnt(28)
    v_mfma_f32_16x16x32_bf16 v[160:163], v[24:27], v[224:227], 0
    v_mfma_f32_16x16x32_bf16 v[164:167], v[24:27], v[228:231], 0
    v_mfma_f32_16x16x32_bf16 v[168:171], v[28:31], v[224:227], 0
    v_mfma_f32_16x16x32_bf16 v[172:175], v[28:31], v[228:231], 0
    v_cvt_pk_bf16_f32 v176, v144, v145
    v_cvt_pk_bf16_f32 v177, v146, v147
    v_cvt_pk_bf16_f32 v178, v152, v153
    v_cvt_pk_bf16_f32 v179, v154, v155
    v_cvt_pk_bf16_f32 v180, v148, v149
    v_cvt_pk_bf16_f32 v181, v150, v151
    v_cvt_pk_bf16_f32 v182, v156, v157
    v_cvt_pk_bf16_f32 v183, v158, v159
    ds_write_b128 v4, v[176:179] offset:0
    ds_write_b128 v4, v[180:183] offset:1024
    s_waitcnt vmcnt(26)
    v_mfma_f32_16x16x32_bf16 v[144:147], v[32:35], v[224:227], 0
    v_mfma_f32_16x16x32_bf16 v[148:151], v[32:35], v[228:231], 0
    v_mfma_f32_16x16x32_bf16 v[152:155], v[36:39], v[224:227], 0
    v_mfma_f32_16x16x32_bf16 v[156:159], v[36:39], v[228:231], 0
    v_cvt_pk_bf16_f32 v176, v160, v161
    v_cvt_pk_bf16_f32 v177, v162, v163
    v_cvt_pk_bf16_f32 v178, v168, v169
    v_cvt_pk_bf16_f32 v179, v170, v171
    v_cvt_pk_bf16_f32 v180, v164, v165
    v_cvt_pk_bf16_f32 v181, v166, v167
    v_cvt_pk_bf16_f32 v182, v172, v173
    v_cvt_pk_bf16_f32 v183, v174, v175
    ds_write_b128 v4, v[176:179] offset:2048
    ds_write_b128 v4, v[180:183] offset:3072
    s_waitcnt vmcnt(24)
    v_mfma_f32_16x16x32_bf16 v[160:163], v[40:43], v[224:227], 0
    v_mfma_f32_16x16x32_bf16 v[164:167], v[40:43], v[228:231], 0
    v_mfma_f32_16x16x32_bf16 v[168:171], v[44:47], v[224:227], 0
    v_mfma_f32_16x16x32_bf16 v[172:175], v[44:47], v[228:231], 0
    v_cvt_pk_bf16_f32 v176, v144, v145
    v_cvt_pk_bf16_f32 v177, v146, v147
    v_cvt_pk_bf16_f32 v178, v152, v153
    v_cvt_pk_bf16_f32 v179, v154, v155
    v_cvt_pk_bf16_f32 v180, v148, v149
    v_cvt_pk_bf16_f32 v181, v150, v151
    v_cvt_pk_bf16_f32 v182, v156, v157
    v_cvt_pk_bf16_f32 v183, v158, v159
    ds_write_b128 v4, v[176:179] offset:4096
    ds_write_b128 v4, v[180:183] offset:5120
    s_waitcnt vmcnt(22)
    v_mfma_f32_16x16x32_bf16 v[144:147], v[48:51], v[224:227], 0
    v_mfma_f32_16x16x32_bf16 v[148:151], v[48:51], v[228:231], 0
    v_mfma_f32_16x16x32_bf16 v[152:155], v[52:55], v[224:227], 0
    v_mfma_f32_16x16x32_bf16 v[156:159], v[52:55], v[228:231], 0
    v_cvt_pk_bf16_f32 v176, v160, v161
    v_cvt_pk_bf16_f32 v177, v162, v163
    v_cvt_pk_bf16_f32 v178, v168, v169
    v_cvt_pk_bf16_f32 v179, v170, v171
    v_cvt_pk_bf16_f32 v180, v164, v165
    v_cvt_pk_bf16_f32 v181, v166, v167
    v_cvt_pk_bf16_f32 v182, v172, v173
    v_cvt_pk_bf16_f32 v183, v174, v175
    ds_write_b128 v4, v[176:179] offset:6144
    ds_write_b128 v4, v[180:183] offset:7168
    s_waitcnt vmcnt(20)
    v_mfma_f32_16x16x32_bf16 v[160:163], v[56:59], v[224:227], 0
    v_mfma_f32_16x16x32_bf16 v[164:167], v[56:59], v[228:231], 0
    v_mfma_f32_16x16x32_bf16 v[168:171], v[60:63], v[224:227], 0
    v_mfma_f32_16x16x32_bf16 v[172:175], v[60:63], v[228:231], 0
    v_cvt_pk_bf16_f32 v176, v144, v145
    v_cvt_pk_bf16_f32 v177, v146, v147
    v_cvt_pk_bf16_f32 v178, v152, v153
    v_cvt_pk_bf16_f32 v179, v154, v155
    v_cvt_pk_bf16_f32 v180, v148, v149
    v_cvt_pk_bf16_f32 v181, v150, v151
    v_cvt_pk_bf16_f32 v182, v156, v157
    v_cvt_pk_bf16_f32 v183, v158, v159
    ds_write_b128 v4, v[176:179] offset:8192
    ds_write_b128 v4, v[180:183] offset:9216
    s_waitcnt vmcnt(18)
    v_mfma_f32_16x16x32_bf16 v[144:147], v[64:67], v[224:227], 0
    v_mfma_f32_16x16x32_bf16 v[148:151], v[64:67], v[228:231], 0
    v_mfma_f32_16x16x32_bf16 v[152:155], v[68:71], v[224:227], 0
    v_mfma_f32_16x16x32_bf16 v[156:159], v[68:71], v[228:231], 0
    v_cvt_pk_bf16_f32 v176, v160, v161
    v_cvt_pk_bf16_f32 v177, v162, v163
    v_cvt_pk_bf16_f32 v178, v168, v169
    v_cvt_pk_bf16_f32 v179, v170, v171
    v_cvt_pk_bf16_f32 v180, v164, v165
    v_cvt_pk_bf16_f32 v181, v166, v167
    v_cvt_pk_bf16_f32 v182, v172, v173
    v_cvt_pk_bf16_f32 v183, v174, v175
    ds_write_b128 v4, v[176:179] offset:10240
    ds_write_b128 v4, v[180:183] offset:11264
    s_waitcnt vmcnt(16)
    v_mfma_f32_16x16x32_bf16 v[160:163], v[72:75], v[224:227], 0
    v_mfma_f32_16x16x32_bf16 v[164:167], v[72:75], v[228:231], 0
    v_mfma_f32_16x16x32_bf16 v[168:171], v[76:79], v[224:227], 0
    v_mfma_f32_16x16x32_bf16 v[172:175], v[76:79], v[228:231], 0
    v_cvt_pk_bf16_f32 v176, v144, v145
    v_cvt_pk_bf16_f32 v177, v146, v147
    v_cvt_pk_bf16_f32 v178, v152, v153
    v_cvt_pk_bf16_f32 v179, v154, v155
    v_cvt_pk_bf16_f32 v180, v148, v149
    v_cvt_pk_bf16_f32 v181, v150, v151
    v_cvt_pk_bf16_f32 v182, v156, v157
    v_cvt_pk_bf16_f32 v183, v158, v159
    ds_write_b128 v4, v[176:179] offset:12288
    ds_write_b128 v4, v[180:183] offset:13312
    s_waitcnt vmcnt(14)
    v_mfma_f32_16x16x32_bf16 v[144:147], v[80:83], v[224:227], 0
    v_mfma_f32_16x16x32_bf16 v[148:151], v[80:83], v[228:231], 0
    v_mfma_f32_16x16x32_bf16 v[152:155], v[84:87], v[224:227], 0
    v_mfma_f32_16x16x32_bf16 v[156:159], v[84:87], v[228:231], 0
    v_cvt_pk_bf16_f32 v176, v160, v161
    v_cvt_pk_bf16_f32 v177, v162, v163
    v_cvt_pk_bf16_f32 v178, v168, v169
    v_cvt_pk_bf16_f32 v179, v170, v171
    v_cvt_pk_bf16_f32 v180, v164, v165
    v_cvt_pk_bf16_f32 v181, v166, v167
    v_cvt_pk_bf16_f32 v182, v172, v173
    v_cvt_pk_bf16_f32 v183, v174, v175
    ds_write_b128 v4, v[176:179] offset:14336
    ds_write_b128 v4, v[180:183] offset:15360
    s_waitcnt vmcnt(12)
    v_mfma_f32_16x16x32_bf16 v[160:163], v[88:91], v[224:227], 0
    v_mfma_f32_16x16x32_bf16 v[164:167], v[88:91], v[228:231], 0
    v_mfma_f32_16x16x32_bf16 v[168:171], v[92:95], v[224:227], 0
    v_mfma_f32_16x16x32_bf16 v[172:175], v[92:95], v[228:231], 0
    v_cvt_pk_bf16_f32 v176, v144, v145
    v_cvt_pk_bf16_f32 v177, v146, v147
    v_cvt_pk_bf16_f32 v178, v152, v153
    v_cvt_pk_bf16_f32 v179, v154, v155
    v_cvt_pk_bf16_f32 v180, v148, v149
    v_cvt_pk_bf16_f32 v181, v150, v151
    v_cvt_pk_bf16_f32 v182, v156, v157
    v_cvt_pk_bf16_f32 v183, v158, v159
    ds_write_b128 v4, v[176:179] offset:16384
    ds_write_b128 v4, v[180:183] offset:17408
    s_waitcnt vmcnt(10)
    v_mfma_f32_16x16x32_bf16 v[144:147], v[96:99], v[224:227], 0
    v_mfma_f32_16x16x32_bf16 v[148:151], v[96:99], v[228:231], 0
    v_mfma_f32_16x16x32_bf16 v[152:155], v[100:103], v[224:227], 0
    v_mfma_f32_16x16x32_bf16 v[156:159], v[100:103], v[228:231], 0
    v_cvt_pk_bf16_f32 v176, v160, v161
    v_cvt_pk_bf16_f32 v177, v162, v163
    v_cvt_pk_bf16_f32 v178, v168, v169
    v_cvt_pk_bf16_f32 v179, v170, v171
    v_cvt_pk_bf16_f32 v180, v164, v165
    v_cvt_pk_bf16_f32 v181, v166, v167
    v_cvt_pk_bf16_f32 v182, v172, v173
    v_cvt_pk_bf16_f32 v183, v174, v175
    ds_write_b128 v4, v[176:179] offset:18432
    ds_write_b128 v4, v[180:183] offset:19456
    s_waitcnt vmcnt(8)
    v_mfma_f32_16x16x32_bf16 v[160:163], v[104:107], v[224:227], 0
    v_mfma_f32_16x16x32_bf16 v[164:167], v[104:107], v[228:231], 0
    v_mfma_f32_16x16x32_bf16 v[168:171], v[108:111], v[224:227], 0
    v_mfma_f32_16x16x32_bf16 v[172:175], v[108:111], v[228:231], 0
    v_cvt_pk_bf16_f32 v176, v144, v145
    v_cvt_pk_bf16_f32 v177, v146, v147
    v_cvt_pk_bf16_f32 v178, v152, v153
    v_cvt_pk_bf16_f32 v179, v154, v155
    v_cvt_pk_bf16_f32 v180, v148, v149
    v_cvt_pk_bf16_f32 v181, v150, v151
    v_cvt_pk_bf16_f32 v182, v156, v157
    v_cvt_pk_bf16_f32 v183, v158, v159
    ds_write_b128 v4, v[176:179] offset:20480
    ds_write_b128 v4, v[180:183] offset:21504
    s_waitcnt vmcnt(6)
    v_mfma_f32_16x16x32_bf16 v[144:147], v[112:115], v[224:227], 0
    v_mfma_f32_16x16x32_bf16 v[148:151], v[112:115], v[228:231], 0
    v_mfma_f32_16x16x32_bf16 v[152:155], v[116:119], v[224:227], 0
    v_mfma_f32_16x16x32_bf16 v[156:159], v[116:119], v[228:231], 0
    v_cvt_pk_bf16_f32 v176, v160, v161
    v_cvt_pk_bf16_f32 v177, v162, v163
    v_cvt_pk_bf16_f32 v178, v168, v169
    v_cvt_pk_bf16_f32 v179, v170, v171
    v_cvt_pk_bf16_f32 v180, v164, v165
    v_cvt_pk_bf16_f32 v181, v166, v167
    v_cvt_pk_bf16_f32 v182, v172, v173
    v_cvt_pk_bf16_f32 v183, v174, v175
    ds_write_b128 v4, v[176:179] offset:22528
    ds_write_b128 v4, v[180:183] offset:23552
    s_waitcnt vmcnt(4)
    v_mfma_f32_16x16x32_bf16 v[160:163], v[120:123], v[224:227], 0
    v_mfma_f32_16x16x32_bf16 v[164:167], v[120:123], v[228:231], 0
    v_mfma_f32_16x16x32_bf16 v[168:171], v[124:127], v[224:227], 0
    v_mfma_f32_16x16x32_bf16 v[172:175], v[124:127], v[228:231], 0
    v_cvt_pk_bf16_f32 v176, v144, v145
    v_cvt_pk_bf16_f32 v177, v146, v147
    v_cvt_pk_bf16_f32 v178, v152, v153
    v_cvt_pk_bf16_f32 v179, v154, v155
    v_cvt_pk_bf16_f32 v180, v148, v149
    v_cvt_pk_bf16_f32 v181, v150, v151
    v_cvt_pk_bf16_f32 v182, v156, v157
    v_cvt_pk_bf16_f32 v183, v158, v159
    ds_write_b128 v4, v[176:179] offset:24576
    ds_write_b128 v4, v[180:183] offset:25600
    s_waitcnt vmcnt(2)
    v_mfma_f32_16x16x32_bf16 v[144:147], v[128:131], v[224:227], 0
    v_mfma_f32_16x16x32_bf16 v[148:151], v[128:131], v[228:231], 0
    v_mfma_f32_16x16x32_bf16 v[152:155], v[132:135], v[224:227], 0
    v_mfma_f32_16x16x32_bf16 v[156:159], v[132:135], v[228:231], 0
    v_cvt_pk_bf16_f32 v176, v160, v161
    v_cvt_pk_bf16_f32 v177, v162, v163
    v_cvt_pk_bf16_f32 v178, v168, v169
    v_cvt_pk_bf16_f32 v179, v170, v171
    v_cvt_pk_bf16_f32 v180, v164, v165
    v_cvt_pk_bf16_f32 v181, v166, v167
    v_cvt_pk_bf16_f32 v182, v172, v173
    v_cvt_pk_bf16_f32 v183, v174, v175
    ds_write_b128 v4, v[176:179] offset:26624
    ds_write_b128 v4, v[180:183] offset:27648
    s_cmp_eq_u32 s55, 1
    s_cbranch_scc1 QS_W1
    s_waitcnt vmcnt(0)
    s_branch QS_W2
QS_W1:
    s_waitcnt vmcnt(1)
QS_W2:
    v_mfma_f32_16x16x32_bf16 v[160:163], v[136:139], v[224:227], 0
    v_mfma_f32_16x16x32_bf16 v[164:167], v[136:139], v[228:231], 0
    v_mfma_f32_16x16x32_bf16 v[168:171], v[140:143], v[224:227], 0
    v_mfma_f32_16x16x32_bf16 v[172:175], v[140:143], v[228:231], 0
    v_cvt_pk_bf16_f32 v176, v144, v145
    v_cvt_pk_bf16_f32 v177, v146, v147
    v_cvt_pk_bf16_f32 v178, v152, v153
    v_cvt_pk_bf16_f32 v179, v154, v155
    v_cvt_pk_bf16_f32 v180, v148, v149
    v_cvt_pk_bf16_f32 v181, v150, v151
    v_cvt_pk_bf16_f32 v182, v156, v157
    v_cvt_pk_bf16_f32 v183, v158, v159
    ds_write_b128 v4, v[176:179] offset:28672
    ds_write_b128 v4, v[180:183] offset:29696
    s_nop 7
    v_cvt_pk_bf16_f32 v176, v160, v161
    v_cvt_pk_bf16_f32 v177, v162, v163
    v_cvt_pk_bf16_f32 v178, v168, v169
    v_cvt_pk_bf16_f32 v179, v170, v171
    v_cvt_pk_bf16_f32 v180, v164, v165
    v_cvt_pk_bf16_f32 v181, v166, v167
    v_cvt_pk_bf16_f32 v182, v172, v173
    v_cvt_pk_bf16_f32 v183, v174, v175
    ds_write_b128 v4, v[176:179] offset:30720
    ds_write_b128 v4, v[180:183] offset:31744
    s_lshl_b32 s16, s12, 16
    s_add_u32 s16, s16, 2097152
    s_add_u32 s22, s4, s16
    s_addc_u32 s23, s5, 0
    v_add_u32 v5, 0, v3
    v_add_u32 v6, 16384, v3
    v_add_u32 v7, 32768, v3
    v_add_u32 v8, 49152, v3
    v_add_u32 v9, 65536, v3
    s_mov_b32 s55, 0
    s_cmp_eq_u32 s53, 0
    s_cbranch_scc1 WK_NOBAR
    s_mov_b32 s53, 0
    s_lshl_b32 s15, s10, 2
    s_add_u32 s15, s15, s3
    s_lshl_b32 s15, s15, 7
    s_add_u32 s15, s15, 4526080
    v_mov_b32 v192, s15
    global_load_dwordx4 v[188:191], v192, s[4:5] sc1
    s_waitcnt vmcnt(0)
WK_NOBAR:
WK_LNC:
    v_xor_b32 v188, s56, v188
    v_xor_b32 v189, s56, v189
    v_xor_b32 v190, s56, v190
    v_xor_b32 v191, s56, v191
    v_or3_b32 v188, v188, v189, v190
    v_or_b32 v188, v188, v191
    v_cmp_ne_u32 vcc, 0, v188
    s_cbranch_vccz WK_LNC_OK
    s_sleep 2
    global_load_dwordx4 v[188:191], v192, s[4:5] sc1
    s_waitcnt vmcnt(0)
    s_branch WK_LNC
WK_LNC_OK:
    s_waitcnt lgkmcnt(0)
    s_barrier
    global_load_dwordx4 a[128:131], v5, s[22:23] offset:0
    global_load_dwordx4 a[132:135], v6, s[22:23] offset:0
    global_load_dwordx4 a[136:139], v7, s[22:23] offset:0
    global_load_dwordx4 a[140:143], v8, s[22:23] offset:0
    global_load_dwordx4 a[144:147], v5, s[22:23] offset:1024
    global_load_dwordx4 a[148:151], v6, s[22:23] offset:1024
    global_load_dwordx4 a[152:155], v7, s[22:23] offset:1024
    global_load_dwordx4 a[156:159], v8, s[22:23] offset:1024
    global_load_dwordx4 a[160:163], v5, s[22:23] offset:2048
    global_load_dwordx4 a[164:167], v6, s[22:23] offset:2048
    global_load_dwordx4 a[168:171], v7, s[22:23] offset:2048
    global_load_dwordx4 a[172:175], v8, s[22:23] offset:2048
    global_load_dwordx4 a[176:179], v5, s[22:23] offset:3072
    global_load_dwordx4 a[180:183], v6, s[22:23] offset:3072
    global_load_dwordx4 a[184:187], v7, s[22:23] offset:3072
    global_load_dwordx4 a[188:191], v8, s[22:23] offset:3072
    s_add_u32 s22, s22, 4096
    s_addc_u32 s23, s23, 0
    global_load_dwordx4 a[192:195], v5, s[22:23] offset:0
    global_load_dwordx4 a[196:199], v6, s[22:23] offset:0
    global_load_dwordx4 a[200:203], v7, s[22:23] offset:0
    global_load_dwordx4 a[204:207], v8, s[22:23] offset:0
    global_load_dwordx4 a[208:211], v5, s[22:23] offset:1024
    global_load_dwordx4 a[212:215], v6, s[22:23] offset:1024
    global_load_dwordx4 a[216:219], v7, s[22:23] offset:1024
    global_load_dwordx4 a[220:223], v8, s[22:23] offset:1024
    global_load_dwordx4 a[224:227], v5, s[22:23] offset:2048
    global_load_dwordx4 a[228:231], v6, s[22:23] offset:2048
    global_load_dwordx4 a[232:235], v7, s[22:23] offset:2048
    global_load_dwordx4 a[236:239], v8, s[22:23] offset:2048
    global_load_dwordx4 a[240:243], v5, s[22:23] offset:3072
    global_load_dwordx4 a[244:247], v6, s[22:23] offset:3072
    global_load_dwordx4 a[248:251], v7, s[22:23] offset:3072
    global_load_dwordx4 a[252:255], v8, s[22:23] offset:3072
    s_add_u32 s22, s22, 4096
    s_addc_u32 s23, s23, 0
    global_load_dwordx4 v[16:19], v5, s[22:23] offset:0
    global_load_dwordx4 v[20:23], v6, s[22:23] offset:0
    global_load_dwordx4 v[24:27], v7, s[22:23] offset:0
    global_load_dwordx4 v[28:31], v8, s[22:23] offset:0
    global_load_dwordx4 v[32:35], v5, s[22:23] offset:1024
    global_load_dwordx4 v[36:39], v6, s[22:23] offset:1024
    global_load_dwordx4 v[40:43], v7, s[22:23] offset:1024
    global_load_dwordx4 v[44:47], v8, s[22:23] offset:1024
    global_load_dwordx4 v[48:51], v5, s[22:23] offset:2048
    global_load_dwordx4 v[52:55], v6, s[22:23] offset:2048
    global_load_dwordx4 v[56:59], v7, s[22:23] offset:2048
    global_load_dwordx4 v[60:63], v8, s[22:23] offset:2048
    global_load_dwordx4 v[64:67], v5, s[22:23] offset:3072
    global_load_dwordx4 v[68:71], v6, s[22:23] offset:3072
    global_load_dwordx4 v[72:75], v7, s[22:23] offset:3072
    global_load_dwordx4 v[76:79], v8, s[22:23] offset:3072
    s_add_u32 s22, s22, 4096
    s_addc_u32 s23, s23, 0
    global_load_dwordx4 v[80:83], v5, s[22:23] offset:0
    global_load_dwordx4 v[84:87], v6, s[22:23] offset:0
    global_load_dwordx4 v[88:91], v7, s[22:23] offset:0
    global_load_dwordx4 v[92:95], v8, s[22:23] offset:0
    global_load_dwordx4 v[96:99], v5, s[22:23] offset:1024
    global_load_dwordx4 v[100:103], v6, s[22:23] offset:1024
    global_load_dwordx4 v[104:107], v7, s[22:23] offset:1024
    global_load_dwordx4 v[108:111], v8, s[22:23] offset:1024
    global_load_dwordx4 v[112:115], v5, s[22:23] offset:2048
    global_load_dwordx4 v[116:119], v6, s[22:23] offset:2048
    global_load_dwordx4 v[120:123], v7, s[22:23] offset:2048
    global_load_dwordx4 v[124:127], v8, s[22:23] offset:2048
    s_cmp_eq_u32 s13, 2
    s_cbranch_scc1 WKG_V
    ds_read_b128 v[144:147], v3 offset:0
    ds_read_b128 v[148:151], v3 offset:1024
    ds_read_b128 v[152:155], v3 offset:2048
    ds_read_b128 v[156:159], v3 offset:3072
    ds_read_b128 v[160:163], v3 offset:4096
    ds_read_b128 v[164:167], v3 offset:5120
    ds_read_b128 v[168:171], v3 offset:6144
    ds_read_b128 v[172:175], v3 offset:7168
    s_waitcnt vmcnt(56)
    ds_read_b128 v[176:179], v3 offset:8192
    ds_read_b128 v[180:183], v3 offset:9216
    ds_read_b128 v[184:187], v3 offset:10240
    ds_read_b128 v[188:191], v3 offset:11264
    ds_read_b128 v[192:195], v3 offset:12288
    ds_read_b128 v[196:199], v3 offset:13312
    ds_read_b128 v[200:203], v3 offset:14336
    ds_read_b128 v[204:207], v3 offset:15360
    s_waitcnt lgkmcnt(8)
    v_mfma_f32_16x16x32_bf16 a[0:3], v[144:147], a[128:131], 0
    v_mfma_f32_16x16x32_bf16 a[4:7], v[148:151], a[128:131], 0
    v_mfma_f32_16x16x32_bf16 a[8:11], v[152:155], a[128:131], 0
    v_mfma_f32_16x16x32_bf16 a[12:15], v[156:159], a[128:131], 0
    v_mfma_f32_16x16x32_bf16 a[16:19], v[160:163], a[128:131], 0
    v_mfma_f32_16x16x32_bf16 a[20:23], v[164:167], a[128:131], 0
    v_mfma_f32_16x16x32_bf16 a[24:27], v[168:171], a[128:131], 0
    v_mfma_f32_16x16x32_bf16 a[28:31], v[172:175], a[128:131], 0
    v_mfma_f32_16x16x32_bf16 a[32:35], v[144:147], a[132:135], 0
    v_mfma_f32_16x16x32_bf16 a[36:39], v[148:151], a[132:135], 0
    v_mfma_f32_16x16x32_bf16 a[40:43], v[152:155], a[132:135], 0
    v_mfma_f32_16x16x32_bf16 a[44:47], v[156:159], a[132:135], 0
    v_mfma_f32_16x16x32_bf16 a[48:51], v[160:163], a[132:135], 0
    v_mfma_f32_16x16x32_bf16 a[52:55], v[164:167], a[132:135], 0
    v_mfma_f32_16x16x32_bf16 a[56:59], v[168:171], a[132:135], 0
    v_mfma_f32_16x16x32_bf16 a[60:63], v[172:175], a[132:135], 0
    v_mfma_f32_16x16x32_bf16 a[64:67], v[144:147], a[136:139], 0
    v_mfma_f32_16x16x32_bf16 a[68:71], v[148:151], a[136:139], 0
    v_mfma_f32_16x16x32_bf16 a[72:75], v[152:155], a[136:139], 0
    v_mfma_f32_16x16x32_bf16 a[76:79], v[156:159], a[136:139], 0
    v_mfma_f32_16x16x32_bf16 a[80:83], v[160:163], a[136:139], 0
    v_mfma_f32_16x16x32_bf16 a[84:87], v[164:167], a[136:139], 0
    v_mfma_f32_16x16x32_bf16 a[88:91], v[168:171], a[136:139], 0
    v_mfma_f32_16x16x32_bf16 a[92:95], v[172:175], a[136:139], 0
    v_mfma_f32_16x16x32_bf16 a[96:99], v[144:147], a[140:143], 0
    v_mfma_f32_16x16x32_bf16 a[100:103], v[148:151], a[140:143], 0
    v_mfma_f32_16x16x32_bf16 a[104:107], v[152:155], a[140:143], 0
    v_mfma_f32_16x16x32_bf16 a[108:111], v[156:159], a[140:143], 0
    v_mfma_f32_16x16x32_bf16 a[112:115], v[160:163], a[140:143], 0
    v_mfma_f32_16x16x32_bf16 a[116:119], v[164:167], a[140:143], 0
    v_mfma_f32_16x16x32_bf16 a[120:123], v[168:171], a[140:143], 0
    v_mfma_f32_16x16x32_bf16 a[124:127], v[172:175], a[140:143], 0
    global_load_dwordx4 v[128:131], v5, s[22:23] offset:3072
    global_load_dwordx4 v[132:135], v6, s[22:23] offset:3072
    global_load_dwordx4 v[136:139], v7, s[22:23] offset:3072
    global_load_dwordx4 v[140:143], v8, s[22:23] offset:3072
    s_waitcnt vmcnt(56)
    ds_read_b128 v[144:147], v3 offset:16384
    ds_read_b128 v[148:151], v3 offset:17408
    ds_read_b128 v[152:155], v3 offset:18432
    ds_read_b128 v[156:159], v3 offset:19456
    ds_read_b128 v[160:163], v3 offset:20480
    ds_read_b128 v[164:167], v3 offset:21504
    ds_read_b128 v[168:171], v3 offset:22528
    ds_read_b128 v[172:175], v3 offset:23552
    s_waitcnt lgkmcnt(8)
    v_mfma_f32_16x16x32_bf16 a[0:3], v[176:179], a[144:147], a[0:3]
    v_mfma_f32_16x16x32_bf16 a[4:7], v[180:183], a[144:147], a[4:7]
    v_mfma_f32_16x16x32_bf16 a[8:11], v[184:187], a[144:147], a[8:11]
    v_mfma_f32_16x16x32_bf16 a[12:15], v[188:191], a[144:147], a[12:15]
    v_mfma_f32_16x16x32_bf16 a[16:19], v[192:195], a[144:147], a[16:19]
    v_mfma_f32_16x16x32_bf16 a[20:23], v[196:199], a[144:147], a[20:23]
    v_mfma_f32_16x16x32_bf16 a[24:27], v[200:203], a[144:147], a[24:27]
    v_mfma_f32_16x16x32_bf16 a[28:31], v[204:207], a[144:147], a[28:31]
    v_mfma_f32_16x16x32_bf16 a[32:35], v[176:179], a[148:151], a[32:35]
    v_mfma_f32_16x16x32_bf16 a[36:39], v[180:183], a[148:151], a[36:39]
    v_mfma_f32_16x16x32_bf16 a[40:43], v[184:187], a[148:151], a[40:43]
    v_mfma_f32_16x16x32_bf16 a[44:47], v[188:191], a[148:151], a[44:47]
    v_mfma_f32_16x16x32_bf16 a[48:51], v[192:195], a[148:151], a[48:51]
    v_mfma_f32_16x16x32_bf16 a[52:55], v[196:199], a[148:151], a[52:55]
    v_mfma_f32_16x16x32_bf16 a[56:59], v[200:203], a[148:151], a[56:59]
    v_mfma_f32_16x16x32_bf16 a[60:63], v[204:207], a[148:151], a[60:63]
    v_mfma_f32_16x16x32_bf16 a[64:67], v[176:179], a[152:155], a[64:67]
    v_mfma_f32_16x16x32_bf16 a[68:71], v[180:183], a[152:155], a[68:71]
    v_mfma_f32_16x16x32_bf16 a[72:75], v[184:187], a[152:155], a[72:75]
    v_mfma_f32_16x16x32_bf16 a[76:79], v[188:191], a[152:155], a[76:79]
    v_mfma_f32_16x16x32_bf16 a[80:83], v[192:195], a[152:155], a[80:83]
    v_mfma_f32_16x16x32_bf16 a[84:87], v[196:199], a[152:155], a[84:87]
    v_mfma_f32_16x16x32_bf16 a[88:91], v[200:203], a[152:155], a[88:91]
    v_mfma_f32_16x16x32_bf16 a[92:95], v[204:207], a[152:155], a[92:95]
    v_mfma_f32_16x16x32_bf16 a[96:99], v[176:179], a[156:159], a[96:99]
    v_mfma_f32_16x16x32_bf16 a[100:103], v[180:183], a[156:159], a[100:103]
    v_mfma_f32_16x16x32_bf16 a[104:107], v[184:187], a[156:159], a[104:107]
    v_mfma_f32_16x16x32_bf16 a[108:111], v[188:191], a[156:159], a[108:111]
    v_mfma_f32_16x16x32_bf16 a[112:115], v[192:195], a[156:159], a[112:115]
    v_mfma_f32_16x16x32_bf16 a[116:119], v[196:199], a[156:159], a[116:119]
    v_mfma_f32_16x16x32_bf16 a[120:123], v[200:203], a[156:159], a[120:123]
    v_mfma_f32_16x16x32_bf16 a[124:127], v[204:207], a[156:159], a[124:127]
    s_waitcnt vmcnt(52)
    ds_read_b128 v[176:179], v3 offset:24576
    ds_read_b128 v[180:183], v3 offset:25600
    ds_read_b128 v[184:187], v3 offset:26624
    ds_read_b128 v[188:191], v3 offset:27648
    ds_read_b128 v[192:195], v3 offset:28672
    ds_read_b128 v[196:199], v3 offset:29696
    ds_read_b128 v[200:203], v3 offset:30720
    ds_read_b128 v[204:207], v3 offset:31744
    s_waitcnt lgkmcnt(8)
    v_mfma_f32_16x16x32_bf16 a[0:3], v[144:147], a[160:163], a[0:3]
    v_mfma_f32_16x16x32_bf16 a[4:7], v[148:151], a[160:163], a[4:7]
    v_mfma_f32_16x16x32_bf16 a[8:11], v[152:155], a[160:163], a[8:11]
    v_mfma_f32_16x16x32_bf16 a[12:15], v[156:159], a[160:163], a[12:15]
    v_mfma_f32_16x16x32_bf16 a[16:19], v[160:163], a[160:163], a[16:19]
    v_mfma_f32_16x16x32_bf16 a[20:23], v[164:167], a[160:163], a[20:23]
    v_mfma_f32_16x16x32_bf16 a[24:27], v[168:171], a[160:163], a[24:27]
    v_mfma_f32_16x16x32_bf16 a[28:31], v[172:175], a[160:163], a[28:31]
    v_mfma_f32_16x16x32_bf16 a[32:35], v[144:147], a[164:167], a[32:35]
    v_mfma_f32_16x16x32_bf16 a[36:39], v[148:151], a[164:167], a[36:39]
    v_mfma_f32_16x16x32_bf16 a[40:43], v[152:155], a[164:167], a[40:43]
    v_mfma_f32_16x16x32_bf16 a[44:47], v[156:159], a[164:167], a[44:47]
    v_mfma_f32_16x16x32_bf16 a[48:51], v[160:163], a[164:167], a[48:51]
    v_mfma_f32_16x16x32_bf16 a[52:55], v[164:167], a[164:167], a[52:55]
    v_mfma_f32_16x16x32_bf16 a[56:59], v[168:171], a[164:167], a[56:59]
    v_mfma_f32_16x16x32_bf16 a[60:63], v[172:175], a[164:167], a[60:63]
    v_mfma_f32_16x16x32_bf16 a[64:67], v[144:147], a[168:171], a[64:67]
    v_mfma_f32_16x16x32_bf16 a[68:71], v[148:151], a[168:171], a[68:71]
    v_mfma_f32_16x16x32_bf16 a[72:75], v[152:155], a[168:171], a[72:75]
    v_mfma_f32_16x16x32_bf16 a[76:79], v[156:159], a[168:171], a[76:79]
    v_mfma_f32_16x16x32_bf16 a[80:83], v[160:163], a[168:171], a[80:83]
    v_mfma_f32_16x16x32_bf16 a[84:87], v[164:167], a[168:171], a[84:87]
    v_mfma_f32_16x16x32_bf16 a[88:91], v[168:171], a[168:171], a[88:91]
    v_mfma_f32_16x16x32_bf16 a[92:95], v[172:175], a[168:171], a[92:95]
    v_mfma_f32_16x16x32_bf16 a[96:99], v[144:147], a[172:175], a[96:99]
    v_mfma_f32_16x16x32_bf16 a[100:103], v[148:151], a[172:175], a[100:103]
    v_mfma_f32_16x16x32_bf16 a[104:107], v[152:155], a[172:175], a[104:107]
    v_mfma_f32_16x16x32_bf16 a[108:111], v[156:159], a[172:175], a[108:111]
    v_mfma_f32_16x16x32_bf16 a[112:115], v[160:163], a[172:175], a[112:115]
    v_mfma_f32_16x16x32_bf16 a[116:119], v[164:167], a[172:175], a[116:119]
    v_mfma_f32_16x16x32_bf16 a[120:123], v[168:171], a[172:175], a[120:123]
    v_mfma_f32_16x16x32_bf16 a[124:127], v[172:175], a[172:175], a[124:127]
    s_waitcnt vmcnt(48)
    ds_read_b128 v[144:147], v3 offset:32768
    ds_read_b128 v[148:151], v3 offset:33792
    ds_read_b128 v[152:155], v3 offset:34816
    ds_read_b128 v[156:159], v3 offset:35840
    ds_read_b128 v[160:163], v3 offset:36864
    ds_read_b128 v[164:167], v3 offset:37888
    ds_read_b128 v[168:171], v3 offset:38912
    ds_read_b128 v[172:175], v3 offset:39936
    s_waitcnt lgkmcnt(8)
    v_mfma_f32_16x16x32_bf16 a[0:3], v[176:179], a[176:179], a[0:3]
    v_mfma_f32_16x16x32_bf16 a[4:7], v[180:183], a[176:179], a[4:7]
    v_mfma_f32_16x16x32_bf16 a[8:11], v[184:187], a[176:179], a[8:11]
    v_mfma_f32_16x16x32_bf16 a[12:15], v[188:191], a[176:179], a[12:15]
    v_mfma_f32_16x16x32_bf16 a[16:19], v[192:195], a[176:179], a[16:19]
    v_mfma_f32_16x16x32_bf16 a[20:23], v[196:199], a[176:179], a[20:23]
    v_mfma_f32_16x16x32_bf16 a[24:27], v[200:203], a[176:179], a[24:27]
    v_mfma_f32_16x16x32_bf16 a[28:31], v[204:207], a[176:179], a[28:31]
    v_mfma_f32_16x16x32_bf16 a[32:35], v[176:179], a[180:183], a[32:35]
    v_mfma_f32_16x16x32_bf16 a[36:39], v[180:183], a[180:183], a[36:39]
    v_mfma_f32_16x16x32_bf16 a[40:43], v[184:187], a[180:183], a[40:43]
    v_mfma_f32_16x16x32_bf16 a[44:47], v[188:191], a[180:183], a[44:47]
    v_mfma_f32_16x16x32_bf16 a[48:51], v[192:195], a[180:183], a[48:51]
    v_mfma_f32_16x16x32_bf16 a[52:55], v[196:199], a[180:183], a[52:55]
    v_mfma_f32_16x16x32_bf16 a[56:59], v[200:203], a[180:183], a[56:59]
    v_mfma_f32_16x16x32_bf16 a[60:63], v[204:207], a[180:183], a[60:63]
    v_mfma_f32_16x16x32_bf16 a[64:67], v[176:179], a[184:187], a[64:67]
    v_mfma_f32_16x16x32_bf16 a[68:71], v[180:183], a[184:187], a[68:71]
    v_mfma_f32_16x16x32_bf16 a[72:75], v[184:187], a[184:187], a[72:75]
    v_mfma_f32_16x16x32_bf16 a[76:79], v[188:191], a[184:187], a[76:79]
    v_mfma_f32_16x16x32_bf16 a[80:83], v[192:195], a[184:187], a[80:83]
    v_mfma_f32_16x16x32_bf16 a[84:87], v[196:199], a[184:187], a[84:87]
    v_mfma_f32_16x16x32_bf16 a[88:91], v[200:203], a[184:187], a[88:91]
    v_mfma_f32_16x16x32_bf16 a[92:95], v[204:207], a[184:187], a[92:95]
    v_mfma_f32_16x16x32_bf16 a[96:99], v[176:179], a[188:191], a[96:99]
    v_mfma_f32_16x16x32_bf16 a[100:103], v[180:183], a[188:191], a[100:103]
    v_mfma_f32_16x16x32_bf16 a[104:107], v[184:187], a[188:191], a[104:107]
    v_mfma_f32_16x16x32_bf16 a[108:111], v[188:191], a[188:191], a[108:111]
    v_mfma_f32_16x16x32_bf16 a[112:115], v[192:195], a[188:191], a[112:115]
    v_mfma_f32_16x16x32_bf16 a[116:119], v[196:199], a[188:191], a[116:119]
    v_mfma_f32_16x16x32_bf16 a[120:123], v[200:203], a[188:191], a[120:123]
    v_mfma_f32_16x16x32_bf16 a[124:127], v[204:207], a[188:191], a[124:127]
    s_waitcnt vmcnt(44)
    ds_read_b128 v[176:179], v3 offset:40960
    ds_read_b128 v[180:183], v3 offset:41984
    ds_read_b128 v[184:187], v3 offset:43008
    ds_read_b128 v[188:191], v3 offset:44032
    ds_read_b128 v[192:195], v3 offset:45056
    ds_read_b128 v[196:199], v3 offset:46080
    ds_read_b128 v[200:203], v3 offset:47104
    ds_read_b128 v[204:207], v3 offset:48128
    s_waitcnt lgkmcnt(8)
    v_mfma_f32_16x16x32_bf16 a[0:3], v[144:147], a[192:195], a[0:3]
    v_mfma_f32_16x16x32_bf16 a[4:7], v[148:151], a[192:195], a[4:7]
    v_mfma_f32_16x16x32_bf16 a[8:11], v[152:155], a[192:195], a[8:11]
    v_mfma_f32_16x16x32_bf16 a[12:15], v[156:159], a[192:195], a[12:15]
    v_mfma_f32_16x16x32_bf16 a[16:19], v[160:163], a[192:195], a[16:19]
    v_mfma_f32_16x16x32_bf16 a[20:23], v[164:167], a[192:195], a[20:23]
    v_mfma_f32_16x16x32_bf16 a[24:27], v[168:171], a[192:195], a[24:27]
    v_mfma_f32_16x16x32_bf16 a[28:31], v[172:175], a[192:195], a[28:31]
    v_mfma_f32_16x16x32_bf16 a[32:35], v[144:147], a[196:199], a[32:35]
    v_mfma_f32_16x16x32_bf16 a[36:39], v[148:151], a[196:199], a[36:39]
    v_mfma_f32_16x16x32_bf16 a[40:43], v[152:155], a[196:199], a[40:43]
    v_mfma_f32_16x16x32_bf16 a[44:47], v[156:159], a[196:199], a[44:47]
    v_mfma_f32_16x16x32_bf16 a[48:51], v[160:163], a[196:199], a[48:51]
    v_mfma_f32_16x16x32_bf16 a[52:55], v[164:167], a[196:199], a[52:55]
    v_mfma_f32_16x16x32_bf16 a[56:59], v[168:171], a[196:199], a[56:59]
    v_mfma_f32_16x16x32_bf16 a[60:63], v[172:175], a[196:199], a[60:63]
    v_mfma_f32_16x16x32_bf16 a[64:67], v[144:147], a[200:203], a[64:67]
    v_mfma_f32_16x16x32_bf16 a[68:71], v[148:151], a[200:203], a[68:71]
    v_mfma_f32_16x16x32_bf16 a[72:75], v[152:155], a[200:203], a[72:75]
    v_mfma_f32_16x16x32_bf16 a[76:79], v[156:159], a[200:203], a[76:79]
    v_mfma_f32_16x16x32_bf16 a[80:83], v[160:163], a[200:203], a[80:83]
    v_mfma_f32_16x16x32_bf16 a[84:87], v[164:167], a[200:203], a[84:87]
    v_mfma_f32_16x16x32_bf16 a[88:91], v[168:171], a[200:203], a[88:91]
    v_mfma_f32_16x16x32_bf16 a[92:95], v[172:175], a[200:203], a[92:95]
    v_mfma_f32_16x16x32_bf16 a[96:99], v[144:147], a[204:207], a[96:99]
    v_mfma_f32_16x16x32_bf16 a[100:103], v[148:151], a[204:207], a[100:103]
    v_mfma_f32_16x16x32_bf16 a[104:107], v[152:155], a[204:207], a[104:107]
    v_mfma_f32_16x16x32_bf16 a[108:111], v[156:159], a[204:207], a[108:111]
    v_mfma_f32_16x16x32_bf16 a[112:115], v[160:163], a[204:207], a[112:115]
    v_mfma_f32_16x16x32_bf16 a[116:119], v[164:167], a[204:207], a[116:119]
    v_mfma_f32_16x16x32_bf16 a[120:123], v[168:171], a[204:207], a[120:123]
    v_mfma_f32_16x16x32_bf16 a[124:127], v[172:175], a[204:207], a[124:127]
    s_waitcnt vmcnt(40)
    ds_read_b128 v[144:147], v3 offset:49152
    ds_read_b128 v[148:151], v3 offset:50176
    ds_read_b128 v[152:155], v3 offset:51200
    ds_read_b128 v[156:159], v3 offset:52224
    ds_read_b128 v[160:163], v3 offset:53248
    ds_read_b128 v[164:167], v3 offset:54272
    ds_read_b128 v[168:171], v3 offset:55296
    ds_read_b128 v[172:175], v3 offset:56320
    s_waitcnt lgkmcnt(8)
    v_mfma_f32_16x16x32_bf16 a[0:3], v[176:179], a[208:211], a[0:3]
    v_mfma_f32_16x16x32_bf16 a[4:7], v[180:183], a[208:211], a[4:7]
    v_mfma_f32_16x16x32_bf16 a[8:11], v[184:187], a[208:211], a[8:11]
    v_mfma_f32_16x16x32_bf16 a[12:15], v[188:191], a[208:211], a[12:15]
    v_mfma_f32_16x16x32_bf16 a[16:19], v[192:195], a[208:211], a[16:19]
    v_mfma_f32_16x16x32_bf16 a[20:23], v[196:199], a[208:211], a[20:23]
    v_mfma_f32_16x16x32_bf16 a[24:27], v[200:203], a[208:211], a[24:27]
    v_mfma_f32_16x16x32_bf16 a[28:31], v[204:207], a[208:211], a[28:31]
    v_mfma_f32_16x16x32_bf16 a[32:35], v[176:179], a[212:215], a[32:35]
    v_mfma_f32_16x16x32_bf16 a[36:39], v[180:183], a[212:215], a[36:39]
    v_mfma_f32_16x16x32_bf16 a[40:43], v[184:187], a[212:215], a[40:43]
    v_mfma_f32_16x16x32_bf16 a[44:47], v[188:191], a[212:215], a[44:47]
    v_mfma_f32_16x16x32_bf16 a[48:51], v[192:195], a[212:215], a[48:51]
    v_mfma_f32_16x16x32_bf16 a[52:55], v[196:199], a[212:215], a[52:55]
    v_mfma_f32_16x16x32_bf16 a[56:59], v[200:203], a[212:215], a[56:59]
    v_mfma_f32_16x16x32_bf16 a[60:63], v[204:207], a[212:215], a[60:63]
    v_mfma_f32_16x16x32_bf16 a[64:67], v[176:179], a[216:219], a[64:67]
    v_mfma_f32_16x16x32_bf16 a[68:71], v[180:183], a[216:219], a[68:71]
    v_mfma_f32_16x16x32_bf16 a[72:75], v[184:187], a[216:219], a[72:75]
    v_mfma_f32_16x16x32_bf16 a[76:79], v[188:191], a[216:219], a[76:79]
    v_mfma_f32_16x16x32_bf16 a[80:83], v[192:195], a[216:219], a[80:83]
    v_mfma_f32_16x16x32_bf16 a[84:87], v[196:199], a[216:219], a[84:87]
    v_mfma_f32_16x16x32_bf16 a[88:91], v[200:203], a[216:219], a[88:91]
    v_mfma_f32_16x16x32_bf16 a[92:95], v[204:207], a[216:219], a[92:95]
    v_mfma_f32_16x16x32_bf16 a[96:99], v[176:179], a[220:223], a[96:99]
    v_mfma_f32_16x16x32_bf16 a[100:103], v[180:183], a[220:223], a[100:103]
    v_mfma_f32_16x16x32_bf16 a[104:107], v[184:187], a[220:223], a[104:107]
    v_mfma_f32_16x16x32_bf16 a[108:111], v[188:191], a[220:223], a[108:111]
    v_mfma_f32_16x16x32_bf16 a[112:115], v[192:195], a[220:223], a[112:115]
    v_mfma_f32_16x16x32_bf16 a[116:119], v[196:199], a[220:223], a[116:119]
    v_mfma_f32_16x16x32_bf16 a[120:123], v[200:203], a[220:223], a[120:123]
    v_mfma_f32_16x16x32_bf16 a[124:127], v[204:207], a[220:223], a[124:127]
    s_waitcnt vmcnt(36)
    ds_read_b128 v[176:179], v3 offset:57344
    ds_read_b128 v[180:183], v3 offset:58368
    ds_read_b128 v[184:187], v3 offset:59392
    ds_read_b128 v[188:191], v3 offset:60416
    ds_read_b128 v[192:195], v3 offset:61440
    ds_read_b128 v[196:199], v3 offset:62464
    ds_read_b128 v[200:203], v3 offset:63488
    ds_read_b128 v[204:207], v3 offset:64512
    s_waitcnt lgkmcnt(8)
    v_mfma_f32_16x16x32_bf16 a[0:3], v[144:147], a[224:227], a[0:3]
    v_mfma_f32_16x16x32_bf16 a[4:7], v[148:151], a[224:227], a[4:7]
    v_mfma_f32_16x16x32_bf16 a[8:11], v[152:155], a[224:227], a[8:11]
    v_mfma_f32_16x16x32_bf16 a[12:15], v[156:159], a[224:227], a[12:15]
    v_mfma_f32_16x16x32_bf16 a[16:19], v[160:163], a[224:227], a[16:19]
    v_mfma_f32_16x16x32_bf16 a[20:23], v[164:167], a[224:227], a[20:23]
    v_mfma_f32_16x16x32_bf16 a[24:27], v[168:171], a[224:227], a[24:27]
    v_mfma_f32_16x16x32_bf16 a[28:31], v[172:175], a[224:227], a[28:31]
    v_mfma_f32_16x16x32_bf16 a[32:35], v[144:147], a[228:231], a[32:35]
    v_mfma_f32_16x16x32_bf16 a[36:39], v[148:151], a[228:231], a[36:39]
    v_mfma_f32_16x16x32_bf16 a[40:43], v[152:155], a[228:231], a[40:43]
    v_mfma_f32_16x16x32_bf16 a[44:47], v[156:159], a[228:231], a[44:47]
    v_mfma_f32_16x16x32_bf16 a[48:51], v[160:163], a[228:231], a[48:51]
    v_mfma_f32_16x16x32_bf16 a[52:55], v[164:167], a[228:231], a[52:55]
    v_mfma_f32_16x16x32_bf16 a[56:59], v[168:171], a[228:231], a[56:59]
    v_mfma_f32_16x16x32_bf16 a[60:63], v[172:175], a[228:231], a[60:63]
    v_mfma_f32_16x16x32_bf16 a[64:67], v[144:147], a[232:235], a[64:67]
    v_mfma_f32_16x16x32_bf16 a[68:71], v[148:151], a[232:235], a[68:71]
    v_mfma_f32_16x16x32_bf16 a[72:75], v[152:155], a[232:235], a[72:75]
    v_mfma_f32_16x16x32_bf16 a[76:79], v[156:159], a[232:235], a[76:79]
    v_mfma_f32_16x16x32_bf16 a[80:83], v[160:163], a[232:235], a[80:83]
    v_mfma_f32_16x16x32_bf16 a[84:87], v[164:167], a[232:235], a[84:87]
    v_mfma_f32_16x16x32_bf16 a[88:91], v[168:171], a[232:235], a[88:91]
    v_mfma_f32_16x16x32_bf16 a[92:95], v[172:175], a[232:235], a[92:95]
    v_mfma_f32_16x16x32_bf16 a[96:99], v[144:147], a[236:239], a[96:99]
    v_mfma_f32_16x16x32_bf16 a[100:103], v[148:151], a[236:239], a[100:103]
    v_mfma_f32_16x16x32_bf16 a[104:107], v[152:155], a[236:239], a[104:107]
    v_mfma_f32_16x16x32_bf16 a[108:111], v[156:159], a[236:239], a[108:111]
    v_mfma_f32_16x16x32_bf16 a[112:115], v[160:163], a[236:239], a[112:115]
    v_mfma_f32_16x16x32_bf16 a[116:119], v[164:167], a[236:239], a[116:119]
    v_mfma_f32_16x16x32_bf16 a[120:123], v[168:171], a[236:239], a[120:123]
    v_mfma_f32_16x16x32_bf16 a[124:127], v[172:175], a[236:239], a[124:127]
    s_waitcnt vmcnt(32)
    ds_read_b128 v[144:147], v9 offset:0
    ds_read_b128 v[148:151], v9 offset:1024
    ds_read_b128 v[152:155], v9 offset:2048
    ds_read_b128 v[156:159], v9 offset:3072
    ds_read_b128 v[160:163], v9 offset:4096
    ds_read_b128 v[164:167], v9 offset:5120
    ds_read_b128 v[168:171], v9 offset:6144
    ds_read_b128 v[172:175], v9 offset:7168
    s_waitcnt lgkmcnt(8)
    v_mfma_f32_16x16x32_bf16 a[0:3], v[176:179], a[240:243], a[0:3]
    v_mfma_f32_16x16x32_bf16 a[4:7], v[180:183], a[240:243], a[4:7]
    v_mfma_f32_16x16x32_bf16 a[8:11], v[184:187], a[240:243], a[8:11]
    v_mfma_f32_16x16x32_bf16 a[12:15], v[188:191], a[240:243], a[12:15]
    v_mfma_f32_16x16x32_bf16 a[16:19], v[192:195], a[240:243], a[16:19]
    v_mfma_f32_16x16x32_bf16 a[20:23], v[196:199], a[240:243], a[20:23]
    v_mfma_f32_16x16x32_bf16 a[24:27], v[200:203], a[240:243], a[24:27]
    v_mfma_f32_16x16x32_bf16 a[28:31], v[204:207], a[240:243], a[28:31]
    v_mfma_f32_16x16x32_bf16 a[32:35], v[176:179], a[244:247], a[32:35]
    v_mfma_f32_16x16x32_bf16 a[36:39], v[180:183], a[244:247], a[36:39]
    v_mfma_f32_16x16x32_bf16 a[40:43], v[184:187], a[244:247], a[40:43]
    v_mfma_f32_16x16x32_bf16 a[44:47], v[188:191], a[244:247], a[44:47]
    v_mfma_f32_16x16x32_bf16 a[48:51], v[192:195], a[244:247], a[48:51]
    v_mfma_f32_16x16x32_bf16 a[52:55], v[196:199], a[244:247], a[52:55]
    v_mfma_f32_16x16x32_bf16 a[56:59], v[200:203], a[244:247], a[56:59]
    v_mfma_f32_16x16x32_bf16 a[60:63], v[204:207], a[244:247], a[60:63]
    v_mfma_f32_16x16x32_bf16 a[64:67], v[176:179], a[248:251], a[64:67]
    v_mfma_f32_16x16x32_bf16 a[68:71], v[180:183], a[248:251], a[68:71]
    v_mfma_f32_16x16x32_bf16 a[72:75], v[184:187], a[248:251], a[72:75]
    v_mfma_f32_16x16x32_bf16 a[76:79], v[188:191], a[248:251], a[76:79]
    v_mfma_f32_16x16x32_bf16 a[80:83], v[192:195], a[248:251], a[80:83]
    v_mfma_f32_16x16x32_bf16 a[84:87], v[196:199], a[248:251], a[84:87]
    v_mfma_f32_16x16x32_bf16 a[88:91], v[200:203], a[248:251], a[88:91]
    v_mfma_f32_16x16x32_bf16 a[92:95], v[204:207], a[248:251], a[92:95]
    v_mfma_f32_16x16x32_bf16 a[96:99], v[176:179], a[252:255], a[96:99]
    v_mfma_f32_16x16x32_bf16 a[100:103], v[180:183], a[252:255], a[100:103]
    v_mfma_f32_16x16x32_bf16 a[104:107], v[184:187], a[252:255], a[104:107]
    v_mfma_f32_16x16x32_bf16 a[108:111], v[188:191], a[252:255], a[108:111]
    v_mfma_f32_16x16x32_bf16 a[112:115], v[192:195], a[252:255], a[112:115]
    v_mfma_f32_16x16x32_bf16 a[116:119], v[196:199], a[252:255], a[116:119]
    v_mfma_f32_16x16x32_bf16 a[120:123], v[200:203], a[252:255], a[120:123]
    v_mfma_f32_16x16x32_bf16 a[124:127], v[204:207], a[252:255], a[124:127]
    s_waitcnt vmcnt(28)
    ds_read_b128 v[176:179], v9 offset:8192
    ds_read_b128 v[180:183], v9 offset:9216
    ds_read_b128 v[184:187], v9 offset:10240
    ds_read_b128 v[188:191], v9 offset:11264
    ds_read_b128 v[192:195], v9 offset:12288
    ds_read_b128 v[196:199], v9 offset:13312
    ds_read_b128 v[200:203], v9 offset:14336
    ds_read_b128 v[204:207], v9 offset:15360
    s_waitcnt lgkmcnt(8)
    v_mfma_f32_16x16x32_bf16 a[0:3], v[144:147], v[16:19], a[0:3]
    v_mfma_f32_16x16x32_bf16 a[4:7], v[148:151], v[16:19], a[4:7]
    v_mfma_f32_16x16x32_bf16 a[8:11], v[152:155], v[16:19], a[8:11]
    v_mfma_f32_16x16x32_bf16 a[12:15], v[156:159], v[16:19], a[12:15]
    v_mfma_f32_16x16x32_bf16 a[16:19], v[160:163], v[16:19], a[16:19]
    v_mfma_f32_16x16x32_bf16 a[20:23], v[164:167], v[16:19], a[20:23]
    v_mfma_f32_16x16x32_bf16 a[24:27], v[168:171], v[16:19], a[24:27]
    v_mfma_f32_16x16x32_bf16 a[28:31], v[172:175], v[16:19], a[28:31]
    v_mfma_f32_16x16x32_bf16 a[32:35], v[144:147], v[20:23], a[32:35]
    v_mfma_f32_16x16x32_bf16 a[36:39], v[148:151], v[20:23], a[36:39]
    v_mfma_f32_16x16x32_bf16 a[40:43], v[152:155], v[20:23], a[40:43]
    v_mfma_f32_16x16x32_bf16 a[44:47], v[156:159], v[20:23], a[44:47]
    v_mfma_f32_16x16x32_bf16 a[48:51], v[160:163], v[20:23], a[48:51]
    v_mfma_f32_16x16x32_bf16 a[52:55], v[164:167], v[20:23], a[52:55]
    v_mfma_f32_16x16x32_bf16 a[56:59], v[168:171], v[20:23], a[56:59]
    v_mfma_f32_16x16x32_bf16 a[60:63], v[172:175], v[20:23], a[60:63]
    v_mfma_f32_16x16x32_bf16 a[64:67], v[144:147], v[24:27], a[64:67]
    v_mfma_f32_16x16x32_bf16 a[68:71], v[148:151], v[24:27], a[68:71]
    v_mfma_f32_16x16x32_bf16 a[72:75], v[152:155], v[24:27], a[72:75]
    v_mfma_f32_16x16x32_bf16 a[76:79], v[156:159], v[24:27], a[76:79]
    v_mfma_f32_16x16x32_bf16 a[80:83], v[160:163], v[24:27], a[80:83]
    v_mfma_f32_16x16x32_bf16 a[84:87], v[164:167], v[24:27], a[84:87]
    v_mfma_f32_16x16x32_bf16 a[88:91], v[168:171], v[24:27], a[88:91]
    v_mfma_f32_16x16x32_bf16 a[92:95], v[172:175], v[24:27], a[92:95]
    v_mfma_f32_16x16x32_bf16 a[96:99], v[144:147], v[28:31], a[96:99]
    v_mfma_f32_16x16x32_bf16 a[100:103], v[148:151], v[28:31], a[100:103]
    v_mfma_f32_16x16x32_bf16 a[104:107], v[152:155], v[28:31], a[104:107]
    v_mfma_f32_16x16x32_bf16 a[108:111], v[156:159], v[28:31], a[108:111]
    v_mfma_f32_16x16x32_bf16 a[112:115], v[160:163], v[28:31], a[112:115]
    v_mfma_f32_16x16x32_bf16 a[116:119], v[164:167], v[28:31], a[116:119]
    v_mfma_f32_16x16x32_bf16 a[120:123], v[168:171], v[28:31], a[120:123]
    v_mfma_f32_16x16x32_bf16 a[124:127], v[172:175], v[28:31], a[124:127]
    s_waitcnt vmcnt(24)
    ds_read_b128 v[144:147], v9 offset:16384
    ds_read_b128 v[148:151], v9 offset:17408
    ds_read_b128 v[152:155], v9 offset:18432
    ds_read_b128 v[156:159], v9 offset:19456
    ds_read_b128 v[160:163], v9 offset:20480
    ds_read_b128 v[164:167], v9 offset:21504
    ds_read_b128 v[168:171], v9 offset:22528
    ds_read_b128 v[172:175], v9 offset:23552
    s_waitcnt lgkmcnt(8)
    v_mfma_f32_16x16x32_bf16 a[0:3], v[176:179], v[32:35], a[0:3]
    v_mfma_f32_16x16x32_bf16 a[4:7], v[180:183], v[32:35], a[4:7]
    v_mfma_f32_16x16x32_bf16 a[8:11], v[184:187], v[32:35], a[8:11]
    v_mfma_f32_16x16x32_bf16 a[12:15], v[188:191], v[32:35], a[12:15]
    v_mfma_f32_16x16x32_bf16 a[16:19], v[192:195], v[32:35], a[16:19]
    v_mfma_f32_16x16x32_bf16 a[20:23], v[196:199], v[32:35], a[20:23]
    v_mfma_f32_16x16x32_bf16 a[24:27], v[200:203], v[32:35], a[24:27]
    v_mfma_f32_16x16x32_bf16 a[28:31], v[204:207], v[32:35], a[28:31]
    v_mfma_f32_16x16x32_bf16 a[32:35], v[176:179], v[36:39], a[32:35]
    v_mfma_f32_16x16x32_bf16 a[36:39], v[180:183], v[36:39], a[36:39]
    v_mfma_f32_16x16x32_bf16 a[40:43], v[184:187], v[36:39], a[40:43]
    v_mfma_f32_16x16x32_bf16 a[44:47], v[188:191], v[36:39], a[44:47]
    v_mfma_f32_16x16x32_bf16 a[48:51], v[192:195], v[36:39], a[48:51]
    v_mfma_f32_16x16x32_bf16 a[52:55], v[196:199], v[36:39], a[52:55]
    v_mfma_f32_16x16x32_bf16 a[56:59], v[200:203], v[36:39], a[56:59]
    v_mfma_f32_16x16x32_bf16 a[60:63], v[204:207], v[36:39], a[60:63]
    v_mfma_f32_16x16x32_bf16 a[64:67], v[176:179], v[40:43], a[64:67]
    v_mfma_f32_16x16x32_bf16 a[68:71], v[180:183], v[40:43], a[68:71]
    v_mfma_f32_16x16x32_bf16 a[72:75], v[184:187], v[40:43], a[72:75]
    v_mfma_f32_16x16x32_bf16 a[76:79], v[188:191], v[40:43], a[76:79]
    v_mfma_f32_16x16x32_bf16 a[80:83], v[192:195], v[40:43], a[80:83]
    v_mfma_f32_16x16x32_bf16 a[84:87], v[196:199], v[40:43], a[84:87]
    v_mfma_f32_16x16x32_bf16 a[88:91], v[200:203], v[40:43], a[88:91]
    v_mfma_f32_16x16x32_bf16 a[92:95], v[204:207], v[40:43], a[92:95]
    v_mfma_f32_16x16x32_bf16 a[96:99], v[176:179], v[44:47], a[96:99]
    v_mfma_f32_16x16x32_bf16 a[100:103], v[180:183], v[44:47], a[100:103]
    v_mfma_f32_16x16x32_bf16 a[104:107], v[184:187], v[44:47], a[104:107]
    v_mfma_f32_16x16x32_bf16 a[108:111], v[188:191], v[44:47], a[108:111]
    v_mfma_f32_16x16x32_bf16 a[112:115], v[192:195], v[44:47], a[112:115]
    v_mfma_f32_16x16x32_bf16 a[116:119], v[196:199], v[44:47], a[116:119]
    v_mfma_f32_16x16x32_bf16 a[120:123], v[200:203], v[44:47], a[120:123]
    v_mfma_f32_16x16x32_bf16 a[124:127], v[204:207], v[44:47], a[124:127]
    s_waitcnt vmcnt(20)
    ds_read_b128 v[176:179], v9 offset:24576
    ds_read_b128 v[180:183], v9 offset:25600
    ds_read_b128 v[184:187], v9 offset:26624
    ds_read_b128 v[188:191], v9 offset:27648
    ds_read_b128 v[192:195], v9 offset:28672
    ds_read_b128 v[196:199], v9 offset:29696
    ds_read_b128 v[200:203], v9 offset:30720
    ds_read_b128 v[204:207], v9 offset:31744
    s_waitcnt lgkmcnt(8)
    v_mfma_f32_16x16x32_bf16 a[0:3], v[144:147], v[48:51], a[0:3]
    v_mfma_f32_16x16x32_bf16 a[4:7], v[148:151], v[48:51], a[4:7]
    v_mfma_f32_16x16x32_bf16 a[8:11], v[152:155], v[48:51], a[8:11]
    v_mfma_f32_16x16x32_bf16 a[12:15], v[156:159], v[48:51], a[12:15]
    v_mfma_f32_16x16x32_bf16 a[16:19], v[160:163], v[48:51], a[16:19]
    v_mfma_f32_16x16x32_bf16 a[20:23], v[164:167], v[48:51], a[20:23]
    v_mfma_f32_16x16x32_bf16 a[24:27], v[168:171], v[48:51], a[24:27]
    v_mfma_f32_16x16x32_bf16 a[28:31], v[172:175], v[48:51], a[28:31]
    v_mfma_f32_16x16x32_bf16 a[32:35], v[144:147], v[52:55], a[32:35]
    v_mfma_f32_16x16x32_bf16 a[36:39], v[148:151], v[52:55], a[36:39]
    v_mfma_f32_16x16x32_bf16 a[40:43], v[152:155], v[52:55], a[40:43]
    v_mfma_f32_16x16x32_bf16 a[44:47], v[156:159], v[52:55], a[44:47]
    v_mfma_f32_16x16x32_bf16 a[48:51], v[160:163], v[52:55], a[48:51]
    v_mfma_f32_16x16x32_bf16 a[52:55], v[164:167], v[52:55], a[52:55]
    v_mfma_f32_16x16x32_bf16 a[56:59], v[168:171], v[52:55], a[56:59]
    v_mfma_f32_16x16x32_bf16 a[60:63], v[172:175], v[52:55], a[60:63]
    v_mfma_f32_16x16x32_bf16 a[64:67], v[144:147], v[56:59], a[64:67]
    v_mfma_f32_16x16x32_bf16 a[68:71], v[148:151], v[56:59], a[68:71]
    v_mfma_f32_16x16x32_bf16 a[72:75], v[152:155], v[56:59], a[72:75]
    v_mfma_f32_16x16x32_bf16 a[76:79], v[156:159], v[56:59], a[76:79]
    v_mfma_f32_16x16x32_bf16 a[80:83], v[160:163], v[56:59], a[80:83]
    v_mfma_f32_16x16x32_bf16 a[84:87], v[164:167], v[56:59], a[84:87]
    v_mfma_f32_16x16x32_bf16 a[88:91], v[168:171], v[56:59], a[88:91]
    v_mfma_f32_16x16x32_bf16 a[92:95], v[172:175], v[56:59], a[92:95]
    v_mfma_f32_16x16x32_bf16 a[96:99], v[144:147], v[60:63], a[96:99]
    v_mfma_f32_16x16x32_bf16 a[100:103], v[148:151], v[60:63], a[100:103]
    v_mfma_f32_16x16x32_bf16 a[104:107], v[152:155], v[60:63], a[104:107]
    v_mfma_f32_16x16x32_bf16 a[108:111], v[156:159], v[60:63], a[108:111]
    v_mfma_f32_16x16x32_bf16 a[112:115], v[160:163], v[60:63], a[112:115]
    v_mfma_f32_16x16x32_bf16 a[116:119], v[164:167], v[60:63], a[116:119]
    v_mfma_f32_16x16x32_bf16 a[120:123], v[168:171], v[60:63], a[120:123]
    v_mfma_f32_16x16x32_bf16 a[124:127], v[172:175], v[60:63], a[124:127]
    s_waitcnt vmcnt(16)
    ds_read_b128 v[144:147], v9 offset:32768
    ds_read_b128 v[148:151], v9 offset:33792
    ds_read_b128 v[152:155], v9 offset:34816
    ds_read_b128 v[156:159], v9 offset:35840
    ds_read_b128 v[160:163], v9 offset:36864
    ds_read_b128 v[164:167], v9 offset:37888
    ds_read_b128 v[168:171], v9 offset:38912
    ds_read_b128 v[172:175], v9 offset:39936
    s_waitcnt lgkmcnt(8)
    v_mfma_f32_16x16x32_bf16 a[0:3], v[176:179], v[64:67], a[0:3]
    v_mfma_f32_16x16x32_bf16 a[4:7], v[180:183], v[64:67], a[4:7]
    v_mfma_f32_16x16x32_bf16 a[8:11], v[184:187], v[64:67], a[8:11]
    v_mfma_f32_16x16x32_bf16 a[12:15], v[188:191], v[64:67], a[12:15]
    v_mfma_f32_16x16x32_bf16 a[16:19], v[192:195], v[64:67], a[16:19]
    v_mfma_f32_16x16x32_bf16 a[20:23], v[196:199], v[64:67], a[20:23]
    v_mfma_f32_16x16x32_bf16 a[24:27], v[200:203], v[64:67], a[24:27]
    v_mfma_f32_16x16x32_bf16 a[28:31], v[204:207], v[64:67], a[28:31]
    v_mfma_f32_16x16x32_bf16 a[32:35], v[176:179], v[68:71], a[32:35]
    v_mfma_f32_16x16x32_bf16 a[36:39], v[180:183], v[68:71], a[36:39]
    v_mfma_f32_16x16x32_bf16 a[40:43], v[184:187], v[68:71], a[40:43]
    v_mfma_f32_16x16x32_bf16 a[44:47], v[188:191], v[68:71], a[44:47]
    v_mfma_f32_16x16x32_bf16 a[48:51], v[192:195], v[68:71], a[48:51]
    v_mfma_f32_16x16x32_bf16 a[52:55], v[196:199], v[68:71], a[52:55]
    v_mfma_f32_16x16x32_bf16 a[56:59], v[200:203], v[68:71], a[56:59]
    v_mfma_f32_16x16x32_bf16 a[60:63], v[204:207], v[68:71], a[60:63]
    v_mfma_f32_16x16x32_bf16 a[64:67], v[176:179], v[72:75], a[64:67]
    v_mfma_f32_16x16x32_bf16 a[68:71], v[180:183], v[72:75], a[68:71]
    v_mfma_f32_16x16x32_bf16 a[72:75], v[184:187], v[72:75], a[72:75]
    v_mfma_f32_16x16x32_bf16 a[76:79], v[188:191], v[72:75], a[76:79]
    v_mfma_f32_16x16x32_bf16 a[80:83], v[192:195], v[72:75], a[80:83]
    v_mfma_f32_16x16x32_bf16 a[84:87], v[196:199], v[72:75], a[84:87]
    v_mfma_f32_16x16x32_bf16 a[88:91], v[200:203], v[72:75], a[88:91]
    v_mfma_f32_16x16x32_bf16 a[92:95], v[204:207], v[72:75], a[92:95]
    v_mfma_f32_16x16x32_bf16 a[96:99], v[176:179], v[76:79], a[96:99]
    v_mfma_f32_16x16x32_bf16 a[100:103], v[180:183], v[76:79], a[100:103]
    v_mfma_f32_16x16x32_bf16 a[104:107], v[184:187], v[76:79], a[104:107]
    v_mfma_f32_16x16x32_bf16 a[108:111], v[188:191], v[76:79], a[108:111]
    v_mfma_f32_16x16x32_bf16 a[112:115], v[192:195], v[76:79], a[112:115]
    v_mfma_f32_16x16x32_bf16 a[116:119], v[196:199], v[76:79], a[116:119]
    v_mfma_f32_16x16x32_bf16 a[120:123], v[200:203], v[76:79], a[120:123]
    v_mfma_f32_16x16x32_bf16 a[124:127], v[204:207], v[76:79], a[124:127]
    s_waitcnt vmcnt(12)
    ds_read_b128 v[176:179], v9 offset:40960
    ds_read_b128 v[180:183], v9 offset:41984
    ds_read_b128 v[184:187], v9 offset:43008
    ds_read_b128 v[188:191], v9 offset:44032
    ds_read_b128 v[192:195], v9 offset:45056
    ds_read_b128 v[196:199], v9 offset:46080
    ds_read_b128 v[200:203], v9 offset:47104
    ds_read_b128 v[204:207], v9 offset:48128
    s_waitcnt lgkmcnt(8)
    v_mfma_f32_16x16x32_bf16 a[0:3], v[144:147], v[80:83], a[0:3]
    v_mfma_f32_16x16x32_bf16 a[4:7], v[148:151], v[80:83], a[4:7]
    v_mfma_f32_16x16x32_bf16 a[8:11], v[152:155], v[80:83], a[8:11]
    v_mfma_f32_16x16x32_bf16 a[12:15], v[156:159], v[80:83], a[12:15]
    v_mfma_f32_16x16x32_bf16 a[16:19], v[160:163], v[80:83], a[16:19]
    v_mfma_f32_16x16x32_bf16 a[20:23], v[164:167], v[80:83], a[20:23]
    v_mfma_f32_16x16x32_bf16 a[24:27], v[168:171], v[80:83], a[24:27]
    v_mfma_f32_16x16x32_bf16 a[28:31], v[172:175], v[80:83], a[28:31]
    v_mfma_f32_16x16x32_bf16 a[32:35], v[144:147], v[84:87], a[32:35]
    v_mfma_f32_16x16x32_bf16 a[36:39], v[148:151], v[84:87], a[36:39]
    v_mfma_f32_16x16x32_bf16 a[40:43], v[152:155], v[84:87], a[40:43]
    v_mfma_f32_16x16x32_bf16 a[44:47], v[156:159], v[84:87], a[44:47]
    v_mfma_f32_16x16x32_bf16 a[48:51], v[160:163], v[84:87], a[48:51]
    v_mfma_f32_16x16x32_bf16 a[52:55], v[164:167], v[84:87], a[52:55]
    v_mfma_f32_16x16x32_bf16 a[56:59], v[168:171], v[84:87], a[56:59]
    v_mfma_f32_16x16x32_bf16 a[60:63], v[172:175], v[84:87], a[60:63]
    v_mfma_f32_16x16x32_bf16 a[64:67], v[144:147], v[88:91], a[64:67]
    v_mfma_f32_16x16x32_bf16 a[68:71], v[148:151], v[88:91], a[68:71]
    v_mfma_f32_16x16x32_bf16 a[72:75], v[152:155], v[88:91], a[72:75]
    v_mfma_f32_16x16x32_bf16 a[76:79], v[156:159], v[88:91], a[76:79]
    v_mfma_f32_16x16x32_bf16 a[80:83], v[160:163], v[88:91], a[80:83]
    v_mfma_f32_16x16x32_bf16 a[84:87], v[164:167], v[88:91], a[84:87]
    v_mfma_f32_16x16x32_bf16 a[88:91], v[168:171], v[88:91], a[88:91]
    v_mfma_f32_16x16x32_bf16 a[92:95], v[172:175], v[88:91], a[92:95]
    v_mfma_f32_16x16x32_bf16 a[96:99], v[144:147], v[92:95], a[96:99]
    v_mfma_f32_16x16x32_bf16 a[100:103], v[148:151], v[92:95], a[100:103]
    v_mfma_f32_16x16x32_bf16 a[104:107], v[152:155], v[92:95], a[104:107]
    v_mfma_f32_16x16x32_bf16 a[108:111], v[156:159], v[92:95], a[108:111]
    v_mfma_f32_16x16x32_bf16 a[112:115], v[160:163], v[92:95], a[112:115]
    v_mfma_f32_16x16x32_bf16 a[116:119], v[164:167], v[92:95], a[116:119]
    v_mfma_f32_16x16x32_bf16 a[120:123], v[168:171], v[92:95], a[120:123]
    v_mfma_f32_16x16x32_bf16 a[124:127], v[172:175], v[92:95], a[124:127]
    s_waitcnt vmcnt(8)
    ds_read_b128 v[144:147], v9 offset:49152
    ds_read_b128 v[148:151], v9 offset:50176
    ds_read_b128 v[152:155], v9 offset:51200
    ds_read_b128 v[156:159], v9 offset:52224
    ds_read_b128 v[160:163], v9 offset:53248
    ds_read_b128 v[164:167], v9 offset:54272
    ds_read_b128 v[168:171], v9 offset:55296
    ds_read_b128 v[172:175], v9 offset:56320
    s_waitcnt lgkmcnt(8)
    v_mfma_f32_16x16x32_bf16 a[0:3], v[176:179], v[96:99], a[0:3]
    v_mfma_f32_16x16x32_bf16 a[4:7], v[180:183], v[96:99], a[4:7]
    v_mfma_f32_16x16x32_bf16 a[8:11], v[184:187], v[96:99], a[8:11]
    v_mfma_f32_16x16x32_bf16 a[12:15], v[188:191], v[96:99], a[12:15]
    v_mfma_f32_16x16x32_bf16 a[16:19], v[192:195], v[96:99], a[16:19]
    v_mfma_f32_16x16x32_bf16 a[20:23], v[196:199], v[96:99], a[20:23]
    v_mfma_f32_16x16x32_bf16 a[24:27], v[200:203], v[96:99], a[24:27]
    v_mfma_f32_16x16x32_bf16 a[28:31], v[204:207], v[96:99], a[28:31]
    v_mfma_f32_16x16x32_bf16 a[32:35], v[176:179], v[100:103], a[32:35]
    v_mfma_f32_16x16x32_bf16 a[36:39], v[180:183], v[100:103], a[36:39]
    v_mfma_f32_16x16x32_bf16 a[40:43], v[184:187], v[100:103], a[40:43]
    v_mfma_f32_16x16x32_bf16 a[44:47], v[188:191], v[100:103], a[44:47]
    v_mfma_f32_16x16x32_bf16 a[48:51], v[192:195], v[100:103], a[48:51]
    v_mfma_f32_16x16x32_bf16 a[52:55], v[196:199], v[100:103], a[52:55]
    v_mfma_f32_16x16x32_bf16 a[56:59], v[200:203], v[100:103], a[56:59]
    v_mfma_f32_16x16x32_bf16 a[60:63], v[204:207], v[100:103], a[60:63]
    v_mfma_f32_16x16x32_bf16 a[64:67], v[176:179], v[104:107], a[64:67]
    v_mfma_f32_16x16x32_bf16 a[68:71], v[180:183], v[104:107], a[68:71]
    v_mfma_f32_16x16x32_bf16 a[72:75], v[184:187], v[104:107], a[72:75]
    v_mfma_f32_16x16x32_bf16 a[76:79], v[188:191], v[104:107], a[76:79]
    v_mfma_f32_16x16x32_bf16 a[80:83], v[192:195], v[104:107], a[80:83]
    v_mfma_f32_16x16x32_bf16 a[84:87], v[196:199], v[104:107], a[84:87]
    v_mfma_f32_16x16x32_bf16 a[88:91], v[200:203], v[104:107], a[88:91]
    v_mfma_f32_16x16x32_bf16 a[92:95], v[204:207], v[104:107], a[92:95]
    v_mfma_f32_16x16x32_bf16 a[96:99], v[176:179], v[108:111], a[96:99]
    v_mfma_f32_16x16x32_bf16 a[100:103], v[180:183], v[108:111], a[100:103]
    v_mfma_f32_16x16x32_bf16 a[104:107], v[184:187], v[108:111], a[104:107]
    v_mfma_f32_16x16x32_bf16 a[108:111], v[188:191], v[108:111], a[108:111]
    v_mfma_f32_16x16x32_bf16 a[112:115], v[192:195], v[108:111], a[112:115]
    v_mfma_f32_16x16x32_bf16 a[116:119], v[196:199], v[108:111], a[116:119]
    v_mfma_f32_16x16x32_bf16 a[120:123], v[200:203], v[108:111], a[120:123]
    v_mfma_f32_16x16x32_bf16 a[124:127], v[204:207], v[108:111], a[124:127]
    s_waitcnt vmcnt(4)
    ds_read_b128 v[176:179], v9 offset:57344
    ds_read_b128 v[180:183], v9 offset:58368
    ds_read_b128 v[184:187], v9 offset:59392
    ds_read_b128 v[188:191], v9 offset:60416
    ds_read_b128 v[192:195], v9 offset:61440
    ds_read_b128 v[196:199], v9 offset:62464
    ds_read_b128 v[200:203], v9 offset:63488
    ds_read_b128 v[204:207], v9 offset:64512
    s_waitcnt lgkmcnt(8)
    v_mfma_f32_16x16x32_bf16 a[0:3], v[144:147], v[112:115], a[0:3]
    v_mfma_f32_16x16x32_bf16 a[4:7], v[148:151], v[112:115], a[4:7]
    v_mfma_f32_16x16x32_bf16 a[8:11], v[152:155], v[112:115], a[8:11]
    v_mfma_f32_16x16x32_bf16 a[12:15], v[156:159], v[112:115], a[12:15]
    v_mfma_f32_16x16x32_bf16 a[16:19], v[160:163], v[112:115], a[16:19]
    v_mfma_f32_16x16x32_bf16 a[20:23], v[164:167], v[112:115], a[20:23]
    v_mfma_f32_16x16x32_bf16 a[24:27], v[168:171], v[112:115], a[24:27]
    v_mfma_f32_16x16x32_bf16 a[28:31], v[172:175], v[112:115], a[28:31]
    v_mfma_f32_16x16x32_bf16 a[32:35], v[144:147], v[116:119], a[32:35]
    v_mfma_f32_16x16x32_bf16 a[36:39], v[148:151], v[116:119], a[36:39]
    v_mfma_f32_16x16x32_bf16 a[40:43], v[152:155], v[116:119], a[40:43]
    v_mfma_f32_16x16x32_bf16 a[44:47], v[156:159], v[116:119], a[44:47]
    v_mfma_f32_16x16x32_bf16 a[48:51], v[160:163], v[116:119], a[48:51]
    v_mfma_f32_16x16x32_bf16 a[52:55], v[164:167], v[116:119], a[52:55]
    v_mfma_f32_16x16x32_bf16 a[56:59], v[168:171], v[116:119], a[56:59]
    v_mfma_f32_16x16x32_bf16 a[60:63], v[172:175], v[116:119], a[60:63]
    v_mfma_f32_16x16x32_bf16 a[64:67], v[144:147], v[120:123], a[64:67]
    v_mfma_f32_16x16x32_bf16 a[68:71], v[148:151], v[120:123], a[68:71]
    v_mfma_f32_16x16x32_bf16 a[72:75], v[152:155], v[120:123], a[72:75]
    v_mfma_f32_16x16x32_bf16 a[76:79], v[156:159], v[120:123], a[76:79]
    v_mfma_f32_16x16x32_bf16 a[80:83], v[160:163], v[120:123], a[80:83]
    v_mfma_f32_16x16x32_bf16 a[84:87], v[164:167], v[120:123], a[84:87]
    v_mfma_f32_16x16x32_bf16 a[88:91], v[168:171], v[120:123], a[88:91]
    v_mfma_f32_16x16x32_bf16 a[92:95], v[172:175], v[120:123], a[92:95]
    v_mfma_f32_16x16x32_bf16 a[96:99], v[144:147], v[124:127], a[96:99]
    v_mfma_f32_16x16x32_bf16 a[100:103], v[148:151], v[124:127], a[100:103]
    v_mfma_f32_16x16x32_bf16 a[104:107], v[152:155], v[124:127], a[104:107]
    v_mfma_f32_16x16x32_bf16 a[108:111], v[156:159], v[124:127], a[108:111]
    v_mfma_f32_16x16x32_bf16 a[112:115], v[160:163], v[124:127], a[112:115]
    v_mfma_f32_16x16x32_bf16 a[116:119], v[164:167], v[124:127], a[116:119]
    v_mfma_f32_16x16x32_bf16 a[120:123], v[168:171], v[124:127], a[120:123]
    v_mfma_f32_16x16x32_bf16 a[124:127], v[172:175], v[124:127], a[124:127]
    s_waitcnt vmcnt(0)
    s_waitcnt lgkmcnt(0)
    v_mfma_f32_16x16x32_bf16 a[0:3], v[176:179], v[128:131], a[0:3]
    v_mfma_f32_16x16x32_bf16 a[4:7], v[180:183], v[128:131], a[4:7]
    v_mfma_f32_16x16x32_bf16 a[8:11], v[184:187], v[128:131], a[8:11]
    v_mfma_f32_16x16x32_bf16 a[12:15], v[188:191], v[128:131], a[12:15]
    v_mfma_f32_16x16x32_bf16 a[16:19], v[192:195], v[128:131], a[16:19]
    v_mfma_f32_16x16x32_bf16 a[20:23], v[196:199], v[128:131], a[20:23]
    v_mfma_f32_16x16x32_bf16 a[24:27], v[200:203], v[128:131], a[24:27]
    v_mfma_f32_16x16x32_bf16 a[28:31], v[204:207], v[128:131], a[28:31]
    v_mfma_f32_16x16x32_bf16 a[32:35], v[176:179], v[132:135], a[32:35]
    v_mfma_f32_16x16x32_bf16 a[36:39], v[180:183], v[132:135], a[36:39]
    v_mfma_f32_16x16x32_bf16 a[40:43], v[184:187], v[132:135], a[40:43]
    v_mfma_f32_16x16x32_bf16 a[44:47], v[188:191], v[132:135], a[44:47]
    v_mfma_f32_16x16x32_bf16 a[48:51], v[192:195], v[132:135], a[48:51]
    v_mfma_f32_16x16x32_bf16 a[52:55], v[196:199], v[132:135], a[52:55]
    v_mfma_f32_16x16x32_bf16 a[56:59], v[200:203], v[132:135], a[56:59]
    v_mfma_f32_16x16x32_bf16 a[60:63], v[204:207], v[132:135], a[60:63]
    v_mfma_f32_16x16x32_bf16 a[64:67], v[176:179], v[136:139], a[64:67]
    v_mfma_f32_16x16x32_bf16 a[68:71], v[180:183], v[136:139], a[68:71]
    v_mfma_f32_16x16x32_bf16 a[72:75], v[184:187], v[136:139], a[72:75]
    v_mfma_f32_16x16x32_bf16 a[76:79], v[188:191], v[136:139], a[76:79]
    v_mfma_f32_16x16x32_bf16 a[80:83], v[192:195], v[136:139], a[80:83]
    v_mfma_f32_16x16x32_bf16 a[84:87], v[196:199], v[136:139], a[84:87]
    v_mfma_f32_16x16x32_bf16 a[88:91], v[200:203], v[136:139], a[88:91]
    v_mfma_f32_16x16x32_bf16 a[92:95], v[204:207], v[136:139], a[92:95]
    v_mfma_f32_16x16x32_bf16 a[96:99], v[176:179], v[140:143], a[96:99]
    v_mfma_f32_16x16x32_bf16 a[100:103], v[180:183], v[140:143], a[100:103]
    v_mfma_f32_16x16x32_bf16 a[104:107], v[184:187], v[140:143], a[104:107]
    v_mfma_f32_16x16x32_bf16 a[108:111], v[188:191], v[140:143], a[108:111]
    v_mfma_f32_16x16x32_bf16 a[112:115], v[192:195], v[140:143], a[112:115]
    v_mfma_f32_16x16x32_bf16 a[116:119], v[196:199], v[140:143], a[116:119]
    v_mfma_f32_16x16x32_bf16 a[120:123], v[200:203], v[140:143], a[120:123]
    v_mfma_f32_16x16x32_bf16 a[124:127], v[204:207], v[140:143], a[124:127]
    s_nop 15
    v_accvgpr_read_b32 v16, a0
    v_accvgpr_read_b32 v17, a1
    v_accvgpr_read_b32 v18, a2
    v_accvgpr_read_b32 v19, a3
    v_accvgpr_read_b32 v20, a4
    v_accvgpr_read_b32 v21, a5
    v_accvgpr_read_b32 v22, a6
    v_accvgpr_read_b32 v23, a7
    v_accvgpr_read_b32 v24, a8
    v_accvgpr_read_b32 v25, a9
    v_accvgpr_read_b32 v26, a10
    v_accvgpr_read_b32 v27, a11
    v_accvgpr_read_b32 v28, a12
    v_accvgpr_read_b32 v29, a13
    v_accvgpr_read_b32 v30, a14
    v_accvgpr_read_b32 v31, a15
    v_accvgpr_read_b32 v32, a16
    v_accvgpr_read_b32 v33, a17
    v_accvgpr_read_b32 v34, a18
    v_accvgpr_read_b32 v35, a19
    v_accvgpr_read_b32 v36, a20
    v_accvgpr_read_b32 v37, a21
    v_accvgpr_read_b32 v38, a22
    v_accvgpr_read_b32 v39, a23
    v_accvgpr_read_b32 v40, a24
    v_accvgpr_read_b32 v41, a25
    v_accvgpr_read_b32 v42, a26
    v_accvgpr_read_b32 v43, a27
    v_accvgpr_read_b32 v44, a28
    v_accvgpr_read_b32 v45, a29
    v_accvgpr_read_b32 v46, a30
    v_accvgpr_read_b32 v47, a31
    v_accvgpr_read_b32 v48, a32
    v_accvgpr_read_b32 v49, a33
    v_accvgpr_read_b32 v50, a34
    v_accvgpr_read_b32 v51, a35
    v_accvgpr_read_b32 v52, a36
    v_accvgpr_read_b32 v53, a37
    v_accvgpr_read_b32 v54, a38
    v_accvgpr_read_b32 v55, a39
    v_accvgpr_read_b32 v56, a40
    v_accvgpr_read_b32 v57, a41
    v_accvgpr_read_b32 v58, a42
    v_accvgpr_read_b32 v59, a43
    v_accvgpr_read_b32 v60, a44
    v_accvgpr_read_b32 v61, a45
    v_accvgpr_read_b32 v62, a46
    v_accvgpr_read_b32 v63, a47
    v_accvgpr_read_b32 v64, a48
    v_accvgpr_read_b32 v65, a49
    v_accvgpr_read_b32 v66, a50
    v_accvgpr_read_b32 v67, a51
    v_accvgpr_read_b32 v68, a52
    v_accvgpr_read_b32 v69, a53
    v_accvgpr_read_b32 v70, a54
    v_accvgpr_read_b32 v71, a55
    v_accvgpr_read_b32 v72, a56
    v_accvgpr_read_b32 v73, a57
    v_accvgpr_read_b32 v74, a58
    v_accvgpr_read_b32 v75, a59
    v_accvgpr_read_b32 v76, a60
    v_accvgpr_read_b32 v77, a61
    v_accvgpr_read_b32 v78, a62
    v_accvgpr_read_b32 v79, a63
    v_accvgpr_read_b32 v80, a64
    v_accvgpr_read_b32 v81, a65
    v_accvgpr_read_b32 v82, a66
    v_accvgpr_read_b32 v83, a67
    v_accvgpr_read_b32 v84, a68
    v_accvgpr_read_b32 v85, a69
    v_accvgpr_read_b32 v86, a70
    v_accvgpr_read_b32 v87, a71
    v_accvgpr_read_b32 v88, a72
    v_accvgpr_read_b32 v89, a73
    v_accvgpr_read_b32 v90, a74
    v_accvgpr_read_b32 v91, a75
    v_accvgpr_read_b32 v92, a76
    v_accvgpr_read_b32 v93, a77
    v_accvgpr_read_b32 v94, a78
    v_accvgpr_read_b32 v95, a79
    v_accvgpr_read_b32 v96, a80
    v_accvgpr_read_b32 v97, a81
    v_accvgpr_read_b32 v98, a82
    v_accvgpr_read_b32 v99, a83
    v_accvgpr_read_b32 v100, a84
    v_accvgpr_read_b32 v101, a85
    v_accvgpr_read_b32 v102, a86
    v_accvgpr_read_b32 v103, a87
    v_accvgpr_read_b32 v104, a88
    v_accvgpr_read_b32 v105, a89
    v_accvgpr_read_b32 v106, a90
    v_accvgpr_read_b32 v107, a91
    v_accvgpr_read_b32 v108, a92
    v_accvgpr_read_b32 v109, a93
    v_accvgpr_read_b32 v110, a94
    v_accvgpr_read_b32 v111, a95
    v_accvgpr_read_b32 v112, a96
    v_accvgpr_read_b32 v113, a97
    v_accvgpr_read_b32 v114, a98
    v_accvgpr_read_b32 v115, a99
    v_accvgpr_read_b32 v116, a100
    v_accvgpr_read_b32 v117, a101
    v_accvgpr_read_b32 v118, a102
    v_accvgpr_read_b32 v119, a103
    v_accvgpr_read_b32 v120, a104
    v_accvgpr_read_b32 v121, a105
    v_accvgpr_read_b32 v122, a106
    v_accvgpr_read_b32 v123, a107
    v_accvgpr_read_b32 v124, a108
    v_accvgpr_read_b32 v125, a109
    v_accvgpr_read_b32 v126, a110
    v_accvgpr_read_b32 v127, a111
    v_accvgpr_read_b32 v128, a112
    v_accvgpr_read_b32 v129, a113
    v_accvgpr_read_b32 v130, a114
    v_accvgpr_read_b32 v131, a115
    v_accvgpr_read_b32 v132, a116
    v_accvgpr_read_b32 v133, a117
    v_accvgpr_read_b32 v134, a118
    v_accvgpr_read_b32 v135, a119
    v_accvgpr_read_b32 v136, a120
    v_accvgpr_read_b32 v137, a121
    v_accvgpr_read_b32 v138, a122
    v_accvgpr_read_b32 v139, a123
    v_accvgpr_read_b32 v140, a124
    v_accvgpr_read_b32 v141, a125
    v_accvgpr_read_b32 v142, a126
    v_accvgpr_read_b32 v143, a127
    s_lshl_b32 s15, s13, 24
    s_add_u32 s15, s15, 33554432
    s_lshl_b32 s16, s12, 14
    s_add_u32 s15, s15, s16
    s_lshl_b32 s16, s14, 19
    s_add_u32 s15, s15, s16
    s_add_u32 s20, s4, s15
    s_addc_u32 s21, s5, 0
    v_add_u32 v4, 0, v3
    v_add_u32 v5, 4096, v3
    v_cvt_pk_bf16_f32 v144, v16, v17
    v_cvt_pk_bf16_f32 v145, v18, v19
    v_cvt_pk_bf16_f32 v146, v20, v21
    v_cvt_pk_bf16_f32 v147, v22, v23
    global_store_dwordx4 v4, v[144:147], s[20:21] offset:0 sc1
    v_cvt_pk_bf16_f32 v148, v24, v25
    v_cvt_pk_bf16_f32 v149, v26, v27
    v_cvt_pk_bf16_f32 v150, v28, v29
    v_cvt_pk_bf16_f32 v151, v30, v31
    global_store_dwordx4 v4, v[148:151], s[20:21] offset:2048 sc1
    v_cvt_pk_bf16_f32 v152, v32, v33
    v_cvt_pk_bf16_f32 v153, v34, v35
    v_cvt_pk_bf16_f32 v154, v36, v37
    v_cvt_pk_bf16_f32 v155, v38, v39
    global_store_dwordx4 v5, v[152:155], s[20:21] offset:0 sc1
    v_cvt_pk_bf16_f32 v156, v40, v41
    v_cvt_pk_bf16_f32 v157, v42, v43
    v_cvt_pk_bf16_f32 v158, v44, v45
    v_cvt_pk_bf16_f32 v159, v46, v47
    global_store_dwordx4 v5, v[156:159], s[20:21] offset:2048 sc1
    s_nop 1
    v_add_u32 v4, 1024, v3
    v_add_u32 v5, 5120, v3
    v_cvt_pk_bf16_f32 v144, v48, v49
    v_cvt_pk_bf16_f32 v145, v50, v51
    v_cvt_pk_bf16_f32 v146, v52, v53
    v_cvt_pk_bf16_f32 v147, v54, v55
    global_store_dwordx4 v4, v[144:147], s[20:21] offset:0 sc1
    v_cvt_pk_bf16_f32 v148, v56, v57
    v_cvt_pk_bf16_f32 v149, v58, v59
    v_cvt_pk_bf16_f32 v150, v60, v61
    v_cvt_pk_bf16_f32 v151, v62, v63
    global_store_dwordx4 v4, v[148:151], s[20:21] offset:2048 sc1
    v_cvt_pk_bf16_f32 v152, v64, v65
    v_cvt_pk_bf16_f32 v153, v66, v67
    v_cvt_pk_bf16_f32 v154, v68, v69
    v_cvt_pk_bf16_f32 v155, v70, v71
    global_store_dwordx4 v5, v[152:155], s[20:21] offset:0 sc1
    v_cvt_pk_bf16_f32 v156, v72, v73
    v_cvt_pk_bf16_f32 v157, v74, v75
    v_cvt_pk_bf16_f32 v158, v76, v77
    v_cvt_pk_bf16_f32 v159, v78, v79
    global_store_dwordx4 v5, v[156:159], s[20:21] offset:2048 sc1
    s_nop 1
    v_add_u32 v4, 8192, v3
    v_add_u32 v5, 12288, v3
    v_cvt_pk_bf16_f32 v144, v80, v81
    v_cvt_pk_bf16_f32 v145, v82, v83
    v_cvt_pk_bf16_f32 v146, v84, v85
    v_cvt_pk_bf16_f32 v147, v86, v87
    global_store_dwordx4 v4, v[144:147], s[20:21] offset:0 sc1
    v_cvt_pk_bf16_f32 v148, v88, v89
    v_cvt_pk_bf16_f32 v149, v90, v91
    v_cvt_pk_bf16_f32 v150, v92, v93
    v_cvt_pk_bf16_f32 v151, v94, v95
    global_store_dwordx4 v4, v[148:151], s[20:21] offset:2048 sc1
    v_cvt_pk_bf16_f32 v152, v96, v97
    v_cvt_pk_bf16_f32 v153, v98, v99
    v_cvt_pk_bf16_f32 v154, v100, v101
    v_cvt_pk_bf16_f32 v155, v102, v103
    global_store_dwordx4 v5, v[152:155], s[20:21] offset:0 sc1
    v_cvt_pk_bf16_f32 v156, v104, v105
    v_cvt_pk_bf16_f32 v157, v106, v107
    v_cvt_pk_bf16_f32 v158, v108, v109
    v_cvt_pk_bf16_f32 v159, v110, v111
    global_store_dwordx4 v5, v[156:159], s[20:21] offset:2048 sc1
    s_nop 1
    v_add_u32 v4, 9216, v3
    v_add_u32 v5, 13312, v3
    v_cvt_pk_bf16_f32 v144, v112, v113
    v_cvt_pk_bf16_f32 v145, v114, v115
    v_cvt_pk_bf16_f32 v146, v116, v117
    v_cvt_pk_bf16_f32 v147, v118, v119
    global_store_dwordx4 v4, v[144:147], s[20:21] offset:0 sc1
    v_cvt_pk_bf16_f32 v148, v120, v121
    v_cvt_pk_bf16_f32 v149, v122, v123
    v_cvt_pk_bf16_f32 v150, v124, v125
    v_cvt_pk_bf16_f32 v151, v126, v127
    global_store_dwordx4 v4, v[148:151], s[20:21] offset:2048 sc1
    v_cvt_pk_bf16_f32 v152, v128, v129
    v_cvt_pk_bf16_f32 v153, v130, v131
    v_cvt_pk_bf16_f32 v154, v132, v133
    v_cvt_pk_bf16_f32 v155, v134, v135
    global_store_dwordx4 v5, v[152:155], s[20:21] offset:0 sc1
    v_cvt_pk_bf16_f32 v156, v136, v137
    v_cvt_pk_bf16_f32 v157, v138, v139
    v_cvt_pk_bf16_f32 v158, v140, v141
    v_cvt_pk_bf16_f32 v159, v142, v143
    global_store_dwordx4 v5, v[156:159], s[20:21] offset:2048 sc1
    s_nop 1
    s_branch WK_GEMM_FL
WKG_V:
    ds_read_b128 v[144:147], v3 offset:0
    ds_read_b128 v[148:151], v3 offset:1024
    ds_read_b128 v[152:155], v3 offset:2048
    ds_read_b128 v[156:159], v3 offset:3072
    ds_read_b128 v[160:163], v3 offset:4096
    ds_read_b128 v[164:167], v3 offset:5120
    ds_read_b128 v[168:171], v3 offset:6144
    ds_read_b128 v[172:175], v3 offset:7168
    s_waitcnt vmcnt(56)
    ds_read_b128 v[176:179], v3 offset:8192
    ds_read_b128 v[180:183], v3 offset:9216
    ds_read_b128 v[184:187], v3 offset:10240
    ds_read_b128 v[188:191], v3 offset:11264
    ds_read_b128 v[192:195], v3 offset:12288
    ds_read_b128 v[196:199], v3 offset:13312
    ds_read_b128 v[200:203], v3 offset:14336
    ds_read_b128 v[204:207], v3 offset:15360
    s_waitcnt lgkmcnt(8)
    v_mfma_f32_16x16x32_bf16 a[0:3], a[128:131], v[144:147], 0
    v_mfma_f32_16x16x32_bf16 a[4:7], a[128:131], v[148:151], 0
    v_mfma_f32_16x16x32_bf16 a[8:11], a[128:131], v[152:155], 0
    v_mfma_f32_16x16x32_bf16 a[12:15], a[128:131], v[156:159], 0
    v_mfma_f32_16x16x32_bf16 a[16:19], a[128:131], v[160:163], 0
    v_mfma_f32_16x16x32_bf16 a[20:23], a[128:131], v[164:167], 0
    v_mfma_f32_16x16x32_bf16 a[24:27], a[128:131], v[168:171], 0
    v_mfma_f32_16x16x32_bf16 a[28:31], a[128:131], v[172:175], 0
    v_mfma_f32_16x16x32_bf16 a[32:35], a[132:135], v[144:147], 0
    v_mfma_f32_16x16x32_bf16 a[36:39], a[132:135], v[148:151], 0
    v_mfma_f32_16x16x32_bf16 a[40:43], a[132:135], v[152:155], 0
    v_mfma_f32_16x16x32_bf16 a[44:47], a[132:135], v[156:159], 0
    v_mfma_f32_16x16x32_bf16 a[48:51], a[132:135], v[160:163], 0
    v_mfma_f32_16x16x32_bf16 a[52:55], a[132:135], v[164:167], 0
    v_mfma_f32_16x16x32_bf16 a[56:59], a[132:135], v[168:171], 0
    v_mfma_f32_16x16x32_bf16 a[60:63], a[132:135], v[172:175], 0
    v_mfma_f32_16x16x32_bf16 a[64:67], a[136:139], v[144:147], 0
    v_mfma_f32_16x16x32_bf16 a[68:71], a[136:139], v[148:151], 0
    v_mfma_f32_16x16x32_bf16 a[72:75], a[136:139], v[152:155], 0
    v_mfma_f32_16x16x32_bf16 a[76:79], a[136:139], v[156:159], 0
    v_mfma_f32_16x16x32_bf16 a[80:83], a[136:139], v[160:163], 0
    v_mfma_f32_16x16x32_bf16 a[84:87], a[136:139], v[164:167], 0
    v_mfma_f32_16x16x32_bf16 a[88:91], a[136:139], v[168:171], 0
    v_mfma_f32_16x16x32_bf16 a[92:95], a[136:139], v[172:175], 0
    v_mfma_f32_16x16x32_bf16 a[96:99], a[140:143], v[144:147], 0
    v_mfma_f32_16x16x32_bf16 a[100:103], a[140:143], v[148:151], 0
    v_mfma_f32_16x16x32_bf16 a[104:107], a[140:143], v[152:155], 0
    v_mfma_f32_16x16x32_bf16 a[108:111], a[140:143], v[156:159], 0
    v_mfma_f32_16x16x32_bf16 a[112:115], a[140:143], v[160:163], 0
    v_mfma_f32_16x16x32_bf16 a[116:119], a[140:143], v[164:167], 0
    v_mfma_f32_16x16x32_bf16 a[120:123], a[140:143], v[168:171], 0
    v_mfma_f32_16x16x32_bf16 a[124:127], a[140:143], v[172:175], 0
    global_load_dwordx4 v[128:131], v5, s[22:23] offset:3072
    global_load_dwordx4 v[132:135], v6, s[22:23] offset:3072
    global_load_dwordx4 v[136:139], v7, s[22:23] offset:3072
    global_load_dwordx4 v[140:143], v8, s[22:23] offset:3072
    s_waitcnt vmcnt(56)
    ds_read_b128 v[144:147], v3 offset:16384
    ds_read_b128 v[148:151], v3 offset:17408
    ds_read_b128 v[152:155], v3 offset:18432
    ds_read_b128 v[156:159], v3 offset:19456
    ds_read_b128 v[160:163], v3 offset:20480
    ds_read_b128 v[164:167], v3 offset:21504
    ds_read_b128 v[168:171], v3 offset:22528
    ds_read_b128 v[172:175], v3 offset:23552
    s_waitcnt lgkmcnt(8)
    v_mfma_f32_16x16x32_bf16 a[0:3], a[144:147], v[176:179], a[0:3]
    v_mfma_f32_16x16x32_bf16 a[4:7], a[144:147], v[180:183], a[4:7]
    v_mfma_f32_16x16x32_bf16 a[8:11], a[144:147], v[184:187], a[8:11]
    v_mfma_f32_16x16x32_bf16 a[12:15], a[144:147], v[188:191], a[12:15]
    v_mfma_f32_16x16x32_bf16 a[16:19], a[144:147], v[192:195], a[16:19]
    v_mfma_f32_16x16x32_bf16 a[20:23], a[144:147], v[196:199], a[20:23]
    v_mfma_f32_16x16x32_bf16 a[24:27], a[144:147], v[200:203], a[24:27]
    v_mfma_f32_16x16x32_bf16 a[28:31], a[144:147], v[204:207], a[28:31]
    v_mfma_f32_16x16x32_bf16 a[32:35], a[148:151], v[176:179], a[32:35]
    v_mfma_f32_16x16x32_bf16 a[36:39], a[148:151], v[180:183], a[36:39]
    v_mfma_f32_16x16x32_bf16 a[40:43], a[148:151], v[184:187], a[40:43]
    v_mfma_f32_16x16x32_bf16 a[44:47], a[148:151], v[188:191], a[44:47]
    v_mfma_f32_16x16x32_bf16 a[48:51], a[148:151], v[192:195], a[48:51]
    v_mfma_f32_16x16x32_bf16 a[52:55], a[148:151], v[196:199], a[52:55]
    v_mfma_f32_16x16x32_bf16 a[56:59], a[148:151], v[200:203], a[56:59]
    v_mfma_f32_16x16x32_bf16 a[60:63], a[148:151], v[204:207], a[60:63]
    v_mfma_f32_16x16x32_bf16 a[64:67], a[152:155], v[176:179], a[64:67]
    v_mfma_f32_16x16x32_bf16 a[68:71], a[152:155], v[180:183], a[68:71]
    v_mfma_f32_16x16x32_bf16 a[72:75], a[152:155], v[184:187], a[72:75]
    v_mfma_f32_16x16x32_bf16 a[76:79], a[152:155], v[188:191], a[76:79]
    v_mfma_f32_16x16x32_bf16 a[80:83], a[152:155], v[192:195], a[80:83]
    v_mfma_f32_16x16x32_bf16 a[84:87], a[152:155], v[196:199], a[84:87]
    v_mfma_f32_16x16x32_bf16 a[88:91], a[152:155], v[200:203], a[88:91]
    v_mfma_f32_16x16x32_bf16 a[92:95], a[152:155], v[204:207], a[92:95]
    v_mfma_f32_16x16x32_bf16 a[96:99], a[156:159], v[176:179], a[96:99]
    v_mfma_f32_16x16x32_bf16 a[100:103], a[156:159], v[180:183], a[100:103]
    v_mfma_f32_16x16x32_bf16 a[104:107], a[156:159], v[184:187], a[104:107]
    v_mfma_f32_16x16x32_bf16 a[108:111], a[156:159], v[188:191], a[108:111]
    v_mfma_f32_16x16x32_bf16 a[112:115], a[156:159], v[192:195], a[112:115]
    v_mfma_f32_16x16x32_bf16 a[116:119], a[156:159], v[196:199], a[116:119]
    v_mfma_f32_16x16x32_bf16 a[120:123], a[156:159], v[200:203], a[120:123]
    v_mfma_f32_16x16x32_bf16 a[124:127], a[156:159], v[204:207], a[124:127]
    s_waitcnt vmcnt(52)
    ds_read_b128 v[176:179], v3 offset:24576
    ds_read_b128 v[180:183], v3 offset:25600
    ds_read_b128 v[184:187], v3 offset:26624
    ds_read_b128 v[188:191], v3 offset:27648
    ds_read_b128 v[192:195], v3 offset:28672
    ds_read_b128 v[196:199], v3 offset:29696
    ds_read_b128 v[200:203], v3 offset:30720
    ds_read_b128 v[204:207], v3 offset:31744
    s_waitcnt lgkmcnt(8)
    v_mfma_f32_16x16x32_bf16 a[0:3], a[160:163], v[144:147], a[0:3]
    v_mfma_f32_16x16x32_bf16 a[4:7], a[160:163], v[148:151], a[4:7]
    v_mfma_f32_16x16x32_bf16 a[8:11], a[160:163], v[152:155], a[8:11]
    v_mfma_f32_16x16x32_bf16 a[12:15], a[160:163], v[156:159], a[12:15]
    v_mfma_f32_16x16x32_bf16 a[16:19], a[160:163], v[160:163], a[16:19]
    v_mfma_f32_16x16x32_bf16 a[20:23], a[160:163], v[164:167], a[20:23]
    v_mfma_f32_16x16x32_bf16 a[24:27], a[160:163], v[168:171], a[24:27]
    v_mfma_f32_16x16x32_bf16 a[28:31], a[160:163], v[172:175], a[28:31]
    v_mfma_f32_16x16x32_bf16 a[32:35], a[164:167], v[144:147], a[32:35]
    v_mfma_f32_16x16x32_bf16 a[36:39], a[164:167], v[148:151], a[36:39]
    v_mfma_f32_16x16x32_bf16 a[40:43], a[164:167], v[152:155], a[40:43]
    v_mfma_f32_16x16x32_bf16 a[44:47], a[164:167], v[156:159], a[44:47]
    v_mfma_f32_16x16x32_bf16 a[48:51], a[164:167], v[160:163], a[48:51]
    v_mfma_f32_16x16x32_bf16 a[52:55], a[164:167], v[164:167], a[52:55]
    v_mfma_f32_16x16x32_bf16 a[56:59], a[164:167], v[168:171], a[56:59]
    v_mfma_f32_16x16x32_bf16 a[60:63], a[164:167], v[172:175], a[60:63]
    v_mfma_f32_16x16x32_bf16 a[64:67], a[168:171], v[144:147], a[64:67]
    v_mfma_f32_16x16x32_bf16 a[68:71], a[168:171], v[148:151], a[68:71]
    v_mfma_f32_16x16x32_bf16 a[72:75], a[168:171], v[152:155], a[72:75]
    v_mfma_f32_16x16x32_bf16 a[76:79], a[168:171], v[156:159], a[76:79]
    v_mfma_f32_16x16x32_bf16 a[80:83], a[168:171], v[160:163], a[80:83]
    v_mfma_f32_16x16x32_bf16 a[84:87], a[168:171], v[164:167], a[84:87]
    v_mfma_f32_16x16x32_bf16 a[88:91], a[168:171], v[168:171], a[88:91]
    v_mfma_f32_16x16x32_bf16 a[92:95], a[168:171], v[172:175], a[92:95]
    v_mfma_f32_16x16x32_bf16 a[96:99], a[172:175], v[144:147], a[96:99]
    v_mfma_f32_16x16x32_bf16 a[100:103], a[172:175], v[148:151], a[100:103]
    v_mfma_f32_16x16x32_bf16 a[104:107], a[172:175], v[152:155], a[104:107]
    v_mfma_f32_16x16x32_bf16 a[108:111], a[172:175], v[156:159], a[108:111]
    v_mfma_f32_16x16x32_bf16 a[112:115], a[172:175], v[160:163], a[112:115]
    v_mfma_f32_16x16x32_bf16 a[116:119], a[172:175], v[164:167], a[116:119]
    v_mfma_f32_16x16x32_bf16 a[120:123], a[172:175], v[168:171], a[120:123]
    v_mfma_f32_16x16x32_bf16 a[124:127], a[172:175], v[172:175], a[124:127]
    s_waitcnt vmcnt(48)
    ds_read_b128 v[144:147], v3 offset:32768
    ds_read_b128 v[148:151], v3 offset:33792
    ds_read_b128 v[152:155], v3 offset:34816
    ds_read_b128 v[156:159], v3 offset:35840
    ds_read_b128 v[160:163], v3 offset:36864
    ds_read_b128 v[164:167], v3 offset:37888
    ds_read_b128 v[168:171], v3 offset:38912
    ds_read_b128 v[172:175], v3 offset:39936
    s_waitcnt lgkmcnt(8)
    v_mfma_f32_16x16x32_bf16 a[0:3], a[176:179], v[176:179], a[0:3]
    v_mfma_f32_16x16x32_bf16 a[4:7], a[176:179], v[180:183], a[4:7]
    v_mfma_f32_16x16x32_bf16 a[8:11], a[176:179], v[184:187], a[8:11]
    v_mfma_f32_16x16x32_bf16 a[12:15], a[176:179], v[188:191], a[12:15]
    v_mfma_f32_16x16x32_bf16 a[16:19], a[176:179], v[192:195], a[16:19]
    v_mfma_f32_16x16x32_bf16 a[20:23], a[176:179], v[196:199], a[20:23]
    v_mfma_f32_16x16x32_bf16 a[24:27], a[176:179], v[200:203], a[24:27]
    v_mfma_f32_16x16x32_bf16 a[28:31], a[176:179], v[204:207], a[28:31]
    v_mfma_f32_16x16x32_bf16 a[32:35], a[180:183], v[176:179], a[32:35]
    v_mfma_f32_16x16x32_bf16 a[36:39], a[180:183], v[180:183], a[36:39]
    v_mfma_f32_16x16x32_bf16 a[40:43], a[180:183], v[184:187], a[40:43]
    v_mfma_f32_16x16x32_bf16 a[44:47], a[180:183], v[188:191], a[44:47]
    v_mfma_f32_16x16x32_bf16 a[48:51], a[180:183], v[192:195], a[48:51]
    v_mfma_f32_16x16x32_bf16 a[52:55], a[180:183], v[196:199], a[52:55]
    v_mfma_f32_16x16x32_bf16 a[56:59], a[180:183], v[200:203], a[56:59]
    v_mfma_f32_16x16x32_bf16 a[60:63], a[180:183], v[204:207], a[60:63]
    v_mfma_f32_16x16x32_bf16 a[64:67], a[184:187], v[176:179], a[64:67]
    v_mfma_f32_16x16x32_bf16 a[68:71], a[184:187], v[180:183], a[68:71]
    v_mfma_f32_16x16x32_bf16 a[72:75], a[184:187], v[184:187], a[72:75]
    v_mfma_f32_16x16x32_bf16 a[76:79], a[184:187], v[188:191], a[76:79]
    v_mfma_f32_16x16x32_bf16 a[80:83], a[184:187], v[192:195], a[80:83]
    v_mfma_f32_16x16x32_bf16 a[84:87], a[184:187], v[196:199], a[84:87]
    v_mfma_f32_16x16x32_bf16 a[88:91], a[184:187], v[200:203], a[88:91]
    v_mfma_f32_16x16x32_bf16 a[92:95], a[184:187], v[204:207], a[92:95]
    v_mfma_f32_16x16x32_bf16 a[96:99], a[188:191], v[176:179], a[96:99]
    v_mfma_f32_16x16x32_bf16 a[100:103], a[188:191], v[180:183], a[100:103]
    v_mfma_f32_16x16x32_bf16 a[104:107], a[188:191], v[184:187], a[104:107]
    v_mfma_f32_16x16x32_bf16 a[108:111], a[188:191], v[188:191], a[108:111]
    v_mfma_f32_16x16x32_bf16 a[112:115], a[188:191], v[192:195], a[112:115]
    v_mfma_f32_16x16x32_bf16 a[116:119], a[188:191], v[196:199], a[116:119]
    v_mfma_f32_16x16x32_bf16 a[120:123], a[188:191], v[200:203], a[120:123]
    v_mfma_f32_16x16x32_bf16 a[124:127], a[188:191], v[204:207], a[124:127]
    s_waitcnt vmcnt(44)
    ds_read_b128 v[176:179], v3 offset:40960
    ds_read_b128 v[180:183], v3 offset:41984
    ds_read_b128 v[184:187], v3 offset:43008
    ds_read_b128 v[188:191], v3 offset:44032
    ds_read_b128 v[192:195], v3 offset:45056
    ds_read_b128 v[196:199], v3 offset:46080
    ds_read_b128 v[200:203], v3 offset:47104
    ds_read_b128 v[204:207], v3 offset:48128
    s_waitcnt lgkmcnt(8)
    v_mfma_f32_16x16x32_bf16 a[0:3], a[192:195], v[144:147], a[0:3]
    v_mfma_f32_16x16x32_bf16 a[4:7], a[192:195], v[148:151], a[4:7]
    v_mfma_f32_16x16x32_bf16 a[8:11], a[192:195], v[152:155], a[8:11]
    v_mfma_f32_16x16x32_bf16 a[12:15], a[192:195], v[156:159], a[12:15]
    v_mfma_f32_16x16x32_bf16 a[16:19], a[192:195], v[160:163], a[16:19]
    v_mfma_f32_16x16x32_bf16 a[20:23], a[192:195], v[164:167], a[20:23]
    v_mfma_f32_16x16x32_bf16 a[24:27], a[192:195], v[168:171], a[24:27]
    v_mfma_f32_16x16x32_bf16 a[28:31], a[192:195], v[172:175], a[28:31]
    v_mfma_f32_16x16x32_bf16 a[32:35], a[196:199], v[144:147], a[32:35]
    v_mfma_f32_16x16x32_bf16 a[36:39], a[196:199], v[148:151], a[36:39]
    v_mfma_f32_16x16x32_bf16 a[40:43], a[196:199], v[152:155], a[40:43]
    v_mfma_f32_16x16x32_bf16 a[44:47], a[196:199], v[156:159], a[44:47]
    v_mfma_f32_16x16x32_bf16 a[48:51], a[196:199], v[160:163], a[48:51]
    v_mfma_f32_16x16x32_bf16 a[52:55], a[196:199], v[164:167], a[52:55]
    v_mfma_f32_16x16x32_bf16 a[56:59], a[196:199], v[168:171], a[56:59]
    v_mfma_f32_16x16x32_bf16 a[60:63], a[196:199], v[172:175], a[60:63]
    v_mfma_f32_16x16x32_bf16 a[64:67], a[200:203], v[144:147], a[64:67]
    v_mfma_f32_16x16x32_bf16 a[68:71], a[200:203], v[148:151], a[68:71]
    v_mfma_f32_16x16x32_bf16 a[72:75], a[200:203], v[152:155], a[72:75]
    v_mfma_f32_16x16x32_bf16 a[76:79], a[200:203], v[156:159], a[76:79]
    v_mfma_f32_16x16x32_bf16 a[80:83], a[200:203], v[160:163], a[80:83]
    v_mfma_f32_16x16x32_bf16 a[84:87], a[200:203], v[164:167], a[84:87]
    v_mfma_f32_16x16x32_bf16 a[88:91], a[200:203], v[168:171], a[88:91]
    v_mfma_f32_16x16x32_bf16 a[92:95], a[200:203], v[172:175], a[92:95]
    v_mfma_f32_16x16x32_bf16 a[96:99], a[204:207], v[144:147], a[96:99]
    v_mfma_f32_16x16x32_bf16 a[100:103], a[204:207], v[148:151], a[100:103]
    v_mfma_f32_16x16x32_bf16 a[104:107], a[204:207], v[152:155], a[104:107]
    v_mfma_f32_16x16x32_bf16 a[108:111], a[204:207], v[156:159], a[108:111]
    v_mfma_f32_16x16x32_bf16 a[112:115], a[204:207], v[160:163], a[112:115]
    v_mfma_f32_16x16x32_bf16 a[116:119], a[204:207], v[164:167], a[116:119]
    v_mfma_f32_16x16x32_bf16 a[120:123], a[204:207], v[168:171], a[120:123]
    v_mfma_f32_16x16x32_bf16 a[124:127], a[204:207], v[172:175], a[124:127]
    s_waitcnt vmcnt(40)
    ds_read_b128 v[144:147], v3 offset:49152
    ds_read_b128 v[148:151], v3 offset:50176
    ds_read_b128 v[152:155], v3 offset:51200
    ds_read_b128 v[156:159], v3 offset:52224
    ds_read_b128 v[160:163], v3 offset:53248
    ds_read_b128 v[164:167], v3 offset:54272
    ds_read_b128 v[168:171], v3 offset:55296
    ds_read_b128 v[172:175], v3 offset:56320
    s_waitcnt lgkmcnt(8)
    v_mfma_f32_16x16x32_bf16 a[0:3], a[208:211], v[176:179], a[0:3]
    v_mfma_f32_16x16x32_bf16 a[4:7], a[208:211], v[180:183], a[4:7]
    v_mfma_f32_16x16x32_bf16 a[8:11], a[208:211], v[184:187], a[8:11]
    v_mfma_f32_16x16x32_bf16 a[12:15], a[208:211], v[188:191], a[12:15]
    v_mfma_f32_16x16x32_bf16 a[16:19], a[208:211], v[192:195], a[16:19]
    v_mfma_f32_16x16x32_bf16 a[20:23], a[208:211], v[196:199], a[20:23]
    v_mfma_f32_16x16x32_bf16 a[24:27], a[208:211], v[200:203], a[24:27]
    v_mfma_f32_16x16x32_bf16 a[28:31], a[208:211], v[204:207], a[28:31]
    v_mfma_f32_16x16x32_bf16 a[32:35], a[212:215], v[176:179], a[32:35]
    v_mfma_f32_16x16x32_bf16 a[36:39], a[212:215], v[180:183], a[36:39]
    v_mfma_f32_16x16x32_bf16 a[40:43], a[212:215], v[184:187], a[40:43]
    v_mfma_f32_16x16x32_bf16 a[44:47], a[212:215], v[188:191], a[44:47]
    v_mfma_f32_16x16x32_bf16 a[48:51], a[212:215], v[192:195], a[48:51]
    v_mfma_f32_16x16x32_bf16 a[52:55], a[212:215], v[196:199], a[52:55]
    v_mfma_f32_16x16x32_bf16 a[56:59], a[212:215], v[200:203], a[56:59]
    v_mfma_f32_16x16x32_bf16 a[60:63], a[212:215], v[204:207], a[60:63]
    v_mfma_f32_16x16x32_bf16 a[64:67], a[216:219], v[176:179], a[64:67]
    v_mfma_f32_16x16x32_bf16 a[68:71], a[216:219], v[180:183], a[68:71]
    v_mfma_f32_16x16x32_bf16 a[72:75], a[216:219], v[184:187], a[72:75]
    v_mfma_f32_16x16x32_bf16 a[76:79], a[216:219], v[188:191], a[76:79]
    v_mfma_f32_16x16x32_bf16 a[80:83], a[216:219], v[192:195], a[80:83]
    v_mfma_f32_16x16x32_bf16 a[84:87], a[216:219], v[196:199], a[84:87]
    v_mfma_f32_16x16x32_bf16 a[88:91], a[216:219], v[200:203], a[88:91]
    v_mfma_f32_16x16x32_bf16 a[92:95], a[216:219], v[204:207], a[92:95]
    v_mfma_f32_16x16x32_bf16 a[96:99], a[220:223], v[176:179], a[96:99]
    v_mfma_f32_16x16x32_bf16 a[100:103], a[220:223], v[180:183], a[100:103]
    v_mfma_f32_16x16x32_bf16 a[104:107], a[220:223], v[184:187], a[104:107]
    v_mfma_f32_16x16x32_bf16 a[108:111], a[220:223], v[188:191], a[108:111]
    v_mfma_f32_16x16x32_bf16 a[112:115], a[220:223], v[192:195], a[112:115]
    v_mfma_f32_16x16x32_bf16 a[116:119], a[220:223], v[196:199], a[116:119]
    v_mfma_f32_16x16x32_bf16 a[120:123], a[220:223], v[200:203], a[120:123]
    v_mfma_f32_16x16x32_bf16 a[124:127], a[220:223], v[204:207], a[124:127]
    s_waitcnt vmcnt(36)
    ds_read_b128 v[176:179], v3 offset:57344
    ds_read_b128 v[180:183], v3 offset:58368
    ds_read_b128 v[184:187], v3 offset:59392
    ds_read_b128 v[188:191], v3 offset:60416
    ds_read_b128 v[192:195], v3 offset:61440
    ds_read_b128 v[196:199], v3 offset:62464
    ds_read_b128 v[200:203], v3 offset:63488
    ds_read_b128 v[204:207], v3 offset:64512
    s_waitcnt lgkmcnt(8)
    v_mfma_f32_16x16x32_bf16 a[0:3], a[224:227], v[144:147], a[0:3]
    v_mfma_f32_16x16x32_bf16 a[4:7], a[224:227], v[148:151], a[4:7]
    v_mfma_f32_16x16x32_bf16 a[8:11], a[224:227], v[152:155], a[8:11]
    v_mfma_f32_16x16x32_bf16 a[12:15], a[224:227], v[156:159], a[12:15]
    v_mfma_f32_16x16x32_bf16 a[16:19], a[224:227], v[160:163], a[16:19]
    v_mfma_f32_16x16x32_bf16 a[20:23], a[224:227], v[164:167], a[20:23]
    v_mfma_f32_16x16x32_bf16 a[24:27], a[224:227], v[168:171], a[24:27]
    v_mfma_f32_16x16x32_bf16 a[28:31], a[224:227], v[172:175], a[28:31]
    v_mfma_f32_16x16x32_bf16 a[32:35], a[228:231], v[144:147], a[32:35]
    v_mfma_f32_16x16x32_bf16 a[36:39], a[228:231], v[148:151], a[36:39]
    v_mfma_f32_16x16x32_bf16 a[40:43], a[228:231], v[152:155], a[40:43]
    v_mfma_f32_16x16x32_bf16 a[44:47], a[228:231], v[156:159], a[44:47]
    v_mfma_f32_16x16x32_bf16 a[48:51], a[228:231], v[160:163], a[48:51]
    v_mfma_f32_16x16x32_bf16 a[52:55], a[228:231], v[164:167], a[52:55]
    v_mfma_f32_16x16x32_bf16 a[56:59], a[228:231], v[168:171], a[56:59]
    v_mfma_f32_16x16x32_bf16 a[60:63], a[228:231], v[172:175], a[60:63]
    v_mfma_f32_16x16x32_bf16 a[64:67], a[232:235], v[144:147], a[64:67]
    v_mfma_f32_16x16x32_bf16 a[68:71], a[232:235], v[148:151], a[68:71]
    v_mfma_f32_16x16x32_bf16 a[72:75], a[232:235], v[152:155], a[72:75]
    v_mfma_f32_16x16x32_bf16 a[76:79], a[232:235], v[156:159], a[76:79]
    v_mfma_f32_16x16x32_bf16 a[80:83], a[232:235], v[160:163], a[80:83]
    v_mfma_f32_16x16x32_bf16 a[84:87], a[232:235], v[164:167], a[84:87]
    v_mfma_f32_16x16x32_bf16 a[88:91], a[232:235], v[168:171], a[88:91]
    v_mfma_f32_16x16x32_bf16 a[92:95], a[232:235], v[172:175], a[92:95]
    v_mfma_f32_16x16x32_bf16 a[96:99], a[236:239], v[144:147], a[96:99]
    v_mfma_f32_16x16x32_bf16 a[100:103], a[236:239], v[148:151], a[100:103]
    v_mfma_f32_16x16x32_bf16 a[104:107], a[236:239], v[152:155], a[104:107]
    v_mfma_f32_16x16x32_bf16 a[108:111], a[236:239], v[156:159], a[108:111]
    v_mfma_f32_16x16x32_bf16 a[112:115], a[236:239], v[160:163], a[112:115]
    v_mfma_f32_16x16x32_bf16 a[116:119], a[236:239], v[164:167], a[116:119]
    v_mfma_f32_16x16x32_bf16 a[120:123], a[236:239], v[168:171], a[120:123]
    v_mfma_f32_16x16x32_bf16 a[124:127], a[236:239], v[172:175], a[124:127]
    s_waitcnt vmcnt(32)
    ds_read_b128 v[144:147], v9 offset:0
    ds_read_b128 v[148:151], v9 offset:1024
    ds_read_b128 v[152:155], v9 offset:2048
    ds_read_b128 v[156:159], v9 offset:3072
    ds_read_b128 v[160:163], v9 offset:4096
    ds_read_b128 v[164:167], v9 offset:5120
    ds_read_b128 v[168:171], v9 offset:6144
    ds_read_b128 v[172:175], v9 offset:7168
    s_waitcnt lgkmcnt(8)
    v_mfma_f32_16x16x32_bf16 a[0:3], a[240:243], v[176:179], a[0:3]
    v_mfma_f32_16x16x32_bf16 a[4:7], a[240:243], v[180:183], a[4:7]
    v_mfma_f32_16x16x32_bf16 a[8:11], a[240:243], v[184:187], a[8:11]
    v_mfma_f32_16x16x32_bf16 a[12:15], a[240:243], v[188:191], a[12:15]
    v_mfma_f32_16x16x32_bf16 a[16:19], a[240:243], v[192:195], a[16:19]
    v_mfma_f32_16x16x32_bf16 a[20:23], a[240:243], v[196:199], a[20:23]
    v_mfma_f32_16x16x32_bf16 a[24:27], a[240:243], v[200:203], a[24:27]
    v_mfma_f32_16x16x32_bf16 a[28:31], a[240:243], v[204:207], a[28:31]
    v_mfma_f32_16x16x32_bf16 a[32:35], a[244:247], v[176:179], a[32:35]
    v_mfma_f32_16x16x32_bf16 a[36:39], a[244:247], v[180:183], a[36:39]
    v_mfma_f32_16x16x32_bf16 a[40:43], a[244:247], v[184:187], a[40:43]
    v_mfma_f32_16x16x32_bf16 a[44:47], a[244:247], v[188:191], a[44:47]
    v_mfma_f32_16x16x32_bf16 a[48:51], a[244:247], v[192:195], a[48:51]
    v_mfma_f32_16x16x32_bf16 a[52:55], a[244:247], v[196:199], a[52:55]
    v_mfma_f32_16x16x32_bf16 a[56:59], a[244:247], v[200:203], a[56:59]
    v_mfma_f32_16x16x32_bf16 a[60:63], a[244:247], v[204:207], a[60:63]
    v_mfma_f32_16x16x32_bf16 a[64:67], a[248:251], v[176:179], a[64:67]
    v_mfma_f32_16x16x32_bf16 a[68:71], a[248:251], v[180:183], a[68:71]
    v_mfma_f32_16x16x32_bf16 a[72:75], a[248:251], v[184:187], a[72:75]
    v_mfma_f32_16x16x32_bf16 a[76:79], a[248:251], v[188:191], a[76:79]
    v_mfma_f32_16x16x32_bf16 a[80:83], a[248:251], v[192:195], a[80:83]
    v_mfma_f32_16x16x32_bf16 a[84:87], a[248:251], v[196:199], a[84:87]
    v_mfma_f32_16x16x32_bf16 a[88:91], a[248:251], v[200:203], a[88:91]
    v_mfma_f32_16x16x32_bf16 a[92:95], a[248:251], v[204:207], a[92:95]
    v_mfma_f32_16x16x32_bf16 a[96:99], a[252:255], v[176:179], a[96:99]
    v_mfma_f32_16x16x32_bf16 a[100:103], a[252:255], v[180:183], a[100:103]
    v_mfma_f32_16x16x32_bf16 a[104:107], a[252:255], v[184:187], a[104:107]
    v_mfma_f32_16x16x32_bf16 a[108:111], a[252:255], v[188:191], a[108:111]
    v_mfma_f32_16x16x32_bf16 a[112:115], a[252:255], v[192:195], a[112:115]
    v_mfma_f32_16x16x32_bf16 a[116:119], a[252:255], v[196:199], a[116:119]
    v_mfma_f32_16x16x32_bf16 a[120:123], a[252:255], v[200:203], a[120:123]
    v_mfma_f32_16x16x32_bf16 a[124:127], a[252:255], v[204:207], a[124:127]
    s_waitcnt vmcnt(28)
    ds_read_b128 v[176:179], v9 offset:8192
    ds_read_b128 v[180:183], v9 offset:9216
    ds_read_b128 v[184:187], v9 offset:10240
    ds_read_b128 v[188:191], v9 offset:11264
    ds_read_b128 v[192:195], v9 offset:12288
    ds_read_b128 v[196:199], v9 offset:13312
    ds_read_b128 v[200:203], v9 offset:14336
    ds_read_b128 v[204:207], v9 offset:15360
    s_waitcnt lgkmcnt(8)
    v_mfma_f32_16x16x32_bf16 a[0:3], v[16:19], v[144:147], a[0:3]
    v_mfma_f32_16x16x32_bf16 a[4:7], v[16:19], v[148:151], a[4:7]
    v_mfma_f32_16x16x32_bf16 a[8:11], v[16:19], v[152:155], a[8:11]
    v_mfma_f32_16x16x32_bf16 a[12:15], v[16:19], v[156:159], a[12:15]
    v_mfma_f32_16x16x32_bf16 a[16:19], v[16:19], v[160:163], a[16:19]
    v_mfma_f32_16x16x32_bf16 a[20:23], v[16:19], v[164:167], a[20:23]
    v_mfma_f32_16x16x32_bf16 a[24:27], v[16:19], v[168:171], a[24:27]
    v_mfma_f32_16x16x32_bf16 a[28:31], v[16:19], v[172:175], a[28:31]
    v_mfma_f32_16x16x32_bf16 a[32:35], v[20:23], v[144:147], a[32:35]
    v_mfma_f32_16x16x32_bf16 a[36:39], v[20:23], v[148:151], a[36:39]
    v_mfma_f32_16x16x32_bf16 a[40:43], v[20:23], v[152:155], a[40:43]
    v_mfma_f32_16x16x32_bf16 a[44:47], v[20:23], v[156:159], a[44:47]
    v_mfma_f32_16x16x32_bf16 a[48:51], v[20:23], v[160:163], a[48:51]
    v_mfma_f32_16x16x32_bf16 a[52:55], v[20:23], v[164:167], a[52:55]
    v_mfma_f32_16x16x32_bf16 a[56:59], v[20:23], v[168:171], a[56:59]
    v_mfma_f32_16x16x32_bf16 a[60:63], v[20:23], v[172:175], a[60:63]
    v_mfma_f32_16x16x32_bf16 a[64:67], v[24:27], v[144:147], a[64:67]
    v_mfma_f32_16x16x32_bf16 a[68:71], v[24:27], v[148:151], a[68:71]
    v_mfma_f32_16x16x32_bf16 a[72:75], v[24:27], v[152:155], a[72:75]
    v_mfma_f32_16x16x32_bf16 a[76:79], v[24:27], v[156:159], a[76:79]
    v_mfma_f32_16x16x32_bf16 a[80:83], v[24:27], v[160:163], a[80:83]
    v_mfma_f32_16x16x32_bf16 a[84:87], v[24:27], v[164:167], a[84:87]
    v_mfma_f32_16x16x32_bf16 a[88:91], v[24:27], v[168:171], a[88:91]
    v_mfma_f32_16x16x32_bf16 a[92:95], v[24:27], v[172:175], a[92:95]
    v_mfma_f32_16x16x32_bf16 a[96:99], v[28:31], v[144:147], a[96:99]
    v_mfma_f32_16x16x32_bf16 a[100:103], v[28:31], v[148:151], a[100:103]
    v_mfma_f32_16x16x32_bf16 a[104:107], v[28:31], v[152:155], a[104:107]
    v_mfma_f32_16x16x32_bf16 a[108:111], v[28:31], v[156:159], a[108:111]
    v_mfma_f32_16x16x32_bf16 a[112:115], v[28:31], v[160:163], a[112:115]
    v_mfma_f32_16x16x32_bf16 a[116:119], v[28:31], v[164:167], a[116:119]
    v_mfma_f32_16x16x32_bf16 a[120:123], v[28:31], v[168:171], a[120:123]
    v_mfma_f32_16x16x32_bf16 a[124:127], v[28:31], v[172:175], a[124:127]
    s_waitcnt vmcnt(24)
    ds_read_b128 v[144:147], v9 offset:16384
    ds_read_b128 v[148:151], v9 offset:17408
    ds_read_b128 v[152:155], v9 offset:18432
    ds_read_b128 v[156:159], v9 offset:19456
    ds_read_b128 v[160:163], v9 offset:20480
    ds_read_b128 v[164:167], v9 offset:21504
    ds_read_b128 v[168:171], v9 offset:22528
    ds_read_b128 v[172:175], v9 offset:23552
    s_waitcnt lgkmcnt(8)
    v_mfma_f32_16x16x32_bf16 a[0:3], v[32:35], v[176:179], a[0:3]
    v_mfma_f32_16x16x32_bf16 a[4:7], v[32:35], v[180:183], a[4:7]
    v_mfma_f32_16x16x32_bf16 a[8:11], v[32:35], v[184:187], a[8:11]
    v_mfma_f32_16x16x32_bf16 a[12:15], v[32:35], v[188:191], a[12:15]
    v_mfma_f32_16x16x32_bf16 a[16:19], v[32:35], v[192:195], a[16:19]
    v_mfma_f32_16x16x32_bf16 a[20:23], v[32:35], v[196:199], a[20:23]
    v_mfma_f32_16x16x32_bf16 a[24:27], v[32:35], v[200:203], a[24:27]
    v_mfma_f32_16x16x32_bf16 a[28:31], v[32:35], v[204:207], a[28:31]
    v_mfma_f32_16x16x32_bf16 a[32:35], v[36:39], v[176:179], a[32:35]
    v_mfma_f32_16x16x32_bf16 a[36:39], v[36:39], v[180:183], a[36:39]
    v_mfma_f32_16x16x32_bf16 a[40:43], v[36:39], v[184:187], a[40:43]
    v_mfma_f32_16x16x32_bf16 a[44:47], v[36:39], v[188:191], a[44:47]
    v_mfma_f32_16x16x32_bf16 a[48:51], v[36:39], v[192:195], a[48:51]
    v_mfma_f32_16x16x32_bf16 a[52:55], v[36:39], v[196:199], a[52:55]
    v_mfma_f32_16x16x32_bf16 a[56:59], v[36:39], v[200:203], a[56:59]
    v_mfma_f32_16x16x32_bf16 a[60:63], v[36:39], v[204:207], a[60:63]
    v_mfma_f32_16x16x32_bf16 a[64:67], v[40:43], v[176:179], a[64:67]
    v_mfma_f32_16x16x32_bf16 a[68:71], v[40:43], v[180:183], a[68:71]
    v_mfma_f32_16x16x32_bf16 a[72:75], v[40:43], v[184:187], a[72:75]
    v_mfma_f32_16x16x32_bf16 a[76:79], v[40:43], v[188:191], a[76:79]
    v_mfma_f32_16x16x32_bf16 a[80:83], v[40:43], v[192:195], a[80:83]
    v_mfma_f32_16x16x32_bf16 a[84:87], v[40:43], v[196:199], a[84:87]
    v_mfma_f32_16x16x32_bf16 a[88:91], v[40:43], v[200:203], a[88:91]
    v_mfma_f32_16x16x32_bf16 a[92:95], v[40:43], v[204:207], a[92:95]
    v_mfma_f32_16x16x32_bf16 a[96:99], v[44:47], v[176:179], a[96:99]
    v_mfma_f32_16x16x32_bf16 a[100:103], v[44:47], v[180:183], a[100:103]
    v_mfma_f32_16x16x32_bf16 a[104:107], v[44:47], v[184:187], a[104:107]
    v_mfma_f32_16x16x32_bf16 a[108:111], v[44:47], v[188:191], a[108:111]
    v_mfma_f32_16x16x32_bf16 a[112:115], v[44:47], v[192:195], a[112:115]
    v_mfma_f32_16x16x32_bf16 a[116:119], v[44:47], v[196:199], a[116:119]
    v_mfma_f32_16x16x32_bf16 a[120:123], v[44:47], v[200:203], a[120:123]
    v_mfma_f32_16x16x32_bf16 a[124:127], v[44:47], v[204:207], a[124:127]
    s_waitcnt vmcnt(20)
    ds_read_b128 v[176:179], v9 offset:24576
    ds_read_b128 v[180:183], v9 offset:25600
    ds_read_b128 v[184:187], v9 offset:26624
    ds_read_b128 v[188:191], v9 offset:27648
    ds_read_b128 v[192:195], v9 offset:28672
    ds_read_b128 v[196:199], v9 offset:29696
    ds_read_b128 v[200:203], v9 offset:30720
    ds_read_b128 v[204:207], v9 offset:31744
    s_waitcnt lgkmcnt(8)
    v_mfma_f32_16x16x32_bf16 a[0:3], v[48:51], v[144:147], a[0:3]
    v_mfma_f32_16x16x32_bf16 a[4:7], v[48:51], v[148:151], a[4:7]
    v_mfma_f32_16x16x32_bf16 a[8:11], v[48:51], v[152:155], a[8:11]
    v_mfma_f32_16x16x32_bf16 a[12:15], v[48:51], v[156:159], a[12:15]
    v_mfma_f32_16x16x32_bf16 a[16:19], v[48:51], v[160:163], a[16:19]
    v_mfma_f32_16x16x32_bf16 a[20:23], v[48:51], v[164:167], a[20:23]
    v_mfma_f32_16x16x32_bf16 a[24:27], v[48:51], v[168:171], a[24:27]
    v_mfma_f32_16x16x32_bf16 a[28:31], v[48:51], v[172:175], a[28:31]
    v_mfma_f32_16x16x32_bf16 a[32:35], v[52:55], v[144:147], a[32:35]
    v_mfma_f32_16x16x32_bf16 a[36:39], v[52:55], v[148:151], a[36:39]
    v_mfma_f32_16x16x32_bf16 a[40:43], v[52:55], v[152:155], a[40:43]
    v_mfma_f32_16x16x32_bf16 a[44:47], v[52:55], v[156:159], a[44:47]
    v_mfma_f32_16x16x32_bf16 a[48:51], v[52:55], v[160:163], a[48:51]
    v_mfma_f32_16x16x32_bf16 a[52:55], v[52:55], v[164:167], a[52:55]
    v_mfma_f32_16x16x32_bf16 a[56:59], v[52:55], v[168:171], a[56:59]
    v_mfma_f32_16x16x32_bf16 a[60:63], v[52:55], v[172:175], a[60:63]
    v_mfma_f32_16x16x32_bf16 a[64:67], v[56:59], v[144:147], a[64:67]
    v_mfma_f32_16x16x32_bf16 a[68:71], v[56:59], v[148:151], a[68:71]
    v_mfma_f32_16x16x32_bf16 a[72:75], v[56:59], v[152:155], a[72:75]
    v_mfma_f32_16x16x32_bf16 a[76:79], v[56:59], v[156:159], a[76:79]
    v_mfma_f32_16x16x32_bf16 a[80:83], v[56:59], v[160:163], a[80:83]
    v_mfma_f32_16x16x32_bf16 a[84:87], v[56:59], v[164:167], a[84:87]
    v_mfma_f32_16x16x32_bf16 a[88:91], v[56:59], v[168:171], a[88:91]
    v_mfma_f32_16x16x32_bf16 a[92:95], v[56:59], v[172:175], a[92:95]
    v_mfma_f32_16x16x32_bf16 a[96:99], v[60:63], v[144:147], a[96:99]
    v_mfma_f32_16x16x32_bf16 a[100:103], v[60:63], v[148:151], a[100:103]
    v_mfma_f32_16x16x32_bf16 a[104:107], v[60:63], v[152:155], a[104:107]
    v_mfma_f32_16x16x32_bf16 a[108:111], v[60:63], v[156:159], a[108:111]
    v_mfma_f32_16x16x32_bf16 a[112:115], v[60:63], v[160:163], a[112:115]
    v_mfma_f32_16x16x32_bf16 a[116:119], v[60:63], v[164:167], a[116:119]
    v_mfma_f32_16x16x32_bf16 a[120:123], v[60:63], v[168:171], a[120:123]
    v_mfma_f32_16x16x32_bf16 a[124:127], v[60:63], v[172:175], a[124:127]
    s_waitcnt vmcnt(16)
    ds_read_b128 v[144:147], v9 offset:32768
    ds_read_b128 v[148:151], v9 offset:33792
    ds_read_b128 v[152:155], v9 offset:34816
    ds_read_b128 v[156:159], v9 offset:35840
    ds_read_b128 v[160:163], v9 offset:36864
    ds_read_b128 v[164:167], v9 offset:37888
    ds_read_b128 v[168:171], v9 offset:38912
    ds_read_b128 v[172:175], v9 offset:39936
    s_waitcnt lgkmcnt(8)
    v_mfma_f32_16x16x32_bf16 a[0:3], v[64:67], v[176:179], a[0:3]
    v_mfma_f32_16x16x32_bf16 a[4:7], v[64:67], v[180:183], a[4:7]
    v_mfma_f32_16x16x32_bf16 a[8:11], v[64:67], v[184:187], a[8:11]
    v_mfma_f32_16x16x32_bf16 a[12:15], v[64:67], v[188:191], a[12:15]
    v_mfma_f32_16x16x32_bf16 a[16:19], v[64:67], v[192:195], a[16:19]
    v_mfma_f32_16x16x32_bf16 a[20:23], v[64:67], v[196:199], a[20:23]
    v_mfma_f32_16x16x32_bf16 a[24:27], v[64:67], v[200:203], a[24:27]
    v_mfma_f32_16x16x32_bf16 a[28:31], v[64:67], v[204:207], a[28:31]
    v_mfma_f32_16x16x32_bf16 a[32:35], v[68:71], v[176:179], a[32:35]
    v_mfma_f32_16x16x32_bf16 a[36:39], v[68:71], v[180:183], a[36:39]
    v_mfma_f32_16x16x32_bf16 a[40:43], v[68:71], v[184:187], a[40:43]
    v_mfma_f32_16x16x32_bf16 a[44:47], v[68:71], v[188:191], a[44:47]
    v_mfma_f32_16x16x32_bf16 a[48:51], v[68:71], v[192:195], a[48:51]
    v_mfma_f32_16x16x32_bf16 a[52:55], v[68:71], v[196:199], a[52:55]
    v_mfma_f32_16x16x32_bf16 a[56:59], v[68:71], v[200:203], a[56:59]
    v_mfma_f32_16x16x32_bf16 a[60:63], v[68:71], v[204:207], a[60:63]
    v_mfma_f32_16x16x32_bf16 a[64:67], v[72:75], v[176:179], a[64:67]
    v_mfma_f32_16x16x32_bf16 a[68:71], v[72:75], v[180:183], a[68:71]
    v_mfma_f32_16x16x32_bf16 a[72:75], v[72:75], v[184:187], a[72:75]
    v_mfma_f32_16x16x32_bf16 a[76:79], v[72:75], v[188:191], a[76:79]
    v_mfma_f32_16x16x32_bf16 a[80:83], v[72:75], v[192:195], a[80:83]
    v_mfma_f32_16x16x32_bf16 a[84:87], v[72:75], v[196:199], a[84:87]
    v_mfma_f32_16x16x32_bf16 a[88:91], v[72:75], v[200:203], a[88:91]
    v_mfma_f32_16x16x32_bf16 a[92:95], v[72:75], v[204:207], a[92:95]
    v_mfma_f32_16x16x32_bf16 a[96:99], v[76:79], v[176:179], a[96:99]
    v_mfma_f32_16x16x32_bf16 a[100:103], v[76:79], v[180:183], a[100:103]
    v_mfma_f32_16x16x32_bf16 a[104:107], v[76:79], v[184:187], a[104:107]
    v_mfma_f32_16x16x32_bf16 a[108:111], v[76:79], v[188:191], a[108:111]
    v_mfma_f32_16x16x32_bf16 a[112:115], v[76:79], v[192:195], a[112:115]
    v_mfma_f32_16x16x32_bf16 a[116:119], v[76:79], v[196:199], a[116:119]
    v_mfma_f32_16x16x32_bf16 a[120:123], v[76:79], v[200:203], a[120:123]
    v_mfma_f32_16x16x32_bf16 a[124:127], v[76:79], v[204:207], a[124:127]
    s_waitcnt vmcnt(12)
    ds_read_b128 v[176:179], v9 offset:40960
    ds_read_b128 v[180:183], v9 offset:41984
    ds_read_b128 v[184:187], v9 offset:43008
    ds_read_b128 v[188:191], v9 offset:44032
    ds_read_b128 v[192:195], v9 offset:45056
    ds_read_b128 v[196:199], v9 offset:46080
    ds_read_b128 v[200:203], v9 offset:47104
    ds_read_b128 v[204:207], v9 offset:48128
    s_waitcnt lgkmcnt(8)
    v_mfma_f32_16x16x32_bf16 a[0:3], v[80:83], v[144:147], a[0:3]
    v_mfma_f32_16x16x32_bf16 a[4:7], v[80:83], v[148:151], a[4:7]
    v_mfma_f32_16x16x32_bf16 a[8:11], v[80:83], v[152:155], a[8:11]
    v_mfma_f32_16x16x32_bf16 a[12:15], v[80:83], v[156:159], a[12:15]
    v_mfma_f32_16x16x32_bf16 a[16:19], v[80:83], v[160:163], a[16:19]
    v_mfma_f32_16x16x32_bf16 a[20:23], v[80:83], v[164:167], a[20:23]
    v_mfma_f32_16x16x32_bf16 a[24:27], v[80:83], v[168:171], a[24:27]
    v_mfma_f32_16x16x32_bf16 a[28:31], v[80:83], v[172:175], a[28:31]
    v_mfma_f32_16x16x32_bf16 a[32:35], v[84:87], v[144:147], a[32:35]
    v_mfma_f32_16x16x32_bf16 a[36:39], v[84:87], v[148:151], a[36:39]
    v_mfma_f32_16x16x32_bf16 a[40:43], v[84:87], v[152:155], a[40:43]
    v_mfma_f32_16x16x32_bf16 a[44:47], v[84:87], v[156:159], a[44:47]
    v_mfma_f32_16x16x32_bf16 a[48:51], v[84:87], v[160:163], a[48:51]
    v_mfma_f32_16x16x32_bf16 a[52:55], v[84:87], v[164:167], a[52:55]
    v_mfma_f32_16x16x32_bf16 a[56:59], v[84:87], v[168:171], a[56:59]
    v_mfma_f32_16x16x32_bf16 a[60:63], v[84:87], v[172:175], a[60:63]
    v_mfma_f32_16x16x32_bf16 a[64:67], v[88:91], v[144:147], a[64:67]
    v_mfma_f32_16x16x32_bf16 a[68:71], v[88:91], v[148:151], a[68:71]
    v_mfma_f32_16x16x32_bf16 a[72:75], v[88:91], v[152:155], a[72:75]
    v_mfma_f32_16x16x32_bf16 a[76:79], v[88:91], v[156:159], a[76:79]
    v_mfma_f32_16x16x32_bf16 a[80:83], v[88:91], v[160:163], a[80:83]
    v_mfma_f32_16x16x32_bf16 a[84:87], v[88:91], v[164:167], a[84:87]
    v_mfma_f32_16x16x32_bf16 a[88:91], v[88:91], v[168:171], a[88:91]
    v_mfma_f32_16x16x32_bf16 a[92:95], v[88:91], v[172:175], a[92:95]
    v_mfma_f32_16x16x32_bf16 a[96:99], v[92:95], v[144:147], a[96:99]
    v_mfma_f32_16x16x32_bf16 a[100:103], v[92:95], v[148:151], a[100:103]
    v_mfma_f32_16x16x32_bf16 a[104:107], v[92:95], v[152:155], a[104:107]
    v_mfma_f32_16x16x32_bf16 a[108:111], v[92:95], v[156:159], a[108:111]
    v_mfma_f32_16x16x32_bf16 a[112:115], v[92:95], v[160:163], a[112:115]
    v_mfma_f32_16x16x32_bf16 a[116:119], v[92:95], v[164:167], a[116:119]
    v_mfma_f32_16x16x32_bf16 a[120:123], v[92:95], v[168:171], a[120:123]
    v_mfma_f32_16x16x32_bf16 a[124:127], v[92:95], v[172:175], a[124:127]
    s_waitcnt vmcnt(8)
    ds_read_b128 v[144:147], v9 offset:49152
    ds_read_b128 v[148:151], v9 offset:50176
    ds_read_b128 v[152:155], v9 offset:51200
    ds_read_b128 v[156:159], v9 offset:52224
    ds_read_b128 v[160:163], v9 offset:53248
    ds_read_b128 v[164:167], v9 offset:54272
    ds_read_b128 v[168:171], v9 offset:55296
    ds_read_b128 v[172:175], v9 offset:56320
    s_waitcnt lgkmcnt(8)
    v_mfma_f32_16x16x32_bf16 a[0:3], v[96:99], v[176:179], a[0:3]
    v_mfma_f32_16x16x32_bf16 a[4:7], v[96:99], v[180:183], a[4:7]
    v_mfma_f32_16x16x32_bf16 a[8:11], v[96:99], v[184:187], a[8:11]
    v_mfma_f32_16x16x32_bf16 a[12:15], v[96:99], v[188:191], a[12:15]
    v_mfma_f32_16x16x32_bf16 a[16:19], v[96:99], v[192:195], a[16:19]
    v_mfma_f32_16x16x32_bf16 a[20:23], v[96:99], v[196:199], a[20:23]
    v_mfma_f32_16x16x32_bf16 a[24:27], v[96:99], v[200:203], a[24:27]
    v_mfma_f32_16x16x32_bf16 a[28:31], v[96:99], v[204:207], a[28:31]
    v_mfma_f32_16x16x32_bf16 a[32:35], v[100:103], v[176:179], a[32:35]
    v_mfma_f32_16x16x32_bf16 a[36:39], v[100:103], v[180:183], a[36:39]
    v_mfma_f32_16x16x32_bf16 a[40:43], v[100:103], v[184:187], a[40:43]
    v_mfma_f32_16x16x32_bf16 a[44:47], v[100:103], v[188:191], a[44:47]
    v_mfma_f32_16x16x32_bf16 a[48:51], v[100:103], v[192:195], a[48:51]
    v_mfma_f32_16x16x32_bf16 a[52:55], v[100:103], v[196:199], a[52:55]
    v_mfma_f32_16x16x32_bf16 a[56:59], v[100:103], v[200:203], a[56:59]
    v_mfma_f32_16x16x32_bf16 a[60:63], v[100:103], v[204:207], a[60:63]
    v_mfma_f32_16x16x32_bf16 a[64:67], v[104:107], v[176:179], a[64:67]
    v_mfma_f32_16x16x32_bf16 a[68:71], v[104:107], v[180:183], a[68:71]
    v_mfma_f32_16x16x32_bf16 a[72:75], v[104:107], v[184:187], a[72:75]
    v_mfma_f32_16x16x32_bf16 a[76:79], v[104:107], v[188:191], a[76:79]
    v_mfma_f32_16x16x32_bf16 a[80:83], v[104:107], v[192:195], a[80:83]
    v_mfma_f32_16x16x32_bf16 a[84:87], v[104:107], v[196:199], a[84:87]
    v_mfma_f32_16x16x32_bf16 a[88:91], v[104:107], v[200:203], a[88:91]
    v_mfma_f32_16x16x32_bf16 a[92:95], v[104:107], v[204:207], a[92:95]
    v_mfma_f32_16x16x32_bf16 a[96:99], v[108:111], v[176:179], a[96:99]
    v_mfma_f32_16x16x32_bf16 a[100:103], v[108:111], v[180:183], a[100:103]
    v_mfma_f32_16x16x32_bf16 a[104:107], v[108:111], v[184:187], a[104:107]
    v_mfma_f32_16x16x32_bf16 a[108:111], v[108:111], v[188:191], a[108:111]
    v_mfma_f32_16x16x32_bf16 a[112:115], v[108:111], v[192:195], a[112:115]
    v_mfma_f32_16x16x32_bf16 a[116:119], v[108:111], v[196:199], a[116:119]
    v_mfma_f32_16x16x32_bf16 a[120:123], v[108:111], v[200:203], a[120:123]
    v_mfma_f32_16x16x32_bf16 a[124:127], v[108:111], v[204:207], a[124:127]
    s_waitcnt vmcnt(4)
    ds_read_b128 v[176:179], v9 offset:57344
    ds_read_b128 v[180:183], v9 offset:58368
    ds_read_b128 v[184:187], v9 offset:59392
    ds_read_b128 v[188:191], v9 offset:60416
    ds_read_b128 v[192:195], v9 offset:61440
    ds_read_b128 v[196:199], v9 offset:62464
    ds_read_b128 v[200:203], v9 offset:63488
    ds_read_b128 v[204:207], v9 offset:64512
    s_waitcnt lgkmcnt(8)
    v_mfma_f32_16x16x32_bf16 a[0:3], v[112:115], v[144:147], a[0:3]
    v_mfma_f32_16x16x32_bf16 a[4:7], v[112:115], v[148:151], a[4:7]
    v_mfma_f32_16x16x32_bf16 a[8:11], v[112:115], v[152:155], a[8:11]
    v_mfma_f32_16x16x32_bf16 a[12:15], v[112:115], v[156:159], a[12:15]
    v_mfma_f32_16x16x32_bf16 a[16:19], v[112:115], v[160:163], a[16:19]
    v_mfma_f32_16x16x32_bf16 a[20:23], v[112:115], v[164:167], a[20:23]
    v_mfma_f32_16x16x32_bf16 a[24:27], v[112:115], v[168:171], a[24:27]
    v_mfma_f32_16x16x32_bf16 a[28:31], v[112:115], v[172:175], a[28:31]
    v_mfma_f32_16x16x32_bf16 a[32:35], v[116:119], v[144:147], a[32:35]
    v_mfma_f32_16x16x32_bf16 a[36:39], v[116:119], v[148:151], a[36:39]
    v_mfma_f32_16x16x32_bf16 a[40:43], v[116:119], v[152:155], a[40:43]
    v_mfma_f32_16x16x32_bf16 a[44:47], v[116:119], v[156:159], a[44:47]
    v_mfma_f32_16x16x32_bf16 a[48:51], v[116:119], v[160:163], a[48:51]
    v_mfma_f32_16x16x32_bf16 a[52:55], v[116:119], v[164:167], a[52:55]
    v_mfma_f32_16x16x32_bf16 a[56:59], v[116:119], v[168:171], a[56:59]
    v_mfma_f32_16x16x32_bf16 a[60:63], v[116:119], v[172:175], a[60:63]
    v_mfma_f32_16x16x32_bf16 a[64:67], v[120:123], v[144:147], a[64:67]
    v_mfma_f32_16x16x32_bf16 a[68:71], v[120:123], v[148:151], a[68:71]
    v_mfma_f32_16x16x32_bf16 a[72:75], v[120:123], v[152:155], a[72:75]
    v_mfma_f32_16x16x32_bf16 a[76:79], v[120:123], v[156:159], a[76:79]
    v_mfma_f32_16x16x32_bf16 a[80:83], v[120:123], v[160:163], a[80:83]
    v_mfma_f32_16x16x32_bf16 a[84:87], v[120:123], v[164:167], a[84:87]
    v_mfma_f32_16x16x32_bf16 a[88:91], v[120:123], v[168:171], a[88:91]
    v_mfma_f32_16x16x32_bf16 a[92:95], v[120:123], v[172:175], a[92:95]
    v_mfma_f32_16x16x32_bf16 a[96:99], v[124:127], v[144:147], a[96:99]
    v_mfma_f32_16x16x32_bf16 a[100:103], v[124:127], v[148:151], a[100:103]
    v_mfma_f32_16x16x32_bf16 a[104:107], v[124:127], v[152:155], a[104:107]
    v_mfma_f32_16x16x32_bf16 a[108:111], v[124:127], v[156:159], a[108:111]
    v_mfma_f32_16x16x32_bf16 a[112:115], v[124:127], v[160:163], a[112:115]
    v_mfma_f32_16x16x32_bf16 a[116:119], v[124:127], v[164:167], a[116:119]
    v_mfma_f32_16x16x32_bf16 a[120:123], v[124:127], v[168:171], a[120:123]
    v_mfma_f32_16x16x32_bf16 a[124:127], v[124:127], v[172:175], a[124:127]
    s_waitcnt vmcnt(0)
    s_waitcnt lgkmcnt(0)
    v_mfma_f32_16x16x32_bf16 a[0:3], v[128:131], v[176:179], a[0:3]
    v_mfma_f32_16x16x32_bf16 a[4:7], v[128:131], v[180:183], a[4:7]
    v_mfma_f32_16x16x32_bf16 a[8:11], v[128:131], v[184:187], a[8:11]
    v_mfma_f32_16x16x32_bf16 a[12:15], v[128:131], v[188:191], a[12:15]
    v_mfma_f32_16x16x32_bf16 a[16:19], v[128:131], v[192:195], a[16:19]
    v_mfma_f32_16x16x32_bf16 a[20:23], v[128:131], v[196:199], a[20:23]
    v_mfma_f32_16x16x32_bf16 a[24:27], v[128:131], v[200:203], a[24:27]
    v_mfma_f32_16x16x32_bf16 a[28:31], v[128:131], v[204:207], a[28:31]
    v_mfma_f32_16x16x32_bf16 a[32:35], v[132:135], v[176:179], a[32:35]
    v_mfma_f32_16x16x32_bf16 a[36:39], v[132:135], v[180:183], a[36:39]
    v_mfma_f32_16x16x32_bf16 a[40:43], v[132:135], v[184:187], a[40:43]
    v_mfma_f32_16x16x32_bf16 a[44:47], v[132:135], v[188:191], a[44:47]
    v_mfma_f32_16x16x32_bf16 a[48:51], v[132:135], v[192:195], a[48:51]
    v_mfma_f32_16x16x32_bf16 a[52:55], v[132:135], v[196:199], a[52:55]
    v_mfma_f32_16x16x32_bf16 a[56:59], v[132:135], v[200:203], a[56:59]
    v_mfma_f32_16x16x32_bf16 a[60:63], v[132:135], v[204:207], a[60:63]
    v_mfma_f32_16x16x32_bf16 a[64:67], v[136:139], v[176:179], a[64:67]
    v_mfma_f32_16x16x32_bf16 a[68:71], v[136:139], v[180:183], a[68:71]
    v_mfma_f32_16x16x32_bf16 a[72:75], v[136:139], v[184:187], a[72:75]
    v_mfma_f32_16x16x32_bf16 a[76:79], v[136:139], v[188:191], a[76:79]
    v_mfma_f32_16x16x32_bf16 a[80:83], v[136:139], v[192:195], a[80:83]
    v_mfma_f32_16x16x32_bf16 a[84:87], v[136:139], v[196:199], a[84:87]
    v_mfma_f32_16x16x32_bf16 a[88:91], v[136:139], v[200:203], a[88:91]
    v_mfma_f32_16x16x32_bf16 a[92:95], v[136:139], v[204:207], a[92:95]
    v_mfma_f32_16x16x32_bf16 a[96:99], v[140:143], v[176:179], a[96:99]
    v_mfma_f32_16x16x32_bf16 a[100:103], v[140:143], v[180:183], a[100:103]
    v_mfma_f32_16x16x32_bf16 a[104:107], v[140:143], v[184:187], a[104:107]
    v_mfma_f32_16x16x32_bf16 a[108:111], v[140:143], v[188:191], a[108:111]
    v_mfma_f32_16x16x32_bf16 a[112:115], v[140:143], v[192:195], a[112:115]
    v_mfma_f32_16x16x32_bf16 a[116:119], v[140:143], v[196:199], a[116:119]
    v_mfma_f32_16x16x32_bf16 a[120:123], v[140:143], v[200:203], a[120:123]
    v_mfma_f32_16x16x32_bf16 a[124:127], v[140:143], v[204:207], a[124:127]
    s_nop 15
    v_accvgpr_read_b32 v16, a0
    v_accvgpr_read_b32 v17, a1
    v_accvgpr_read_b32 v18, a2
    v_accvgpr_read_b32 v19, a3
    v_accvgpr_read_b32 v20, a4
    v_accvgpr_read_b32 v21, a5
    v_accvgpr_read_b32 v22, a6
    v_accvgpr_read_b32 v23, a7
    v_accvgpr_read_b32 v24, a8
    v_accvgpr_read_b32 v25, a9
    v_accvgpr_read_b32 v26, a10
    v_accvgpr_read_b32 v27, a11
    v_accvgpr_read_b32 v28, a12
    v_accvgpr_read_b32 v29, a13
    v_accvgpr_read_b32 v30, a14
    v_accvgpr_read_b32 v31, a15
    v_accvgpr_read_b32 v32, a16
    v_accvgpr_read_b32 v33, a17
    v_accvgpr_read_b32 v34, a18
    v_accvgpr_read_b32 v35, a19
    v_accvgpr_read_b32 v36, a20
    v_accvgpr_read_b32 v37, a21
    v_accvgpr_read_b32 v38, a22
    v_accvgpr_read_b32 v39, a23
    v_accvgpr_read_b32 v40, a24
    v_accvgpr_read_b32 v41, a25
    v_accvgpr_read_b32 v42, a26
    v_accvgpr_read_b32 v43, a27
    v_accvgpr_read_b32 v44, a28
    v_accvgpr_read_b32 v45, a29
    v_accvgpr_read_b32 v46, a30
    v_accvgpr_read_b32 v47, a31
    v_accvgpr_read_b32 v48, a32
    v_accvgpr_read_b32 v49, a33
    v_accvgpr_read_b32 v50, a34
    v_accvgpr_read_b32 v51, a35
    v_accvgpr_read_b32 v52, a36
    v_accvgpr_read_b32 v53, a37
    v_accvgpr_read_b32 v54, a38
    v_accvgpr_read_b32 v55, a39
    v_accvgpr_read_b32 v56, a40
    v_accvgpr_read_b32 v57, a41
    v_accvgpr_read_b32 v58, a42
    v_accvgpr_read_b32 v59, a43
    v_accvgpr_read_b32 v60, a44
    v_accvgpr_read_b32 v61, a45
    v_accvgpr_read_b32 v62, a46
    v_accvgpr_read_b32 v63, a47
    v_accvgpr_read_b32 v64, a48
    v_accvgpr_read_b32 v65, a49
    v_accvgpr_read_b32 v66, a50
    v_accvgpr_read_b32 v67, a51
    v_accvgpr_read_b32 v68, a52
    v_accvgpr_read_b32 v69, a53
    v_accvgpr_read_b32 v70, a54
    v_accvgpr_read_b32 v71, a55
    v_accvgpr_read_b32 v72, a56
    v_accvgpr_read_b32 v73, a57
    v_accvgpr_read_b32 v74, a58
    v_accvgpr_read_b32 v75, a59
    v_accvgpr_read_b32 v76, a60
    v_accvgpr_read_b32 v77, a61
    v_accvgpr_read_b32 v78, a62
    v_accvgpr_read_b32 v79, a63
    v_accvgpr_read_b32 v80, a64
    v_accvgpr_read_b32 v81, a65
    v_accvgpr_read_b32 v82, a66
    v_accvgpr_read_b32 v83, a67
    v_accvgpr_read_b32 v84, a68
    v_accvgpr_read_b32 v85, a69
    v_accvgpr_read_b32 v86, a70
    v_accvgpr_read_b32 v87, a71
    v_accvgpr_read_b32 v88, a72
    v_accvgpr_read_b32 v89, a73
    v_accvgpr_read_b32 v90, a74
    v_accvgpr_read_b32 v91, a75
    v_accvgpr_read_b32 v92, a76
    v_accvgpr_read_b32 v93, a77
    v_accvgpr_read_b32 v94, a78
    v_accvgpr_read_b32 v95, a79
    v_accvgpr_read_b32 v96, a80
    v_accvgpr_read_b32 v97, a81
    v_accvgpr_read_b32 v98, a82
    v_accvgpr_read_b32 v99, a83
    v_accvgpr_read_b32 v100, a84
    v_accvgpr_read_b32 v101, a85
    v_accvgpr_read_b32 v102, a86
    v_accvgpr_read_b32 v103, a87
    v_accvgpr_read_b32 v104, a88
    v_accvgpr_read_b32 v105, a89
    v_accvgpr_read_b32 v106, a90
    v_accvgpr_read_b32 v107, a91
    v_accvgpr_read_b32 v108, a92
    v_accvgpr_read_b32 v109, a93
    v_accvgpr_read_b32 v110, a94
    v_accvgpr_read_b32 v111, a95
    v_accvgpr_read_b32 v112, a96
    v_accvgpr_read_b32 v113, a97
    v_accvgpr_read_b32 v114, a98
    v_accvgpr_read_b32 v115, a99
    v_accvgpr_read_b32 v116, a100
    v_accvgpr_read_b32 v117, a101
    v_accvgpr_read_b32 v118, a102
    v_accvgpr_read_b32 v119, a103
    v_accvgpr_read_b32 v120, a104
    v_accvgpr_read_b32 v121, a105
    v_accvgpr_read_b32 v122, a106
    v_accvgpr_read_b32 v123, a107
    v_accvgpr_read_b32 v124, a108
    v_accvgpr_read_b32 v125, a109
    v_accvgpr_read_b32 v126, a110
    v_accvgpr_read_b32 v127, a111
    v_accvgpr_read_b32 v128, a112
    v_accvgpr_read_b32 v129, a113
    v_accvgpr_read_b32 v130, a114
    v_accvgpr_read_b32 v131, a115
    v_accvgpr_read_b32 v132, a116
    v_accvgpr_read_b32 v133, a117
    v_accvgpr_read_b32 v134, a118
    v_accvgpr_read_b32 v135, a119
    v_accvgpr_read_b32 v136, a120
    v_accvgpr_read_b32 v137, a121
    v_accvgpr_read_b32 v138, a122
    v_accvgpr_read_b32 v139, a123
    v_accvgpr_read_b32 v140, a124
    v_accvgpr_read_b32 v141, a125
    v_accvgpr_read_b32 v142, a126
    v_accvgpr_read_b32 v143, a127
    s_lshl_b32 s16, s12, 14
    s_add_u32 s15, s16, 67108864
    s_lshl_b32 s16, s14, 19
    s_add_u32 s15, s15, s16
    s_add_u32 s20, s4, s15
    s_addc_u32 s21, s5, 0
    v_add_u32 v4, 0, v3
    v_add_u32 v5, 4096, v3
    v_cvt_pk_bf16_f32 v144, v16, v17
    v_cvt_pk_bf16_f32 v145, v18, v19
    v_cvt_pk_bf16_f32 v146, v48, v49
    v_cvt_pk_bf16_f32 v147, v50, v51
    global_store_dwordx4 v4, v[144:147], s[20:21] offset:0 sc1
    v_cvt_pk_bf16_f32 v148, v20, v21
    v_cvt_pk_bf16_f32 v149, v22, v23
    v_cvt_pk_bf16_f32 v150, v52, v53
    v_cvt_pk_bf16_f32 v151, v54, v55
    global_store_dwordx4 v4, v[148:151], s[20:21] offset:1024 sc1
    v_cvt_pk_bf16_f32 v152, v24, v25
    v_cvt_pk_bf16_f32 v153, v26, v27
    v_cvt_pk_bf16_f32 v154, v56, v57
    v_cvt_pk_bf16_f32 v155, v58, v59
    global_store_dwordx4 v4, v[152:155], s[20:21] offset:2048 sc1
    v_cvt_pk_bf16_f32 v156, v28, v29
    v_cvt_pk_bf16_f32 v157, v30, v31
    v_cvt_pk_bf16_f32 v158, v60, v61
    v_cvt_pk_bf16_f32 v159, v62, v63
    global_store_dwordx4 v4, v[156:159], s[20:21] offset:3072 sc1
    s_nop 1
    v_cvt_pk_bf16_f32 v144, v32, v33
    v_cvt_pk_bf16_f32 v145, v34, v35
    v_cvt_pk_bf16_f32 v146, v64, v65
    v_cvt_pk_bf16_f32 v147, v66, v67
    global_store_dwordx4 v5, v[144:147], s[20:21] offset:0 sc1
    v_cvt_pk_bf16_f32 v148, v36, v37
    v_cvt_pk_bf16_f32 v149, v38, v39
    v_cvt_pk_bf16_f32 v150, v68, v69
    v_cvt_pk_bf16_f32 v151, v70, v71
    global_store_dwordx4 v5, v[148:151], s[20:21] offset:1024 sc1
    v_cvt_pk_bf16_f32 v152, v40, v41
    v_cvt_pk_bf16_f32 v153, v42, v43
    v_cvt_pk_bf16_f32 v154, v72, v73
    v_cvt_pk_bf16_f32 v155, v74, v75
    global_store_dwordx4 v5, v[152:155], s[20:21] offset:2048 sc1
    v_cvt_pk_bf16_f32 v156, v44, v45
    v_cvt_pk_bf16_f32 v157, v46, v47
    v_cvt_pk_bf16_f32 v158, v76, v77
    v_cvt_pk_bf16_f32 v159, v78, v79
    global_store_dwordx4 v5, v[156:159], s[20:21] offset:3072 sc1
    s_nop 1
    v_add_u32 v4, 8192, v3
    v_add_u32 v5, 12288, v3
    v_cvt_pk_bf16_f32 v144, v80, v81
    v_cvt_pk_bf16_f32 v145, v82, v83
    v_cvt_pk_bf16_f32 v146, v112, v113
    v_cvt_pk_bf16_f32 v147, v114, v115
    global_store_dwordx4 v4, v[144:147], s[20:21] offset:0 sc1
    v_cvt_pk_bf16_f32 v148, v84, v85
    v_cvt_pk_bf16_f32 v149, v86, v87
    v_cvt_pk_bf16_f32 v150, v116, v117
    v_cvt_pk_bf16_f32 v151, v118, v119
    global_store_dwordx4 v4, v[148:151], s[20:21] offset:1024 sc1
    v_cvt_pk_bf16_f32 v152, v88, v89
    v_cvt_pk_bf16_f32 v153, v90, v91
    v_cvt_pk_bf16_f32 v154, v120, v121
    v_cvt_pk_bf16_f32 v155, v122, v123
    global_store_dwordx4 v4, v[152:155], s[20:21] offset:2048 sc1
    v_cvt_pk_bf16_f32 v156, v92, v93
    v_cvt_pk_bf16_f32 v157, v94, v95
    v_cvt_pk_bf16_f32 v158, v124, v125
    v_cvt_pk_bf16_f32 v159, v126, v127
    global_store_dwordx4 v4, v[156:159], s[20:21] offset:3072 sc1
    s_nop 1
    v_cvt_pk_bf16_f32 v144, v96, v97
    v_cvt_pk_bf16_f32 v145, v98, v99
    v_cvt_pk_bf16_f32 v146, v128, v129
    v_cvt_pk_bf16_f32 v147, v130, v131
    global_store_dwordx4 v5, v[144:147], s[20:21] offset:0 sc1
    v_cvt_pk_bf16_f32 v148, v100, v101
    v_cvt_pk_bf16_f32 v149, v102, v103
    v_cvt_pk_bf16_f32 v150, v132, v133
    v_cvt_pk_bf16_f32 v151, v134, v135
    global_store_dwordx4 v5, v[148:151], s[20:21] offset:1024 sc1
    v_cvt_pk_bf16_f32 v152, v104, v105
    v_cvt_pk_bf16_f32 v153, v106, v107
    v_cvt_pk_bf16_f32 v154, v136, v137
    v_cvt_pk_bf16_f32 v155, v138, v139
    global_store_dwordx4 v5, v[152:155], s[20:21] offset:2048 sc1
    v_cvt_pk_bf16_f32 v156, v108, v109
    v_cvt_pk_bf16_f32 v157, v110, v111
    v_cvt_pk_bf16_f32 v158, v140, v141
    v_cvt_pk_bf16_f32 v159, v142, v143
    global_store_dwordx4 v5, v[156:159], s[20:21] offset:3072 sc1
    s_nop 1
WK_GEMM_FL:
    s_lshl_b32 s41, s14, 9
    s_lshl_b32 s15, s12, 4
    s_add_u32 s41, s41, s15
    s_lshl_b32 s15, s13, 2
    s_add_u32 s41, s41, s15
    s_add_u32 s41, s41, 4456448
    s_waitcnt vmcnt(0)
    s_mov_b64 s[38:39], exec
    v_mov_b32 v240, s41
    v_mov_b32 v241, s56
    s_mov_b64 exec, 1
    global_store_dword v240, v241, s[4:5] sc1
    s_mov_b64 exec, s[38:39]
WK_GEMM_NEXT:
    s_add_u32 s42, s42, 32
    s_branch WK_GEMM
WK_GEMM_DONE:
    s_cmp_lg_u32 s40, 223
    s_cbranch_scc1 WK_NOTOPK
    v_and_b32 v4, 31, v2
    v_lshlrev_b32 v4, 7, v4
    v_add_u32 v4, 4526080, v4
WK_TKB:
    global_load_dwordx4 v[8:11], v4, s[4:5] sc1
    s_waitcnt vmcnt(0)
    v_xor_b32 v8, s56, v8
    v_xor_b32 v9, s56, v9
    v_xor_b32 v10, s56, v10
    v_xor_b32 v11, s56, v11
    v_or3_b32 v8, v8, v9, v10
    v_or_b32 v8, v8, v11
    v_cmp_ne_u32 vcc, 0, v8
    s_cbranch_vccnz WK_TKB
    s_barrier
    v_lshlrev_b32 v3, 5, v0
    v_add_u32 v3, 4194304, v3
    global_load_dwordx4 v[8:11], v3, s[4:5]
    global_load_dwordx4 v[12:15], v3, s[4:5] offset:16
    v_lshlrev_b32 v4, 3, v0
    v_sub_u32 v4, 2047, v4
    v_lshrrev_b32 v5, 6, v0
    v_lshlrev_b32 v5, 2, v5
    v_add_u32 v5, 0, v5
    v_mov_b32 v6, 0
    s_waitcnt vmcnt(0)
    v_ashrrev_i32 v16, 31, v8
    v_or_b32 v16, 0x80000000, v16
    v_xor_b32 v8, v8, v16
    v_and_b32 v8, 0xffff0000, v8
    v_subrev_u32 v16, 0, v4
    v_or_b32 v8, v8, v16
    v_ashrrev_i32 v16, 31, v9
    v_or_b32 v16, 0x80000000, v16
    v_xor_b32 v9, v9, v16
    v_and_b32 v9, 0xffff0000, v9
    v_subrev_u32 v16, 1, v4
    v_or_b32 v9, v9, v16
    v_ashrrev_i32 v16, 31, v10
    v_or_b32 v16, 0x80000000, v16
    v_xor_b32 v10, v10, v16
    v_and_b32 v10, 0xffff0000, v10
    v_subrev_u32 v16, 2, v4
    v_or_b32 v10, v10, v16
    v_ashrrev_i32 v16, 31, v11
    v_or_b32 v16, 0x80000000, v16
    v_xor_b32 v11, v11, v16
    v_and_b32 v11, 0xffff0000, v11
    v_subrev_u32 v16, 3, v4
    v_or_b32 v11, v11, v16
    v_ashrrev_i32 v16, 31, v12
    v_or_b32 v16, 0x80000000, v16
    v_xor_b32 v12, v12, v16
    v_and_b32 v12, 0xffff0000, v12
    v_subrev_u32 v16, 4, v4
    v_or_b32 v12, v12, v16
    v_ashrrev_i32 v16, 31, v13
    v_or_b32 v16, 0x80000000, v16
    v_xor_b32 v13, v13, v16
    v_and_b32 v13, 0xffff0000, v13
    v_subrev_u32 v16, 5, v4
    v_or_b32 v13, v13, v16
    v_ashrrev_i32 v16, 31, v14
    v_or_b32 v16, 0x80000000, v16
    v_xor_b32 v14, v14, v16
    v_and_b32 v14, 0xffff0000, v14
    v_subrev_u32 v16, 6, v4
    v_or_b32 v14, v14, v16
    v_ashrrev_i32 v16, 31, v15
    v_or_b32 v16, 0x80000000, v16
    v_xor_b32 v15, v15, v16
    v_and_b32 v15, 0xffff0000, v15
    v_subrev_u32 v16, 7, v4
    v_or_b32 v15, v15, v16
    v_max3_u32 v16, v8, v9, v10
    v_max3_u32 v16, v16, v11, v12
    v_max3_u32 v16, v16, v13, v14
    v_max_u32 v16, v16, v15
    s_nop 1
    v_max_u32_dpp v16, v16, v16 quad_perm:[1,0,3,2] row_mask:0xf bank_mask:0xf
    s_nop 1
    v_max_u32_dpp v16, v16, v16 quad_perm:[2,3,0,1] row_mask:0xf bank_mask:0xf
    s_nop 1
    v_max_u32_dpp v16, v16, v16 row_half_mirror row_mask:0xf bank_mask:0xf
    s_nop 1
    v_max_u32_dpp v16, v16, v16 row_mirror row_mask:0xf bank_mask:0xf
    v_mov_b32 v17, v16
    s_nop 1
    v_permlane16_swap_b32 v16, v17
    s_nop 1
    v_max_u32 v16, v16, v17
    v_mov_b32 v17, v16
    s_nop 1
    v_permlane32_swap_b32 v16, v17
    s_nop 1
    v_max_u32 v16, v16, v17
    ds_write_b32 v5, v16 offset:0
    s_waitcnt lgkmcnt(0)
    s_barrier
    ds_read_b128 v[20:23], v6 offset:0
    s_waitcnt lgkmcnt(0)
    v_max3_u32 v16, v20, v21, v22
    v_max_u32 v16, v16, v23
    v_mov_b32 v24, v16
    v_cmp_eq_u32 vcc, v16, v8
    s_nop 1
    v_cndmask_b32 v8, v8, 0, vcc
    v_cmp_eq_u32 vcc, v16, v9
    s_nop 1
    v_cndmask_b32 v9, v9, 0, vcc
    v_cmp_eq_u32 vcc, v16, v10
    s_nop 1
    v_cndmask_b32 v10, v10, 0, vcc
    v_cmp_eq_u32 vcc, v16, v11
    s_nop 1
    v_cndmask_b32 v11, v11, 0, vcc
    v_cmp_eq_u32 vcc, v16, v12
    s_nop 1
    v_cndmask_b32 v12, v12, 0, vcc
    v_cmp_eq_u32 vcc, v16, v13
    s_nop 1
    v_cndmask_b32 v13, v13, 0, vcc
    v_cmp_eq_u32 vcc, v16, v14
    s_nop 1
    v_cndmask_b32 v14, v14, 0, vcc
    v_cmp_eq_u32 vcc, v16, v15
    s_nop 1
    v_cndmask_b32 v15, v15, 0, vcc
    v_max3_u32 v16, v8, v9, v10
    v_max3_u32 v16, v16, v11, v12
    v_max3_u32 v16, v16, v13, v14
    v_max_u32 v16, v16, v15
    s_nop 1
    v_max_u32_dpp v16, v16, v16 quad_perm:[1,0,3,2] row_mask:0xf bank_mask:0xf
    s_nop 1
    v_max_u32_dpp v16, v16, v16 quad_perm:[2,3,0,1] row_mask:0xf bank_mask:0xf
    s_nop 1
    v_max_u32_dpp v16, v16, v16 row_half_mirror row_mask:0xf bank_mask:0xf
    s_nop 1
    v_max_u32_dpp v16, v16, v16 row_mirror row_mask:0xf bank_mask:0xf
    v_mov_b32 v17, v16
    s_nop 1
    v_permlane16_swap_b32 v16, v17
    s_nop 1
    v_max_u32 v16, v16, v17
    v_mov_b32 v17, v16
    s_nop 1
    v_permlane32_swap_b32 v16, v17
    s_nop 1
    v_max_u32 v16, v16, v17
    ds_write_b32 v5, v16 offset:16
    s_waitcnt lgkmcnt(0)
    s_barrier
    ds_read_b128 v[20:23], v6 offset:16
    s_waitcnt lgkmcnt(0)
    v_max3_u32 v16, v20, v21, v22
    v_max_u32 v16, v16, v23
    v_mov_b32 v25, v16
    v_cmp_eq_u32 vcc, v16, v8
    s_nop 1
    v_cndmask_b32 v8, v8, 0, vcc
    v_cmp_eq_u32 vcc, v16, v9
    s_nop 1
    v_cndmask_b32 v9, v9, 0, vcc
    v_cmp_eq_u32 vcc, v16, v10
    s_nop 1
    v_cndmask_b32 v10, v10, 0, vcc
    v_cmp_eq_u32 vcc, v16, v11
    s_nop 1
    v_cndmask_b32 v11, v11, 0, vcc
    v_cmp_eq_u32 vcc, v16, v12
    s_nop 1
    v_cndmask_b32 v12, v12, 0, vcc
    v_cmp_eq_u32 vcc, v16, v13
    s_nop 1
    v_cndmask_b32 v13, v13, 0, vcc
    v_cmp_eq_u32 vcc, v16, v14
    s_nop 1
    v_cndmask_b32 v14, v14, 0, vcc
    v_cmp_eq_u32 vcc, v16, v15
    s_nop 1
    v_cndmask_b32 v15, v15, 0, vcc
    v_max3_u32 v16, v8, v9, v10
    v_max3_u32 v16, v16, v11, v12
    v_max3_u32 v16, v16, v13, v14
    v_max_u32 v16, v16, v15
    s_nop 1
    v_max_u32_dpp v16, v16, v16 quad_perm:[1,0,3,2] row_mask:0xf bank_mask:0xf
    s_nop 1
    v_max_u32_dpp v16, v16, v16 quad_perm:[2,3,0,1] row_mask:0xf bank_mask:0xf
    s_nop 1
    v_max_u32_dpp v16, v16, v16 row_half_mirror row_mask:0xf bank_mask:0xf
    s_nop 1
    v_max_u32_dpp v16, v16, v16 row_mirror row_mask:0xf bank_mask:0xf
    v_mov_b32 v17, v16
    s_nop 1
    v_permlane16_swap_b32 v16, v17
    s_nop 1
    v_max_u32 v16, v16, v17
    v_mov_b32 v17, v16
    s_nop 1
    v_permlane32_swap_b32 v16, v17
    s_nop 1
    v_max_u32 v16, v16, v17
    ds_write_b32 v5, v16 offset:32
    s_waitcnt lgkmcnt(0)
    s_barrier
    ds_read_b128 v[20:23], v6 offset:32
    s_waitcnt lgkmcnt(0)
    v_max3_u32 v16, v20, v21, v22
    v_max_u32 v16, v16, v23
    v_mov_b32 v26, v16
    v_cmp_eq_u32 vcc, v16, v8
    s_nop 1
    v_cndmask_b32 v8, v8, 0, vcc
    v_cmp_eq_u32 vcc, v16, v9
    s_nop 1
    v_cndmask_b32 v9, v9, 0, vcc
    v_cmp_eq_u32 vcc, v16, v10
    s_nop 1
    v_cndmask_b32 v10, v10, 0, vcc
    v_cmp_eq_u32 vcc, v16, v11
    s_nop 1
    v_cndmask_b32 v11, v11, 0, vcc
    v_cmp_eq_u32 vcc, v16, v12
    s_nop 1
    v_cndmask_b32 v12, v12, 0, vcc
    v_cmp_eq_u32 vcc, v16, v13
    s_nop 1
    v_cndmask_b32 v13, v13, 0, vcc
    v_cmp_eq_u32 vcc, v16, v14
    s_nop 1
    v_cndmask_b32 v14, v14, 0, vcc
    v_cmp_eq_u32 vcc, v16, v15
    s_nop 1
    v_cndmask_b32 v15, v15, 0, vcc
    v_max3_u32 v16, v8, v9, v10
    v_max3_u32 v16, v16, v11, v12
    v_max3_u32 v16, v16, v13, v14
    v_max_u32 v16, v16, v15
    s_nop 1
    v_max_u32_dpp v16, v16, v16 quad_perm:[1,0,3,2] row_mask:0xf bank_mask:0xf
    s_nop 1
    v_max_u32_dpp v16, v16, v16 quad_perm:[2,3,0,1] row_mask:0xf bank_mask:0xf
    s_nop 1
    v_max_u32_dpp v16, v16, v16 row_half_mirror row_mask:0xf bank_mask:0xf
    s_nop 1
    v_max_u32_dpp v16, v16, v16 row_mirror row_mask:0xf bank_mask:0xf
    v_mov_b32 v17, v16
    s_nop 1
    v_permlane16_swap_b32 v16, v17
    s_nop 1
    v_max_u32 v16, v16, v17
    v_mov_b32 v17, v16
    s_nop 1
    v_permlane32_swap_b32 v16, v17
    s_nop 1
    v_max_u32 v16, v16, v17
    ds_write_b32 v5, v16 offset:48
    s_waitcnt lgkmcnt(0)
    s_barrier
    ds_read_b128 v[20:23], v6 offset:48
    s_waitcnt lgkmcnt(0)
    v_max3_u32 v16, v20, v21, v22
    v_max_u32 v16, v16, v23
    v_mov_b32 v27, v16
    v_cmp_eq_u32 vcc, v16, v8
    s_nop 1
    v_cndmask_b32 v8, v8, 0, vcc
    v_cmp_eq_u32 vcc, v16, v9
    s_nop 1
    v_cndmask_b32 v9, v9, 0, vcc
    v_cmp_eq_u32 vcc, v16, v10
    s_nop 1
    v_cndmask_b32 v10, v10, 0, vcc
    v_cmp_eq_u32 vcc, v16, v11
    s_nop 1
    v_cndmask_b32 v11, v11, 0, vcc
    v_cmp_eq_u32 vcc, v16, v12
    s_nop 1
    v_cndmask_b32 v12, v12, 0, vcc
    v_cmp_eq_u32 vcc, v16, v13
    s_nop 1
    v_cndmask_b32 v13, v13, 0, vcc
    v_cmp_eq_u32 vcc, v16, v14
    s_nop 1
    v_cndmask_b32 v14, v14, 0, vcc
    v_cmp_eq_u32 vcc, v16, v15
    s_nop 1
    v_cndmask_b32 v15, v15, 0, vcc
    v_max3_u32 v16, v8, v9, v10
    v_max3_u32 v16, v16, v11, v12
    v_max3_u32 v16, v16, v13, v14
    v_max_u32 v16, v16, v15
    s_nop 1
    v_max_u32_dpp v16, v16, v16 quad_perm:[1,0,3,2] row_mask:0xf bank_mask:0xf
    s_nop 1
    v_max_u32_dpp v16, v16, v16 quad_perm:[2,3,0,1] row_mask:0xf bank_mask:0xf
    s_nop 1
    v_max_u32_dpp v16, v16, v16 row_half_mirror row_mask:0xf bank_mask:0xf
    s_nop 1
    v_max_u32_dpp v16, v16, v16 row_mirror row_mask:0xf bank_mask:0xf
    v_mov_b32 v17, v16
    s_nop 1
    v_permlane16_swap_b32 v16, v17
    s_nop 1
    v_max_u32 v16, v16, v17
    v_mov_b32 v17, v16
    s_nop 1
    v_permlane32_swap_b32 v16, v17
    s_nop 1
    v_max_u32 v16, v16, v17
    ds_write_b32 v5, v16 offset:64
    s_waitcnt lgkmcnt(0)
    s_barrier
    ds_read_b128 v[20:23], v6 offset:64
    s_waitcnt lgkmcnt(0)
    v_max3_u32 v16, v20, v21, v22
    v_max_u32 v16, v16, v23
    v_mov_b32 v28, v16
    v_cmp_eq_u32 vcc, v16, v8
    s_nop 1
    v_cndmask_b32 v8, v8, 0, vcc
    v_cmp_eq_u32 vcc, v16, v9
    s_nop 1
    v_cndmask_b32 v9, v9, 0, vcc
    v_cmp_eq_u32 vcc, v16, v10
    s_nop 1
    v_cndmask_b32 v10, v10, 0, vcc
    v_cmp_eq_u32 vcc, v16, v11
    s_nop 1
    v_cndmask_b32 v11, v11, 0, vcc
    v_cmp_eq_u32 vcc, v16, v12
    s_nop 1
    v_cndmask_b32 v12, v12, 0, vcc
    v_cmp_eq_u32 vcc, v16, v13
    s_nop 1
    v_cndmask_b32 v13, v13, 0, vcc
    v_cmp_eq_u32 vcc, v16, v14
    s_nop 1
    v_cndmask_b32 v14, v14, 0, vcc
    v_cmp_eq_u32 vcc, v16, v15
    s_nop 1
    v_cndmask_b32 v15, v15, 0, vcc
    v_max3_u32 v16, v8, v9, v10
    v_max3_u32 v16, v16, v11, v12
    v_max3_u32 v16, v16, v13, v14
    v_max_u32 v16, v16, v15
    s_nop 1
    v_max_u32_dpp v16, v16, v16 quad_perm:[1,0,3,2] row_mask:0xf bank_mask:0xf
    s_nop 1
    v_max_u32_dpp v16, v16, v16 quad_perm:[2,3,0,1] row_mask:0xf bank_mask:0xf
    s_nop 1
    v_max_u32_dpp v16, v16, v16 row_half_mirror row_mask:0xf bank_mask:0xf
    s_nop 1
    v_max_u32_dpp v16, v16, v16 row_mirror row_mask:0xf bank_mask:0xf
    v_mov_b32 v17, v16
    s_nop 1
    v_permlane16_swap_b32 v16, v17
    s_nop 1
    v_max_u32 v16, v16, v17
    v_mov_b32 v17, v16
    s_nop 1
    v_permlane32_swap_b32 v16, v17
    s_nop 1
    v_max_u32 v16, v16, v17
    ds_write_b32 v5, v16 offset:80
    s_waitcnt lgkmcnt(0)
    s_barrier
    ds_read_b128 v[20:23], v6 offset:80
    s_waitcnt lgkmcnt(0)
    v_max3_u32 v16, v20, v21, v22
    v_max_u32 v16, v16, v23
    v_mov_b32 v29, v16
    v_cmp_eq_u32 vcc, v16, v8
    s_nop 1
    v_cndmask_b32 v8, v8, 0, vcc
    v_cmp_eq_u32 vcc, v16, v9
    s_nop 1
    v_cndmask_b32 v9, v9, 0, vcc
    v_cmp_eq_u32 vcc, v16, v10
    s_nop 1
    v_cndmask_b32 v10, v10, 0, vcc
    v_cmp_eq_u32 vcc, v16, v11
    s_nop 1
    v_cndmask_b32 v11, v11, 0, vcc
    v_cmp_eq_u32 vcc, v16, v12
    s_nop 1
    v_cndmask_b32 v12, v12, 0, vcc
    v_cmp_eq_u32 vcc, v16, v13
    s_nop 1
    v_cndmask_b32 v13, v13, 0, vcc
    v_cmp_eq_u32 vcc, v16, v14
    s_nop 1
    v_cndmask_b32 v14, v14, 0, vcc
    v_cmp_eq_u32 vcc, v16, v15
    s_nop 1
    v_cndmask_b32 v15, v15, 0, vcc
    v_max3_u32 v16, v8, v9, v10
    v_max3_u32 v16, v16, v11, v12
    v_max3_u32 v16, v16, v13, v14
    v_max_u32 v16, v16, v15
    s_nop 1
    v_max_u32_dpp v16, v16, v16 quad_perm:[1,0,3,2] row_mask:0xf bank_mask:0xf
    s_nop 1
    v_max_u32_dpp v16, v16, v16 quad_perm:[2,3,0,1] row_mask:0xf bank_mask:0xf
    s_nop 1
    v_max_u32_dpp v16, v16, v16 row_half_mirror row_mask:0xf bank_mask:0xf
    s_nop 1
    v_max_u32_dpp v16, v16, v16 row_mirror row_mask:0xf bank_mask:0xf
    v_mov_b32 v17, v16
    s_nop 1
    v_permlane16_swap_b32 v16, v17
    s_nop 1
    v_max_u32 v16, v16, v17
    v_mov_b32 v17, v16
    s_nop 1
    v_permlane32_swap_b32 v16, v17
    s_nop 1
    v_max_u32 v16, v16, v17
    ds_write_b32 v5, v16 offset:96
    s_waitcnt lgkmcnt(0)
    s_barrier
    ds_read_b128 v[20:23], v6 offset:96
    s_waitcnt lgkmcnt(0)
    v_max3_u32 v16, v20, v21, v22
    v_max_u32 v16, v16, v23
    v_mov_b32 v30, v16
    v_cmp_eq_u32 vcc, v16, v8
    s_nop 1
    v_cndmask_b32 v8, v8, 0, vcc
    v_cmp_eq_u32 vcc, v16, v9
    s_nop 1
    v_cndmask_b32 v9, v9, 0, vcc
    v_cmp_eq_u32 vcc, v16, v10
    s_nop 1
    v_cndmask_b32 v10, v10, 0, vcc
    v_cmp_eq_u32 vcc, v16, v11
    s_nop 1
    v_cndmask_b32 v11, v11, 0, vcc
    v_cmp_eq_u32 vcc, v16, v12
    s_nop 1
    v_cndmask_b32 v12, v12, 0, vcc
    v_cmp_eq_u32 vcc, v16, v13
    s_nop 1
    v_cndmask_b32 v13, v13, 0, vcc
    v_cmp_eq_u32 vcc, v16, v14
    s_nop 1
    v_cndmask_b32 v14, v14, 0, vcc
    v_cmp_eq_u32 vcc, v16, v15
    s_nop 1
    v_cndmask_b32 v15, v15, 0, vcc
    v_max3_u32 v16, v8, v9, v10
    v_max3_u32 v16, v16, v11, v12
    v_max3_u32 v16, v16, v13, v14
    v_max_u32 v16, v16, v15
    s_nop 1
    v_max_u32_dpp v16, v16, v16 quad_perm:[1,0,3,2] row_mask:0xf bank_mask:0xf
    s_nop 1
    v_max_u32_dpp v16, v16, v16 quad_perm:[2,3,0,1] row_mask:0xf bank_mask:0xf
    s_nop 1
    v_max_u32_dpp v16, v16, v16 row_half_mirror row_mask:0xf bank_mask:0xf
    s_nop 1
    v_max_u32_dpp v16, v16, v16 row_mirror row_mask:0xf bank_mask:0xf
    v_mov_b32 v17, v16
    s_nop 1
    v_permlane16_swap_b32 v16, v17
    s_nop 1
    v_max_u32 v16, v16, v17
    v_mov_b32 v17, v16
    s_nop 1
    v_permlane32_swap_b32 v16, v17
    s_nop 1
    v_max_u32 v16, v16, v17
    ds_write_b32 v5, v16 offset:112
    s_waitcnt lgkmcnt(0)
    s_barrier
    ds_read_b128 v[20:23], v6 offset:112
    s_waitcnt lgkmcnt(0)
    v_max3_u32 v16, v20, v21, v22
    v_max_u32 v16, v16, v23
    v_mov_b32 v31, v16
    v_cmp_eq_u32 vcc, v16, v8
    s_nop 1
    v_cndmask_b32 v8, v8, 0, vcc
    v_cmp_eq_u32 vcc, v16, v9
    s_nop 1
    v_cndmask_b32 v9, v9, 0, vcc
    v_cmp_eq_u32 vcc, v16, v10
    s_nop 1
    v_cndmask_b32 v10, v10, 0, vcc
    v_cmp_eq_u32 vcc, v16, v11
    s_nop 1
    v_cndmask_b32 v11, v11, 0, vcc
    v_cmp_eq_u32 vcc, v16, v12
    s_nop 1
    v_cndmask_b32 v12, v12, 0, vcc
    v_cmp_eq_u32 vcc, v16, v13
    s_nop 1
    v_cndmask_b32 v13, v13, 0, vcc
    v_cmp_eq_u32 vcc, v16, v14
    s_nop 1
    v_cndmask_b32 v14, v14, 0, vcc
    v_cmp_eq_u32 vcc, v16, v15
    s_nop 1
    v_cndmask_b32 v15, v15, 0, vcc
    v_and_b32 v24, 0x7ff, v24
    v_sub_u32 v24, 2047, v24
    v_and_b32 v25, 0x7ff, v25
    v_sub_u32 v25, 2047, v25
    v_and_b32 v26, 0x7ff, v26
    v_sub_u32 v26, 2047, v26
    v_and_b32 v27, 0x7ff, v27
    v_sub_u32 v27, 2047, v27
    v_and_b32 v28, 0x7ff, v28
    v_sub_u32 v28, 2047, v28
    v_and_b32 v29, 0x7ff, v29
    v_sub_u32 v29, 2047, v29
    v_and_b32 v30, 0x7ff, v30
    v_sub_u32 v30, 2047, v30
    v_and_b32 v31, 0x7ff, v31
    v_sub_u32 v31, 2047, v31
    v_mov_b32 v3, 4259840
    v_cmp_eq_u32 vcc, 0, v0
    s_and_saveexec_b64 s[14:15], vcc
    s_cbranch_execz WKT_TKSKIP
    global_store_dwordx4 v3, v[24:27], s[4:5] sc1
    global_store_dwordx4 v3, v[28:31], s[4:5] offset:16 sc1
    s_mov_b32 s41, 4521984
    s_waitcnt vmcnt(0)
    s_mov_b64 s[38:39], exec
    v_mov_b32 v240, s41
    v_mov_b32 v241, s56
    s_mov_b64 exec, 1
    global_store_dword v240, v241, s[4:5] sc1
    s_mov_b64 exec, s[38:39]
WKT_TKSKIP:
    s_mov_b64 exec, s[14:15]
    s_barrier
WK_NOTOPK:
    s_cmp_ge_u32 s40, 112
    s_cbranch_scc1 WK_NOM1
    v_mov_b32 v3, 4521984
WK_M1POLL:
    global_load_dword v4, v3, s[4:5] sc1
    s_waitcnt vmcnt(0)
    v_cmp_ne_u32 vcc, s56, v4
    s_cbranch_vccnz WK_M1POLL
    s_mov_b32 s10, s40
    s_load_dwordx2 s[6:7], s[0:1], 72
    s_load_dwordx2 s[8:9], s[0:1], 80
    v_and_b32 v3, 7, v2
    v_lshlrev_b32 v3, 2, v3
    v_add_u32 v3, 4259840, v3
    global_load_dword v4, v3, s[4:5] sc1
    v_lshrrev_b32 v5, 4, v2
    v_and_b32 v6, 15, v2
    v_mul_u32_u24 v7, 28672, v5
    v_lshlrev_b32 v6, 1, v6
    v_add_u32 v7, v7, v6
    s_mul_i32 s11, s3, 458752
    s_lshl_b32 s12, s10, 5
    s_add_u32 s11, s11, s12
    v_add_u32 v7, s11, v7
    v_add_u32 v8, 0, v7
    v_add_u32 v9, 3584, v7
    v_add_u32 v10, 7168, v7
    v_add_u32 v11, 10752, v7
    v_add_u32 v12, 14336, v7
    v_add_u32 v13, 17920, v7
    v_add_u32 v14, 21504, v7
    v_add_u32 v15, 25088, v7
    s_waitcnt vmcnt(0) lgkmcnt(0)
    v_lshlrev_b32 v4, 10, v4
    v_lshlrev_b32 v5, 4, v5
    v_add_u32 v4, v4, v5
    s_lshl_b32 s11, s3, 8
    v_add_u32 v4, s11, v4
    global_load_dwordx4 v[16:19], v4, s[4:5] offset:0
    global_load_dwordx4 v[20:23], v4, s[4:5] offset:64
    global_load_dwordx4 v[24:27], v4, s[4:5] offset:128
    global_load_dwordx4 v[28:31], v4, s[4:5] offset:192
    global_load_ushort v32, v8, s[6:7]
    global_load_ushort v64, v8, s[8:9]
    global_load_ushort v33, v9, s[6:7]
    global_load_ushort v65, v9, s[8:9]
    global_load_ushort v34, v10, s[6:7]
    global_load_ushort v66, v10, s[8:9]
    global_load_ushort v35, v11, s[6:7]
    global_load_ushort v67, v11, s[8:9]
    global_load_ushort v36, v12, s[6:7]
    global_load_ushort v68, v12, s[8:9]
    global_load_ushort v37, v13, s[6:7]
    global_load_ushort v69, v13, s[8:9]
    global_load_ushort v38, v14, s[6:7]
    global_load_ushort v70, v14, s[8:9]
    global_load_ushort v39, v15, s[6:7]
    global_load_ushort v71, v15, s[8:9]
    s_add_u32 s6, s6, 114688
    s_addc_u32 s7, s7, 0
    s_add_u32 s8, s8, 114688
    s_addc_u32 s9, s9, 0
    global_load_ushort v40, v8, s[6:7]
    global_load_ushort v72, v8, s[8:9]
    global_load_ushort v41, v9, s[6:7]
    global_load_ushort v73, v9, s[8:9]
    global_load_ushort v42, v10, s[6:7]
    global_load_ushort v74, v10, s[8:9]
    global_load_ushort v43, v11, s[6:7]
    global_load_ushort v75, v11, s[8:9]
    global_load_ushort v44, v12, s[6:7]
    global_load_ushort v76, v12, s[8:9]
    global_load_ushort v45, v13, s[6:7]
    global_load_ushort v77, v13, s[8:9]
    global_load_ushort v46, v14, s[6:7]
    global_load_ushort v78, v14, s[8:9]
    global_load_ushort v47, v15, s[6:7]
    global_load_ushort v79, v15, s[8:9]
    s_add_u32 s6, s6, 114688
    s_addc_u32 s7, s7, 0
    s_add_u32 s8, s8, 114688
    s_addc_u32 s9, s9, 0
    global_load_ushort v48, v8, s[6:7]
    global_load_ushort v80, v8, s[8:9]
    global_load_ushort v49, v9, s[6:7]
    global_load_ushort v81, v9, s[8:9]
    global_load_ushort v50, v10, s[6:7]
    global_load_ushort v82, v10, s[8:9]
    global_load_ushort v51, v11, s[6:7]
    global_load_ushort v83, v11, s[8:9]
    global_load_ushort v52, v12, s[6:7]
    global_load_ushort v84, v12, s[8:9]
    global_load_ushort v53, v13, s[6:7]
    global_load_ushort v85, v13, s[8:9]
    global_load_ushort v54, v14, s[6:7]
    global_load_ushort v86, v14, s[8:9]
    global_load_ushort v55, v15, s[6:7]
    global_load_ushort v87, v15, s[8:9]
    s_add_u32 s6, s6, 114688
    s_addc_u32 s7, s7, 0
    s_add_u32 s8, s8, 114688
    s_addc_u32 s9, s9, 0
    global_load_ushort v56, v8, s[6:7]
    global_load_ushort v88, v8, s[8:9]
    global_load_ushort v57, v9, s[6:7]
    global_load_ushort v89, v9, s[8:9]
    global_load_ushort v58, v10, s[6:7]
    global_load_ushort v90, v10, s[8:9]
    global_load_ushort v59, v11, s[6:7]
    global_load_ushort v91, v11, s[8:9]
    global_load_ushort v60, v12, s[6:7]
    global_load_ushort v92, v12, s[8:9]
    global_load_ushort v61, v13, s[6:7]
    global_load_ushort v93, v13, s[8:9]
    global_load_ushort v62, v14, s[6:7]
    global_load_ushort v94, v14, s[8:9]
    global_load_ushort v63, v15, s[6:7]
    global_load_ushort v95, v15, s[8:9]
    s_add_u32 s6, s6, 114688
    s_addc_u32 s7, s7, 0
    s_add_u32 s8, s8, 114688
    s_addc_u32 s9, s9, 0
    s_waitcnt vmcnt(0)
    v_lshl_or_b32 v32, v33, 16, v32
    v_lshl_or_b32 v64, v65, 16, v64
    v_lshl_or_b32 v33, v35, 16, v34
    v_lshl_or_b32 v65, v67, 16, v66
    v_lshl_or_b32 v34, v37, 16, v36
    v_lshl_or_b32 v66, v69, 16, v68
    v_lshl_or_b32 v35, v39, 16, v38
    v_lshl_or_b32 v67, v71, 16, v70
    v_lshl_or_b32 v40, v41, 16, v40
    v_lshl_or_b32 v72, v73, 16, v72
    v_lshl_or_b32 v41, v43, 16, v42
    v_lshl_or_b32 v73, v75, 16, v74
    v_lshl_or_b32 v42, v45, 16, v44
    v_lshl_or_b32 v74, v77, 16, v76
    v_lshl_or_b32 v43, v47, 16, v46
    v_lshl_or_b32 v75, v79, 16, v78
    v_lshl_or_b32 v48, v49, 16, v48
    v_lshl_or_b32 v80, v81, 16, v80
    v_lshl_or_b32 v49, v51, 16, v50
    v_lshl_or_b32 v81, v83, 16, v82
    v_lshl_or_b32 v50, v53, 16, v52
    v_lshl_or_b32 v82, v85, 16, v84
    v_lshl_or_b32 v51, v55, 16, v54
    v_lshl_or_b32 v83, v87, 16, v86
    v_lshl_or_b32 v56, v57, 16, v56
    v_lshl_or_b32 v88, v89, 16, v88
    v_lshl_or_b32 v57, v59, 16, v58
    v_lshl_or_b32 v89, v91, 16, v90
    v_lshl_or_b32 v58, v61, 16, v60
    v_lshl_or_b32 v90, v93, 16, v92
    v_lshl_or_b32 v59, v63, 16, v62
    v_lshl_or_b32 v91, v95, 16, v94
    s_nop 1
    v_mfma_f32_16x16x32_bf16 v[96:99], v[16:19], v[32:35], 0
    v_mfma_f32_16x16x32_bf16 v[100:103], v[16:19], v[64:67], 0
    v_mfma_f32_16x16x32_bf16 v[96:99], v[20:23], v[40:43], v[96:99]
    v_mfma_f32_16x16x32_bf16 v[100:103], v[20:23], v[72:75], v[100:103]
    v_mfma_f32_16x16x32_bf16 v[96:99], v[24:27], v[48:51], v[96:99]
    v_mfma_f32_16x16x32_bf16 v[100:103], v[24:27], v[80:83], v[100:103]
    v_mfma_f32_16x16x32_bf16 v[96:99], v[28:31], v[56:59], v[96:99]
    v_mfma_f32_16x16x32_bf16 v[100:103], v[28:31], v[88:91], v[100:103]
    s_nop 7
    v_lshlrev_b32 v3, 4, v2
    v_add_u32 v3, 0, v3
    s_lshl_b32 s11, s3, 11
    v_add_u32 v4, s11, v3
    ds_write_b128 v4, v[96:99]
    ds_write_b128 v4, v[100:103] offset:1024
    s_waitcnt lgkmcnt(0)
    s_barrier
    s_cmp_lg_u32 s3, 0
    s_cbranch_scc1 WK_M1DONE
    ds_read_b128 v[16:19], v3 offset:2048
    ds_read_b128 v[20:23], v3 offset:3072
    ds_read_b128 v[24:27], v3 offset:4096
    ds_read_b128 v[28:31], v3 offset:5120
    ds_read_b128 v[32:35], v3 offset:6144
    ds_read_b128 v[36:39], v3 offset:7168
    s_waitcnt lgkmcnt(0)
    v_add_f32 v96, v96, v16
    v_add_f32 v97, v97, v17
    v_add_f32 v98, v98, v18
    v_add_f32 v99, v99, v19
    v_add_f32 v100, v100, v20
    v_add_f32 v101, v101, v21
    v_add_f32 v102, v102, v22
    v_add_f32 v103, v103, v23
    v_add_f32 v96, v96, v24
    v_add_f32 v97, v97, v25
    v_add_f32 v98, v98, v26
    v_add_f32 v99, v99, v27
    v_add_f32 v100, v100, v28
    v_add_f32 v101, v101, v29
    v_add_f32 v102, v102, v30
    v_add_f32 v103, v103, v31
    v_add_f32 v96, v96, v32
    v_add_f32 v97, v97, v33
    v_add_f32 v98, v98, v34
    v_add_f32 v99, v99, v35
    v_add_f32 v100, v100, v36
    v_add_f32 v101, v101, v37
    v_add_f32 v102, v102, v38
    v_add_f32 v103, v103, v39
    v_cvt_pk_bf16_f32 v96, v96, v96
    v_lshlrev_b32 v96, 16, v96
    v_cvt_pk_bf16_f32 v97, v97, v97
    v_lshlrev_b32 v97, 16, v97
    v_cvt_pk_bf16_f32 v98, v98, v98
    v_lshlrev_b32 v98, 16, v98
    v_cvt_pk_bf16_f32 v99, v99, v99
    v_lshlrev_b32 v99, 16, v99
    v_cvt_pk_bf16_f32 v100, v100, v100
    v_lshlrev_b32 v100, 16, v100
    v_cvt_pk_bf16_f32 v101, v101, v101
    v_lshlrev_b32 v101, 16, v101
    v_cvt_pk_bf16_f32 v102, v102, v102
    v_lshlrev_b32 v102, 16, v102
    v_cvt_pk_bf16_f32 v103, v103, v103
    v_lshlrev_b32 v103, 16, v103
    v_mov_b32 v8, 0x3fb8aa3b
    v_mul_f32 v9, v8, v96
    v_exp_f32 v9, -v9
    s_nop 0
    v_add_f32 v9, 1.0, v9
    v_rcp_f32 v9, v9
    s_nop 0
    v_mul_f32 v96, v96, v9
    v_cvt_pk_bf16_f32 v96, v96, v96
    v_lshlrev_b32 v96, 16, v96
    v_mul_f32 v96, v96, v100
    v_cvt_pk_bf16_f32 v96, v96, v96
    v_mul_f32 v9, v8, v97
    v_exp_f32 v9, -v9
    s_nop 0
    v_add_f32 v9, 1.0, v9
    v_rcp_f32 v9, v9
    s_nop 0
    v_mul_f32 v97, v97, v9
    v_cvt_pk_bf16_f32 v97, v97, v97
    v_lshlrev_b32 v97, 16, v97
    v_mul_f32 v97, v97, v101
    v_cvt_pk_bf16_f32 v97, v97, v97
    v_mul_f32 v9, v8, v98
    v_exp_f32 v9, -v9
    s_nop 0
    v_add_f32 v9, 1.0, v9
    v_rcp_f32 v9, v9
    s_nop 0
    v_mul_f32 v98, v98, v9
    v_cvt_pk_bf16_f32 v98, v98, v98
    v_lshlrev_b32 v98, 16, v98
    v_mul_f32 v98, v98, v102
    v_cvt_pk_bf16_f32 v98, v98, v98
    v_mul_f32 v9, v8, v99
    v_exp_f32 v9, -v9
    s_nop 0
    v_add_f32 v9, 1.0, v9
    v_rcp_f32 v9, v9
    s_nop 0
    v_mul_f32 v99, v99, v9
    v_cvt_pk_bf16_f32 v99, v99, v99
    v_lshlrev_b32 v99, 16, v99
    v_mul_f32 v99, v99, v103
    v_cvt_pk_bf16_f32 v99, v99, v99
    v_lshrrev_b32 v5, 4, v2
    v_mul_u32_u24 v5, 14336, v5
    v_and_b32 v6, 15, v2
    v_lshlrev_b32 v6, 1, v6
    v_add_u32 v5, v5, v6
    s_lshl_b32 s12, s10, 5
    s_add_u32 s12, s12, 4263936
    v_add_u32 v5, s12, v5
    s_mov_b64 exec, 0xffffffff
    global_store_short v5, v96, s[4:5] sc1
    v_add_u32 v5, 3584, v5
    global_store_short v5, v97, s[4:5] sc1
    v_add_u32 v5, 3584, v5
    global_store_short v5, v98, s[4:5] sc1
    v_add_u32 v5, 3584, v5
    global_store_short v5, v99, s[4:5] sc1
    v_add_u32 v5, 3584, v5
    s_lshl_b32 s41, s10, 2
    s_add_u32 s41, s41, 4522496
    s_waitcnt vmcnt(0)
    s_mov_b64 s[38:39], exec
    v_mov_b32 v240, s41
    v_mov_b32 v241, s56
    s_mov_b64 exec, 1
    global_store_dword v240, v241, s[4:5] sc1
    s_mov_b64 exec, s[38:39]
    s_mov_b64 exec, -1
WK_M1DONE:
    s_barrier
WK_NOM1:
    s_cmp_lt_u32 s40, 112
    s_cbranch_scc1 WK_NOM2
    s_cmp_ge_u32 s40, 144
    s_cbranch_scc1 WK_NOM2
    v_lshlrev_b32 v3, 3, v2
    v_add_u32 v3, 4522496, v3
WK_M2POLL:
    global_load_dwordx2 v[4:5], v3, s[4:5] sc1
    s_waitcnt vmcnt(0)
    v_xor_b32 v4, s56, v4
    v_xor_b32 v5, s56, v5
    v_or_b32 v4, v4, v5
    v_cmp_ne_u32 vcc, 0, v4
    s_and_b32 s41, vcc_hi, 0x00ffffff
    s_or_b32 s41, s41, vcc_lo
    s_cbranch_scc1 WK_M2POLL
    s_sub_u32 s10, s40, 112
    s_load_dwordx2 s[6:7], s[0:1], 88
    v_lshrrev_b32 v5, 4, v2
    v_and_b32 v6, 15, v2
    v_lshlrev_b32 v7, 13, v5
    v_lshlrev_b32 v6, 1, v6
    v_add_u32 v7, v7, v6
    s_mul_i32 s11, s3, 458752
    s_lshl_b32 s12, s10, 5
    s_add_u32 s11, s11, s12
    v_add_u32 v7, s11, v7
    v_add_u32 v8, 0, v7
    v_add_u32 v9, 1024, v7
    v_add_u32 v10, 2048, v7
    v_add_u32 v11, 3072, v7
    v_add_u32 v12, 4096, v7
    v_add_u32 v13, 5120, v7
    v_add_u32 v14, 6144, v7
    v_add_u32 v15, 7168, v7
    v_and_b32 v4, 7, v2
    v_mul_u32_u24 v4, 3584, v4
    v_lshlrev_b32 v5, 4, v5
    v_add_u32 v4, v4, v5
    s_mul_i32 s11, s3, 896
    s_add_u32 s11, s11, 4263936
    v_add_u32 v4, s11, v4
    s_waitcnt lgkmcnt(0)
    global_load_dwordx4 v[16:19], v4, s[4:5] offset:0 sc1
    global_load_dwordx4 v[20:23], v4, s[4:5] offset:64 sc1
    global_load_dwordx4 v[24:27], v4, s[4:5] offset:128 sc1
    global_load_dwordx4 v[28:31], v4, s[4:5] offset:192 sc1
    global_load_dwordx4 v[32:35], v4, s[4:5] offset:256 sc1
    global_load_dwordx4 v[36:39], v4, s[4:5] offset:320 sc1
    global_load_dwordx4 v[40:43], v4, s[4:5] offset:384 sc1
    global_load_dwordx4 v[44:47], v4, s[4:5] offset:448 sc1
    global_load_dwordx4 v[48:51], v4, s[4:5] offset:512 sc1
    global_load_dwordx4 v[52:55], v4, s[4:5] offset:576 sc1
    global_load_dwordx4 v[56:59], v4, s[4:5] offset:640 sc1
    global_load_dwordx4 v[60:63], v4, s[4:5] offset:704 sc1
    global_load_dwordx4 v[64:67], v4, s[4:5] offset:768 sc1
    global_load_dwordx4 v[68:71], v4, s[4:5] offset:832 sc1
    global_load_ushort v72, v8, s[6:7]
    global_load_ushort v73, v9, s[6:7]
    global_load_ushort v74, v10, s[6:7]
    global_load_ushort v75, v11, s[6:7]
    global_load_ushort v76, v12, s[6:7]
    global_load_ushort v77, v13, s[6:7]
    global_load_ushort v78, v14, s[6:7]
    global_load_ushort v79, v15, s[6:7]
    s_add_u32 s6, s6, 32768
    s_addc_u32 s7, s7, 0
    global_load_ushort v80, v8, s[6:7]
    global_load_ushort v81, v9, s[6:7]
    global_load_ushort v82, v10, s[6:7]
    global_load_ushort v83, v11, s[6:7]
    global_load_ushort v84, v12, s[6:7]
    global_load_ushort v85, v13, s[6:7]
    global_load_ushort v86, v14, s[6:7]
    global_load_ushort v87, v15, s[6:7]
    s_add_u32 s6, s6, 32768
    s_addc_u32 s7, s7, 0
    global_load_ushort v88, v8, s[6:7]
    global_load_ushort v89, v9, s[6:7]
    global_load_ushort v90, v10, s[6:7]
    global_load_ushort v91, v11, s[6:7]
    global_load_ushort v92, v12, s[6:7]
    global_load_ushort v93, v13, s[6:7]
    global_load_ushort v94, v14, s[6:7]
    global_load_ushort v95, v15, s[6:7]
    s_add_u32 s6, s6, 32768
    s_addc_u32 s7, s7, 0
    global_load_ushort v96, v8, s[6:7]
    global_load_ushort v97, v9, s[6:7]
    global_load_ushort v98, v10, s[6:7]
    global_load_ushort v99, v11, s[6:7]
    global_load_ushort v100, v12, s[6:7]
    global_load_ushort v101, v13, s[6:7]
    global_load_ushort v102, v14, s[6:7]
    global_load_ushort v103, v15, s[6:7]
    s_add_u32 s6, s6, 32768
    s_addc_u32 s7, s7, 0
    global_load_ushort v104, v8, s[6:7]
    global_load_ushort v105, v9, s[6:7]
    global_load_ushort v106, v10, s[6:7]
    global_load_ushort v107, v11, s[6:7]
    global_load_ushort v108, v12, s[6:7]
    global_load_ushort v109, v13, s[6:7]
    global_load_ushort v110, v14, s[6:7]
    global_load_ushort v111, v15, s[6:7]
    s_add_u32 s6, s6, 32768
    s_addc_u32 s7, s7, 0
    global_load_ushort v112, v8, s[6:7]
    global_load_ushort v113, v9, s[6:7]
    global_load_ushort v114, v10, s[6:7]
    global_load_ushort v115, v11, s[6:7]
    global_load_ushort v116, v12, s[6:7]
    global_load_ushort v117, v13, s[6:7]
    global_load_ushort v118, v14, s[6:7]
    global_load_ushort v119, v15, s[6:7]
    s_add_u32 s6, s6, 32768
    s_addc_u32 s7, s7, 0
    global_load_ushort v120, v8, s[6:7]
    global_load_ushort v121, v9, s[6:7]
    global_load_ushort v122, v10, s[6:7]
    global_load_ushort v123, v11, s[6:7]
    global_load_ushort v124, v12, s[6:7]
    global_load_ushort v125, v13, s[6:7]
    global_load_ushort v126, v14, s[6:7]
    global_load_ushort v127, v15, s[6:7]
    s_add_u32 s6, s6, 32768
    s_addc_u32 s7, s7, 0
    global_load_ushort v128, v8, s[6:7]
    global_load_ushort v129, v9, s[6:7]
    global_load_ushort v130, v10, s[6:7]
    global_load_ushort v131, v11, s[6:7]
    global_load_ushort v132, v12, s[6:7]
    global_load_ushort v133, v13, s[6:7]
    global_load_ushort v134, v14, s[6:7]
    global_load_ushort v135, v15, s[6:7]
    s_add_u32 s6, s6, 32768
    s_addc_u32 s7, s7, 0
    global_load_ushort v136, v8, s[6:7]
    global_load_ushort v137, v9, s[6:7]
    global_load_ushort v138, v10, s[6:7]
    global_load_ushort v139, v11, s[6:7]
    global_load_ushort v140, v12, s[6:7]
    global_load_ushort v141, v13, s[6:7]
    global_load_ushort v142, v14, s[6:7]
    global_load_ushort v143, v15, s[6:7]
    s_add_u32 s6, s6, 32768
    s_addc_u32 s7, s7, 0
    global_load_ushort v144, v8, s[6:7]
    global_load_ushort v145, v9, s[6:7]
    global_load_ushort v146, v10, s[6:7]
    global_load_ushort v147, v11, s[6:7]
    global_load_ushort v148, v12, s[6:7]
    global_load_ushort v149, v13, s[6:7]
    global_load_ushort v150, v14, s[6:7]
    global_load_ushort v151, v15, s[6:7]
    s_add_u32 s6, s6, 32768
    s_addc_u32 s7, s7, 0
    global_load_ushort v152, v8, s[6:7]
    global_load_ushort v153, v9, s[6:7]
    global_load_ushort v154, v10, s[6:7]
    global_load_ushort v155, v11, s[6:7]
    global_load_ushort v156, v12, s[6:7]
    global_load_ushort v157, v13, s[6:7]
    global_load_ushort v158, v14, s[6:7]
    global_load_ushort v159, v15, s[6:7]
    s_add_u32 s6, s6, 32768
    s_addc_u32 s7, s7, 0
    global_load_ushort v160, v8, s[6:7]
    global_load_ushort v161, v9, s[6:7]
    global_load_ushort v162, v10, s[6:7]
    global_load_ushort v163, v11, s[6:7]
    global_load_ushort v164, v12, s[6:7]
    global_load_ushort v165, v13, s[6:7]
    global_load_ushort v166, v14, s[6:7]
    global_load_ushort v167, v15, s[6:7]
    s_add_u32 s6, s6, 32768
    s_addc_u32 s7, s7, 0
    global_load_ushort v168, v8, s[6:7]
    global_load_ushort v169, v9, s[6:7]
    global_load_ushort v170, v10, s[6:7]
    global_load_ushort v171, v11, s[6:7]
    global_load_ushort v172, v12, s[6:7]
    global_load_ushort v173, v13, s[6:7]
    global_load_ushort v174, v14, s[6:7]
    global_load_ushort v175, v15, s[6:7]
    s_add_u32 s6, s6, 32768
    s_addc_u32 s7, s7, 0
    global_load_ushort v176, v8, s[6:7]
    global_load_ushort v177, v9, s[6:7]
    global_load_ushort v178, v10, s[6:7]
    global_load_ushort v179, v11, s[6:7]
    global_load_ushort v180, v12, s[6:7]
    global_load_ushort v181, v13, s[6:7]
    global_load_ushort v182, v14, s[6:7]
    global_load_ushort v183, v15, s[6:7]
    s_add_u32 s6, s6, 32768
    s_addc_u32 s7, s7, 0
    s_waitcnt vmcnt(0)
    v_lshl_or_b32 v72, v73, 16, v72
    v_lshl_or_b32 v73, v75, 16, v74
    v_lshl_or_b32 v74, v77, 16, v76
    v_lshl_or_b32 v75, v79, 16, v78
    v_lshl_or_b32 v80, v81, 16, v80
    v_lshl_or_b32 v81, v83, 16, v82
    v_lshl_or_b32 v82, v85, 16, v84
    v_lshl_or_b32 v83, v87, 16, v86
    v_lshl_or_b32 v88, v89, 16, v88
    v_lshl_or_b32 v89, v91, 16, v90
    v_lshl_or_b32 v90, v93, 16, v92
    v_lshl_or_b32 v91, v95, 16, v94
    v_lshl_or_b32 v96, v97, 16, v96
    v_lshl_or_b32 v97, v99, 16, v98
    v_lshl_or_b32 v98, v101, 16, v100
    v_lshl_or_b32 v99, v103, 16, v102
    v_lshl_or_b32 v104, v105, 16, v104
    v_lshl_or_b32 v105, v107, 16, v106
    v_lshl_or_b32 v106, v109, 16, v108
    v_lshl_or_b32 v107, v111, 16, v110
    v_lshl_or_b32 v112, v113, 16, v112
    v_lshl_or_b32 v113, v115, 16, v114
    v_lshl_or_b32 v114, v117, 16, v116
    v_lshl_or_b32 v115, v119, 16, v118
    v_lshl_or_b32 v120, v121, 16, v120
    v_lshl_or_b32 v121, v123, 16, v122
    v_lshl_or_b32 v122, v125, 16, v124
    v_lshl_or_b32 v123, v127, 16, v126
    v_lshl_or_b32 v128, v129, 16, v128
    v_lshl_or_b32 v129, v131, 16, v130
    v_lshl_or_b32 v130, v133, 16, v132
    v_lshl_or_b32 v131, v135, 16, v134
    v_lshl_or_b32 v136, v137, 16, v136
    v_lshl_or_b32 v137, v139, 16, v138
    v_lshl_or_b32 v138, v141, 16, v140
    v_lshl_or_b32 v139, v143, 16, v142
    v_lshl_or_b32 v144, v145, 16, v144
    v_lshl_or_b32 v145, v147, 16, v146
    v_lshl_or_b32 v146, v149, 16, v148
    v_lshl_or_b32 v147, v151, 16, v150
    v_lshl_or_b32 v152, v153, 16, v152
    v_lshl_or_b32 v153, v155, 16, v154
    v_lshl_or_b32 v154, v157, 16, v156
    v_lshl_or_b32 v155, v159, 16, v158
    v_lshl_or_b32 v160, v161, 16, v160
    v_lshl_or_b32 v161, v163, 16, v162
    v_lshl_or_b32 v162, v165, 16, v164
    v_lshl_or_b32 v163, v167, 16, v166
    v_lshl_or_b32 v168, v169, 16, v168
    v_lshl_or_b32 v169, v171, 16, v170
    v_lshl_or_b32 v170, v173, 16, v172
    v_lshl_or_b32 v171, v175, 16, v174
    v_lshl_or_b32 v176, v177, 16, v176
    v_lshl_or_b32 v177, v179, 16, v178
    v_lshl_or_b32 v178, v181, 16, v180
    v_lshl_or_b32 v179, v183, 16, v182
    s_nop 1
    v_mfma_f32_16x16x32_bf16 v[8:11], v[16:19], v[72:75], 0
    v_mfma_f32_16x16x32_bf16 v[8:11], v[20:23], v[80:83], v[8:11]
    v_mfma_f32_16x16x32_bf16 v[8:11], v[24:27], v[88:91], v[8:11]
    v_mfma_f32_16x16x32_bf16 v[8:11], v[28:31], v[96:99], v[8:11]
    v_mfma_f32_16x16x32_bf16 v[8:11], v[32:35], v[104:107], v[8:11]
    v_mfma_f32_16x16x32_bf16 v[8:11], v[36:39], v[112:115], v[8:11]
    v_mfma_f32_16x16x32_bf16 v[8:11], v[40:43], v[120:123], v[8:11]
    v_mfma_f32_16x16x32_bf16 v[8:11], v[44:47], v[128:131], v[8:11]
    v_mfma_f32_16x16x32_bf16 v[8:11], v[48:51], v[136:139], v[8:11]
    v_mfma_f32_16x16x32_bf16 v[8:11], v[52:55], v[144:147], v[8:11]
    v_mfma_f32_16x16x32_bf16 v[8:11], v[56:59], v[152:155], v[8:11]
    v_mfma_f32_16x16x32_bf16 v[8:11], v[60:63], v[160:163], v[8:11]
    v_mfma_f32_16x16x32_bf16 v[8:11], v[64:67], v[168:171], v[8:11]
    v_mfma_f32_16x16x32_bf16 v[8:11], v[68:71], v[176:179], v[8:11]
    s_nop 7
    v_lshlrev_b32 v3, 4, v2
    v_add_u32 v3, 0, v3
    s_lshl_b32 s11, s3, 10
    v_add_u32 v4, s11, v3
    ds_write_b128 v4, v[8:11]
    s_waitcnt lgkmcnt(0)
    s_barrier
    s_cmp_lg_u32 s3, 0
    s_cbranch_scc1 WK_M2DONE
    ds_read_b128 v[12:15], v3 offset:1024
    ds_read_b128 v[16:19], v3 offset:2048
    ds_read_b128 v[20:23], v3 offset:3072
    v_lshrrev_b32 v5, 4, v2
    v_and_b32 v5, 1, v5
    v_lshlrev_b32 v5, 4, v5
    v_add_u32 v5, 4259840, v5
    global_load_dwordx4 v[24:27], v5, s[4:5] sc1
    s_waitcnt vmcnt(0) lgkmcnt(0)
    v_add_f32 v8, v8, v12
    v_add_f32 v9, v9, v13
    v_add_f32 v10, v10, v14
    v_add_f32 v11, v11, v15
    v_add_f32 v8, v8, v16
    v_add_f32 v9, v9, v17
    v_add_f32 v10, v10, v18
    v_add_f32 v11, v11, v19
    v_add_f32 v8, v8, v20
    v_add_f32 v9, v9, v21
    v_add_f32 v10, v10, v22
    v_add_f32 v11, v11, v23
    v_and_b32 v6, 15, v2
    v_lshlrev_b32 v6, 1, v6
    s_lshl_b32 s12, s10, 5
    v_add_u32 v6, s12, v6
    v_lshlrev_b32 v28, 2, v24
    v_add_u32 v28, 4194304, v28
    global_load_dword v32, v28, s[4:5]
    v_lshlrev_b32 v40, 10, v24
    v_add_u32 v40, v40, v6
    global_load_ushort v36, v40, s[4:5]
    v_lshlrev_b32 v28, 2, v25
    v_add_u32 v28, 4194304, v28
    global_load_dword v33, v28, s[4:5]
    v_lshlrev_b32 v41, 10, v25
    v_add_u32 v41, v41, v6
    global_load_ushort v37, v41, s[4:5]
    v_lshlrev_b32 v28, 2, v26
    v_add_u32 v28, 4194304, v28
    global_load_dword v34, v28, s[4:5]
    v_lshlrev_b32 v42, 10, v26
    v_add_u32 v42, v42, v6
    global_load_ushort v38, v42, s[4:5]
    v_lshlrev_b32 v28, 2, v27
    v_add_u32 v28, 4194304, v28
    global_load_dword v35, v28, s[4:5]
    v_lshlrev_b32 v43, 10, v27
    v_add_u32 v43, v43, v6
    global_load_ushort v39, v43, s[4:5]
    s_waitcnt vmcnt(0)
    v_mov_b32 v29, 0x3fb8aa3b
    v_cvt_pk_bf16_f32 v8, v8, v8
    v_lshlrev_b32 v8, 16, v8
    v_mul_f32 v30, v29, v32
    v_exp_f32 v30, -v30
    s_nop 0
    v_add_f32 v30, 1.0, v30
    v_rcp_f32 v30, v30
    s_nop 0
    v_cvt_pk_bf16_f32 v30, v30, v30
    v_lshlrev_b32 v30, 16, v30
    v_mul_f32 v8, v8, v30
    v_cvt_pk_bf16_f32 v8, v8, v8
    v_lshlrev_b32 v8, 16, v8
    v_lshlrev_b32 v36, 16, v36
    v_add_f32 v8, v8, v36
    v_cvt_pk_bf16_f32 v8, v8, v8
    v_cvt_pk_bf16_f32 v9, v9, v9
    v_lshlrev_b32 v9, 16, v9
    v_mul_f32 v30, v29, v33
    v_exp_f32 v30, -v30
    s_nop 0
    v_add_f32 v30, 1.0, v30
    v_rcp_f32 v30, v30
    s_nop 0
    v_cvt_pk_bf16_f32 v30, v30, v30
    v_lshlrev_b32 v30, 16, v30
    v_mul_f32 v9, v9, v30
    v_cvt_pk_bf16_f32 v9, v9, v9
    v_lshlrev_b32 v9, 16, v9
    v_lshlrev_b32 v37, 16, v37
    v_add_f32 v9, v9, v37
    v_cvt_pk_bf16_f32 v9, v9, v9
    v_cvt_pk_bf16_f32 v10, v10, v10
    v_lshlrev_b32 v10, 16, v10
    v_mul_f32 v30, v29, v34
    v_exp_f32 v30, -v30
    s_nop 0
    v_add_f32 v30, 1.0, v30
    v_rcp_f32 v30, v30
    s_nop 0
    v_cvt_pk_bf16_f32 v30, v30, v30
    v_lshlrev_b32 v30, 16, v30
    v_mul_f32 v10, v10, v30
    v_cvt_pk_bf16_f32 v10, v10, v10
    v_lshlrev_b32 v10, 16, v10
    v_lshlrev_b32 v38, 16, v38
    v_add_f32 v10, v10, v38
    v_cvt_pk_bf16_f32 v10, v10, v10
    v_cvt_pk_bf16_f32 v11, v11, v11
    v_lshlrev_b32 v11, 16, v11
    v_mul_f32 v30, v29, v35
    v_exp_f32 v30, -v30
    s_nop 0
    v_add_f32 v30, 1.0, v30
    v_rcp_f32 v30, v30
    s_nop 0
    v_cvt_pk_bf16_f32 v30, v30, v30
    v_lshlrev_b32 v30, 16, v30
    v_mul_f32 v11, v11, v30
    v_cvt_pk_bf16_f32 v11, v11, v11
    v_lshlrev_b32 v11, 16, v11
    v_lshlrev_b32 v39, 16, v39
    v_add_f32 v11, v11, v39
    v_cvt_pk_bf16_f32 v11, v11, v11
    s_mov_b64 exec, 0xffffffff
    global_store_short v40, v8, s[4:5] sc1
    global_store_short v41, v9, s[4:5] sc1
    global_store_short v42, v10, s[4:5] sc1
    global_store_short v43, v11, s[4:5] sc1
    s_lshl_b32 s41, s10, 2
    s_add_u32 s41, s41, 4523008
    s_waitcnt vmcnt(0)
    s_mov_b64 s[38:39], exec
    v_mov_b32 v240, s41
    v_mov_b32 v241, s56
    s_mov_b64 exec, 1
    global_store_dword v240, v241, s[4:5] sc1
    s_mov_b64 exec, s[38:39]
    s_mov_b64 exec, -1
WK_M2DONE:
    s_barrier
WK_NOM2:
    s_load_dwordx2 s[6:7], s[0:1], 0
    s_load_dwordx2 s[8:9], s[0:1], 96
    s_lshr_b32 s42, s40, 4
    s_and_b32 s43, s40, 15
    v_lshlrev_b32 v3, 4, v2
    s_load_dwordx2 s[20:21], s[0:1], 40
    v_and_b32 v144, 1, v2
    v_lshlrev_b32 v144, 4, v144
    v_mov_b32 v145, 0x3f80
    v_lshlrev_b32 v144, v144, v145
    v_lshrrev_b32 v145, 4, v2
    v_bfe_u32 v146, v2, 3, 1
    v_sub_u32 v145, v145, v146
    v_lshlrev_b32 v145, 2, v145
    v_bfe_u32 v146, v2, 1, 2
    v_add_u32 v145, v145, v146
    v_cmp_eq_u32 vcc, 0, v145
    s_nop 1
    v_cndmask_b32 v224, 0, v144, vcc
    v_cmp_eq_u32 vcc, 1, v145
    s_nop 1
    v_cndmask_b32 v225, 0, v144, vcc
    v_cmp_eq_u32 vcc, 2, v145
    s_nop 1
    v_cndmask_b32 v226, 0, v144, vcc
    v_cmp_eq_u32 vcc, 3, v145
    s_nop 1
    v_cndmask_b32 v227, 0, v144, vcc
    v_cmp_eq_u32 vcc, 8, v145
    s_nop 1
    v_cndmask_b32 v228, 0, v144, vcc
    v_cmp_eq_u32 vcc, 9, v145
    s_nop 1
    v_cndmask_b32 v229, 0, v144, vcc
    v_cmp_eq_u32 vcc, 10, v145
    s_nop 1
    v_cndmask_b32 v230, 0, v144, vcc
    v_cmp_eq_u32 vcc, 11, v145
    s_nop 1
    v_cndmask_b32 v231, 0, v144, vcc
    v_and_b32 v4, 15, v2
    v_lshlrev_b32 v4, 10, v4
    v_lshrrev_b32 v5, 4, v2
    v_lshlrev_b32 v5, 4, v5
    v_add_u32 v4, v4, v5
    v_add_u32 v5, 16384, v4
    s_lshl_b32 s12, s3, 20
    s_lshl_b32 s13, s43, 6
    s_add_u32 s12, s12, s13
    s_waitcnt lgkmcnt(0)
    s_mov_b64 s[44:45], s[6:7]
    s_mov_b64 s[46:47], s[8:9]
    s_add_u32 s20, s20, s12
    s_addc_u32 s21, s21, 0
    s_waitcnt vmcnt(0)
    global_load_dwordx4 a[0:3], v4, s[20:21]
    global_load_dwordx4 a[4:7], v5, s[20:21]
    s_add_u32 s20, s20, 32768
    s_addc_u32 s21, s21, 0
    global_load_dwordx4 a[8:11], v4, s[20:21]
    global_load_dwordx4 a[12:15], v5, s[20:21]
    s_add_u32 s20, s20, 32768
    s_addc_u32 s21, s21, 0
    global_load_dwordx4 a[16:19], v4, s[20:21]
    global_load_dwordx4 a[20:23], v5, s[20:21]
    s_add_u32 s20, s20, 32768
    s_addc_u32 s21, s21, 0
    global_load_dwordx4 a[24:27], v4, s[20:21]
    global_load_dwordx4 a[28:31], v5, s[20:21]
    s_add_u32 s20, s20, 32768
    s_addc_u32 s21, s21, 0
    global_load_dwordx4 a[32:35], v4, s[20:21]
    global_load_dwordx4 a[36:39], v5, s[20:21]
    s_add_u32 s20, s20, 32768
    s_addc_u32 s21, s21, 0
    global_load_dwordx4 a[40:43], v4, s[20:21]
    global_load_dwordx4 a[44:47], v5, s[20:21]
    s_add_u32 s20, s20, 32768
    s_addc_u32 s21, s21, 0
    global_load_dwordx4 a[48:51], v4, s[20:21]
    global_load_dwordx4 a[52:55], v5, s[20:21]
    s_add_u32 s20, s20, 32768
    s_addc_u32 s21, s21, 0
    global_load_dwordx4 a[56:59], v4, s[20:21]
    global_load_dwordx4 a[60:63], v5, s[20:21]
    s_add_u32 s20, s20, 32768
    s_addc_u32 s21, s21, 0
    global_load_dwordx4 a[64:67], v4, s[20:21]
    global_load_dwordx4 a[68:71], v5, s[20:21]
    s_add_u32 s20, s20, 32768
    s_addc_u32 s21, s21, 0
    global_load_dwordx4 a[72:75], v4, s[20:21]
    global_load_dwordx4 a[76:79], v5, s[20:21]
    s_add_u32 s20, s20, 32768
    s_addc_u32 s21, s21, 0
    global_load_dwordx4 a[80:83], v4, s[20:21]
    global_load_dwordx4 a[84:87], v5, s[20:21]
    s_add_u32 s20, s20, 32768
    s_addc_u32 s21, s21, 0
    global_load_dwordx4 a[88:91], v4, s[20:21]
    global_load_dwordx4 a[92:95], v5, s[20:21]
    s_add_u32 s20, s20, 32768
    s_addc_u32 s21, s21, 0
    global_load_dwordx4 a[96:99], v4, s[20:21]
    global_load_dwordx4 a[100:103], v5, s[20:21]
    s_add_u32 s20, s20, 32768
    s_addc_u32 s21, s21, 0
    global_load_dwordx4 a[104:107], v4, s[20:21]
    global_load_dwordx4 a[108:111], v5, s[20:21]
    s_add_u32 s20, s20, 32768
    s_addc_u32 s21, s21, 0
    global_load_dwordx4 a[112:115], v4, s[20:21]
    global_load_dwordx4 a[116:119], v5, s[20:21]
    s_add_u32 s20, s20, 32768
    s_addc_u32 s21, s21, 0
    global_load_dwordx4 a[120:123], v4, s[20:21]
    global_load_dwordx4 a[124:127], v5, s[20:21]
    s_add_u32 s20, s20, 32768
    s_addc_u32 s21, s21, 0
    global_load_dwordx4 a[128:131], v4, s[20:21]
    global_load_dwordx4 a[132:135], v5, s[20:21]
    s_add_u32 s20, s20, 32768
    s_addc_u32 s21, s21, 0
    global_load_dwordx4 a[136:139], v4, s[20:21]
    global_load_dwordx4 a[140:143], v5, s[20:21]
    s_add_u32 s20, s20, 32768
    s_addc_u32 s21, s21, 0
    global_load_dwordx4 a[144:147], v4, s[20:21]
    global_load_dwordx4 a[148:151], v5, s[20:21]
    s_add_u32 s20, s20, 32768
    s_addc_u32 s21, s21, 0
    global_load_dwordx4 a[152:155], v4, s[20:21]
    global_load_dwordx4 a[156:159], v5, s[20:21]
    s_add_u32 s20, s20, 32768
    s_addc_u32 s21, s21, 0
    global_load_dwordx4 a[160:163], v4, s[20:21]
    global_load_dwordx4 a[164:167], v5, s[20:21]
    s_add_u32 s20, s20, 32768
    s_addc_u32 s21, s21, 0
    global_load_dwordx4 a[168:171], v4, s[20:21]
    global_load_dwordx4 a[172:175], v5, s[20:21]
    s_add_u32 s20, s20, 32768
    s_addc_u32 s21, s21, 0
    global_load_dwordx4 a[176:179], v4, s[20:21]
    global_load_dwordx4 a[180:183], v5, s[20:21]
    s_add_u32 s20, s20, 32768
    s_addc_u32 s21, s21, 0
    global_load_dwordx4 a[184:187], v4, s[20:21]
    global_load_dwordx4 a[188:191], v5, s[20:21]
    s_add_u32 s20, s20, 32768
    s_addc_u32 s21, s21, 0
    global_load_dwordx4 a[192:195], v4, s[20:21]
    global_load_dwordx4 a[196:199], v5, s[20:21]
    s_add_u32 s20, s20, 32768
    s_addc_u32 s21, s21, 0
    global_load_dwordx4 a[200:203], v4, s[20:21]
    global_load_dwordx4 a[204:207], v5, s[20:21]
    s_add_u32 s20, s20, 32768
    s_addc_u32 s21, s21, 0
    global_load_dwordx4 a[208:211], v4, s[20:21]
    global_load_dwordx4 a[212:215], v5, s[20:21]
    s_add_u32 s20, s20, 32768
    s_addc_u32 s21, s21, 0
    global_load_dwordx4 a[216:219], v4, s[20:21]
    global_load_dwordx4 a[220:223], v5, s[20:21]
    s_add_u32 s20, s20, 32768
    s_addc_u32 s21, s21, 0
    global_load_dwordx4 a[224:227], v4, s[20:21]
    global_load_dwordx4 a[228:231], v5, s[20:21]
    s_add_u32 s20, s20, 32768
    s_addc_u32 s21, s21, 0
    global_load_dwordx4 a[232:235], v4, s[20:21]
    global_load_dwordx4 a[236:239], v5, s[20:21]
    s_add_u32 s20, s20, 32768
    s_addc_u32 s21, s21, 0
    global_load_dwordx4 a[240:243], v4, s[20:21]
    global_load_dwordx4 a[244:247], v5, s[20:21]
    s_add_u32 s20, s20, 32768
    s_addc_u32 s21, s21, 0
    global_load_dwordx4 a[248:251], v4, s[20:21]
    global_load_dwordx4 a[252:255], v5, s[20:21]
    s_add_u32 s20, s20, 32768
    s_addc_u32 s21, s21, 0
    s_waitcnt vmcnt(62)
    v_mfma_f32_16x16x32_bf16 v[144:147], a[0:3], v[224:227], 0
    v_mfma_f32_16x16x32_bf16 v[148:151], a[0:3], v[228:231], 0
    v_mfma_f32_16x16x32_bf16 v[152:155], a[4:7], v[224:227], 0
    v_mfma_f32_16x16x32_bf16 v[156:159], a[4:7], v[228:231], 0
    s_waitcnt vmcnt(60)
    v_mfma_f32_16x16x32_bf16 v[160:163], a[8:11], v[224:227], 0
    v_mfma_f32_16x16x32_bf16 v[164:167], a[8:11], v[228:231], 0
    v_mfma_f32_16x16x32_bf16 v[168:171], a[12:15], v[224:227], 0
    v_mfma_f32_16x16x32_bf16 v[172:175], a[12:15], v[228:231], 0
    v_cvt_pk_bf16_f32 v176, v144, v145
    v_cvt_pk_bf16_f32 v177, v146, v147
    v_cvt_pk_bf16_f32 v178, v152, v153
    v_cvt_pk_bf16_f32 v179, v154, v155
    v_cvt_pk_bf16_f32 v180, v148, v149
    v_cvt_pk_bf16_f32 v181, v150, v151
    v_cvt_pk_bf16_f32 v182, v156, v157
    v_cvt_pk_bf16_f32 v183, v158, v159
    s_nop 0
    v_accvgpr_write_b32 a0, v176
    v_accvgpr_write_b32 a1, v177
    v_accvgpr_write_b32 a2, v178
    v_accvgpr_write_b32 a3, v179
    v_accvgpr_write_b32 a4, v180
    v_accvgpr_write_b32 a5, v181
    v_accvgpr_write_b32 a6, v182
    v_accvgpr_write_b32 a7, v183
    s_waitcnt vmcnt(58)
    v_mfma_f32_16x16x32_bf16 v[144:147], a[16:19], v[224:227], 0
    v_mfma_f32_16x16x32_bf16 v[148:151], a[16:19], v[228:231], 0
    v_mfma_f32_16x16x32_bf16 v[152:155], a[20:23], v[224:227], 0
    v_mfma_f32_16x16x32_bf16 v[156:159], a[20:23], v[228:231], 0
    v_cvt_pk_bf16_f32 v176, v160, v161
    v_cvt_pk_bf16_f32 v177, v162, v163
    v_cvt_pk_bf16_f32 v178, v168, v169
    v_cvt_pk_bf16_f32 v179, v170, v171
    v_cvt_pk_bf16_f32 v180, v164, v165
    v_cvt_pk_bf16_f32 v181, v166, v167
    v_cvt_pk_bf16_f32 v182, v172, v173
    v_cvt_pk_bf16_f32 v183, v174, v175
    s_nop 0
    v_accvgpr_write_b32 a8, v176
    v_accvgpr_write_b32 a9, v177
    v_accvgpr_write_b32 a10, v178
    v_accvgpr_write_b32 a11, v179
    v_accvgpr_write_b32 a12, v180
    v_accvgpr_write_b32 a13, v181
    v_accvgpr_write_b32 a14, v182
    v_accvgpr_write_b32 a15, v183
    s_waitcnt vmcnt(56)
    v_mfma_f32_16x16x32_bf16 v[160:163], a[24:27], v[224:227], 0
    v_mfma_f32_16x16x32_bf16 v[164:167], a[24:27], v[228:231], 0
    v_mfma_f32_16x16x32_bf16 v[168:171], a[28:31], v[224:227], 0
    v_mfma_f32_16x16x32_bf16 v[172:175], a[28:31], v[228:231], 0
    v_cvt_pk_bf16_f32 v176, v144, v145
    v_cvt_pk_bf16_f32 v177, v146, v147
    v_cvt_pk_bf16_f32 v178, v152, v153
    v_cvt_pk_bf16_f32 v179, v154, v155
    v_cvt_pk_bf16_f32 v180, v148, v149
    v_cvt_pk_bf16_f32 v181, v150, v151
    v_cvt_pk_bf16_f32 v182, v156, v157
    v_cvt_pk_bf16_f32 v183, v158, v159
    s_nop 0
    v_accvgpr_write_b32 a16, v176
    v_accvgpr_write_b32 a17, v177
    v_accvgpr_write_b32 a18, v178
    v_accvgpr_write_b32 a19, v179
    v_accvgpr_write_b32 a20, v180
    v_accvgpr_write_b32 a21, v181
    v_accvgpr_write_b32 a22, v182
    v_accvgpr_write_b32 a23, v183
    s_waitcnt vmcnt(54)
    v_mfma_f32_16x16x32_bf16 v[144:147], a[32:35], v[224:227], 0
    v_mfma_f32_16x16x32_bf16 v[148:151], a[32:35], v[228:231], 0
    v_mfma_f32_16x16x32_bf16 v[152:155], a[36:39], v[224:227], 0
    v_mfma_f32_16x16x32_bf16 v[156:159], a[36:39], v[228:231], 0
    v_cvt_pk_bf16_f32 v176, v160, v161
    v_cvt_pk_bf16_f32 v177, v162, v163
    v_cvt_pk_bf16_f32 v178, v168, v169
    v_cvt_pk_bf16_f32 v179, v170, v171
    v_cvt_pk_bf16_f32 v180, v164, v165
    v_cvt_pk_bf16_f32 v181, v166, v167
    v_cvt_pk_bf16_f32 v182, v172, v173
    v_cvt_pk_bf16_f32 v183, v174, v175
    s_nop 0
    v_accvgpr_write_b32 a24, v176
    v_accvgpr_write_b32 a25, v177
    v_accvgpr_write_b32 a26, v178
    v_accvgpr_write_b32 a27, v179
    v_accvgpr_write_b32 a28, v180
    v_accvgpr_write_b32 a29, v181
    v_accvgpr_write_b32 a30, v182
    v_accvgpr_write_b32 a31, v183
    s_waitcnt vmcnt(52)
    v_mfma_f32_16x16x32_bf16 v[160:163], a[40:43], v[224:227], 0
    v_mfma_f32_16x16x32_bf16 v[164:167], a[40:43], v[228:231], 0
    v_mfma_f32_16x16x32_bf16 v[168:171], a[44:47], v[224:227], 0
    v_mfma_f32_16x16x32_bf16 v[172:175], a[44:47], v[228:231], 0
    v_cvt_pk_bf16_f32 v176, v144, v145
    v_cvt_pk_bf16_f32 v177, v146, v147
    v_cvt_pk_bf16_f32 v178, v152, v153
    v_cvt_pk_bf16_f32 v179, v154, v155
    v_cvt_pk_bf16_f32 v180, v148, v149
    v_cvt_pk_bf16_f32 v181, v150, v151
    v_cvt_pk_bf16_f32 v182, v156, v157
    v_cvt_pk_bf16_f32 v183, v158, v159
    s_nop 0
    v_accvgpr_write_b32 a32, v176
    v_accvgpr_write_b32 a33, v177
    v_accvgpr_write_b32 a34, v178
    v_accvgpr_write_b32 a35, v179
    v_accvgpr_write_b32 a36, v180
    v_accvgpr_write_b32 a37, v181
    v_accvgpr_write_b32 a38, v182
    v_accvgpr_write_b32 a39, v183
    s_waitcnt vmcnt(50)
    v_mfma_f32_16x16x32_bf16 v[144:147], a[48:51], v[224:227], 0
    v_mfma_f32_16x16x32_bf16 v[148:151], a[48:51], v[228:231], 0
    v_mfma_f32_16x16x32_bf16 v[152:155], a[52:55], v[224:227], 0
    v_mfma_f32_16x16x32_bf16 v[156:159], a[52:55], v[228:231], 0
    v_cvt_pk_bf16_f32 v176, v160, v161
    v_cvt_pk_bf16_f32 v177, v162, v163
    v_cvt_pk_bf16_f32 v178, v168, v169
    v_cvt_pk_bf16_f32 v179, v170, v171
    v_cvt_pk_bf16_f32 v180, v164, v165
    v_cvt_pk_bf16_f32 v181, v166, v167
    v_cvt_pk_bf16_f32 v182, v172, v173
    v_cvt_pk_bf16_f32 v183, v174, v175
    s_nop 0
    v_accvgpr_write_b32 a40, v176
    v_accvgpr_write_b32 a41, v177
    v_accvgpr_write_b32 a42, v178
    v_accvgpr_write_b32 a43, v179
    v_accvgpr_write_b32 a44, v180
    v_accvgpr_write_b32 a45, v181
    v_accvgpr_write_b32 a46, v182
    v_accvgpr_write_b32 a47, v183
    s_waitcnt vmcnt(48)
    v_mfma_f32_16x16x32_bf16 v[160:163], a[56:59], v[224:227], 0
    v_mfma_f32_16x16x32_bf16 v[164:167], a[56:59], v[228:231], 0
    v_mfma_f32_16x16x32_bf16 v[168:171], a[60:63], v[224:227], 0
    v_mfma_f32_16x16x32_bf16 v[172:175], a[60:63], v[228:231], 0
    v_cvt_pk_bf16_f32 v176, v144, v145
    v_cvt_pk_bf16_f32 v177, v146, v147
    v_cvt_pk_bf16_f32 v178, v152, v153
    v_cvt_pk_bf16_f32 v179, v154, v155
    v_cvt_pk_bf16_f32 v180, v148, v149
    v_cvt_pk_bf16_f32 v181, v150, v151
    v_cvt_pk_bf16_f32 v182, v156, v157
    v_cvt_pk_bf16_f32 v183, v158, v159
    s_nop 0
    v_accvgpr_write_b32 a48, v176
    v_accvgpr_write_b32 a49, v177
    v_accvgpr_write_b32 a50, v178
    v_accvgpr_write_b32 a51, v179
    v_accvgpr_write_b32 a52, v180
    v_accvgpr_write_b32 a53, v181
    v_accvgpr_write_b32 a54, v182
    v_accvgpr_write_b32 a55, v183
    s_waitcnt vmcnt(46)
    v_mfma_f32_16x16x32_bf16 v[144:147], a[64:67], v[224:227], 0
    v_mfma_f32_16x16x32_bf16 v[148:151], a[64:67], v[228:231], 0
    v_mfma_f32_16x16x32_bf16 v[152:155], a[68:71], v[224:227], 0
    v_mfma_f32_16x16x32_bf16 v[156:159], a[68:71], v[228:231], 0
    v_cvt_pk_bf16_f32 v176, v160, v161
    v_cvt_pk_bf16_f32 v177, v162, v163
    v_cvt_pk_bf16_f32 v178, v168, v169
    v_cvt_pk_bf16_f32 v179, v170, v171
    v_cvt_pk_bf16_f32 v180, v164, v165
    v_cvt_pk_bf16_f32 v181, v166, v167
    v_cvt_pk_bf16_f32 v182, v172, v173
    v_cvt_pk_bf16_f32 v183, v174, v175
    s_nop 0
    v_accvgpr_write_b32 a56, v176
    v_accvgpr_write_b32 a57, v177
    v_accvgpr_write_b32 a58, v178
    v_accvgpr_write_b32 a59, v179
    v_accvgpr_write_b32 a60, v180
    v_accvgpr_write_b32 a61, v181
    v_accvgpr_write_b32 a62, v182
    v_accvgpr_write_b32 a63, v183
    s_waitcnt vmcnt(44)
    v_mfma_f32_16x16x32_bf16 v[160:163], a[72:75], v[224:227], 0
    v_mfma_f32_16x16x32_bf16 v[164:167], a[72:75], v[228:231], 0
    v_mfma_f32_16x16x32_bf16 v[168:171], a[76:79], v[224:227], 0
    v_mfma_f32_16x16x32_bf16 v[172:175], a[76:79], v[228:231], 0
    v_cvt_pk_bf16_f32 v176, v144, v145
    v_cvt_pk_bf16_f32 v177, v146, v147
    v_cvt_pk_bf16_f32 v178, v152, v153
    v_cvt_pk_bf16_f32 v179, v154, v155
    v_cvt_pk_bf16_f32 v180, v148, v149
    v_cvt_pk_bf16_f32 v181, v150, v151
    v_cvt_pk_bf16_f32 v182, v156, v157
    v_cvt_pk_bf16_f32 v183, v158, v159
    s_nop 0
    v_accvgpr_write_b32 a64, v176
    v_accvgpr_write_b32 a65, v177
    v_accvgpr_write_b32 a66, v178
    v_accvgpr_write_b32 a67, v179
    v_accvgpr_write_b32 a68, v180
    v_accvgpr_write_b32 a69, v181
    v_accvgpr_write_b32 a70, v182
    v_accvgpr_write_b32 a71, v183
    s_waitcnt vmcnt(42)
    v_mfma_f32_16x16x32_bf16 v[144:147], a[80:83], v[224:227], 0
    v_mfma_f32_16x16x32_bf16 v[148:151], a[80:83], v[228:231], 0
    v_mfma_f32_16x16x32_bf16 v[152:155], a[84:87], v[224:227], 0
    v_mfma_f32_16x16x32_bf16 v[156:159], a[84:87], v[228:231], 0
    v_cvt_pk_bf16_f32 v176, v160, v161
    v_cvt_pk_bf16_f32 v177, v162, v163
    v_cvt_pk_bf16_f32 v178, v168, v169
    v_cvt_pk_bf16_f32 v179, v170, v171
    v_cvt_pk_bf16_f32 v180, v164, v165
    v_cvt_pk_bf16_f32 v181, v166, v167
    v_cvt_pk_bf16_f32 v182, v172, v173
    v_cvt_pk_bf16_f32 v183, v174, v175
    s_nop 0
    v_accvgpr_write_b32 a72, v176
    v_accvgpr_write_b32 a73, v177
    v_accvgpr_write_b32 a74, v178
    v_accvgpr_write_b32 a75, v179
    v_accvgpr_write_b32 a76, v180
    v_accvgpr_write_b32 a77, v181
    v_accvgpr_write_b32 a78, v182
    v_accvgpr_write_b32 a79, v183
    s_waitcnt vmcnt(40)
    v_mfma_f32_16x16x32_bf16 v[160:163], a[88:91], v[224:227], 0
    v_mfma_f32_16x16x32_bf16 v[164:167], a[88:91], v[228:231], 0
    v_mfma_f32_16x16x32_bf16 v[168:171], a[92:95], v[224:227], 0
    v_mfma_f32_16x16x32_bf16 v[172:175], a[92:95], v[228:231], 0
    v_cvt_pk_bf16_f32 v176, v144, v145
    v_cvt_pk_bf16_f32 v177, v146, v147
    v_cvt_pk_bf16_f32 v178, v152, v153
    v_cvt_pk_bf16_f32 v179, v154, v155
    v_cvt_pk_bf16_f32 v180, v148, v149
    v_cvt_pk_bf16_f32 v181, v150, v151
    v_cvt_pk_bf16_f32 v182, v156, v157
    v_cvt_pk_bf16_f32 v183, v158, v159
    s_nop 0
    v_accvgpr_write_b32 a80, v176
    v_accvgpr_write_b32 a81, v177
    v_accvgpr_write_b32 a82, v178
    v_accvgpr_write_b32 a83, v179
    v_accvgpr_write_b32 a84, v180
    v_accvgpr_write_b32 a85, v181
    v_accvgpr_write_b32 a86, v182
    v_accvgpr_write_b32 a87, v183
    s_waitcnt vmcnt(38)
    v_mfma_f32_16x16x32_bf16 v[144:147], a[96:99], v[224:227], 0
    v_mfma_f32_16x16x32_bf16 v[148:151], a[96:99], v[228:231], 0
    v_mfma_f32_16x16x32_bf16 v[152:155], a[100:103], v[224:227], 0
    v_mfma_f32_16x16x32_bf16 v[156:159], a[100:103], v[228:231], 0
    v_cvt_pk_bf16_f32 v176, v160, v161
    v_cvt_pk_bf16_f32 v177, v162, v163
    v_cvt_pk_bf16_f32 v178, v168, v169
    v_cvt_pk_bf16_f32 v179, v170, v171
    v_cvt_pk_bf16_f32 v180, v164, v165
    v_cvt_pk_bf16_f32 v181, v166, v167
    v_cvt_pk_bf16_f32 v182, v172, v173
    v_cvt_pk_bf16_f32 v183, v174, v175
    s_nop 0
    v_accvgpr_write_b32 a88, v176
    v_accvgpr_write_b32 a89, v177
    v_accvgpr_write_b32 a90, v178
    v_accvgpr_write_b32 a91, v179
    v_accvgpr_write_b32 a92, v180
    v_accvgpr_write_b32 a93, v181
    v_accvgpr_write_b32 a94, v182
    v_accvgpr_write_b32 a95, v183
    s_waitcnt vmcnt(36)
    v_mfma_f32_16x16x32_bf16 v[160:163], a[104:107], v[224:227], 0
    v_mfma_f32_16x16x32_bf16 v[164:167], a[104:107], v[228:231], 0
    v_mfma_f32_16x16x32_bf16 v[168:171], a[108:111], v[224:227], 0
    v_mfma_f32_16x16x32_bf16 v[172:175], a[108:111], v[228:231], 0
    v_cvt_pk_bf16_f32 v176, v144, v145
    v_cvt_pk_bf16_f32 v177, v146, v147
    v_cvt_pk_bf16_f32 v178, v152, v153
    v_cvt_pk_bf16_f32 v179, v154, v155
    v_cvt_pk_bf16_f32 v180, v148, v149
    v_cvt_pk_bf16_f32 v181, v150, v151
    v_cvt_pk_bf16_f32 v182, v156, v157
    v_cvt_pk_bf16_f32 v183, v158, v159
    s_nop 0
    v_accvgpr_write_b32 a96, v176
    v_accvgpr_write_b32 a97, v177
    v_accvgpr_write_b32 a98, v178
    v_accvgpr_write_b32 a99, v179
    v_accvgpr_write_b32 a100, v180
    v_accvgpr_write_b32 a101, v181
    v_accvgpr_write_b32 a102, v182
    v_accvgpr_write_b32 a103, v183
    s_waitcnt vmcnt(34)
    v_mfma_f32_16x16x32_bf16 v[144:147], a[112:115], v[224:227], 0
    v_mfma_f32_16x16x32_bf16 v[148:151], a[112:115], v[228:231], 0
    v_mfma_f32_16x16x32_bf16 v[152:155], a[116:119], v[224:227], 0
    v_mfma_f32_16x16x32_bf16 v[156:159], a[116:119], v[228:231], 0
    v_cvt_pk_bf16_f32 v176, v160, v161
    v_cvt_pk_bf16_f32 v177, v162, v163
    v_cvt_pk_bf16_f32 v178, v168, v169
    v_cvt_pk_bf16_f32 v179, v170, v171
    v_cvt_pk_bf16_f32 v180, v164, v165
    v_cvt_pk_bf16_f32 v181, v166, v167
    v_cvt_pk_bf16_f32 v182, v172, v173
    v_cvt_pk_bf16_f32 v183, v174, v175
    s_nop 0
    v_accvgpr_write_b32 a104, v176
    v_accvgpr_write_b32 a105, v177
    v_accvgpr_write_b32 a106, v178
    v_accvgpr_write_b32 a107, v179
    v_accvgpr_write_b32 a108, v180
    v_accvgpr_write_b32 a109, v181
    v_accvgpr_write_b32 a110, v182
    v_accvgpr_write_b32 a111, v183
    s_waitcnt vmcnt(32)
    v_mfma_f32_16x16x32_bf16 v[160:163], a[120:123], v[224:227], 0
    v_mfma_f32_16x16x32_bf16 v[164:167], a[120:123], v[228:231], 0
    v_mfma_f32_16x16x32_bf16 v[168:171], a[124:127], v[224:227], 0
    v_mfma_f32_16x16x32_bf16 v[172:175], a[124:127], v[228:231], 0
    v_cvt_pk_bf16_f32 v176, v144, v145
    v_cvt_pk_bf16_f32 v177, v146, v147
    v_cvt_pk_bf16_f32 v178, v152, v153
    v_cvt_pk_bf16_f32 v179, v154, v155
    v_cvt_pk_bf16_f32 v180, v148, v149
    v_cvt_pk_bf16_f32 v181, v150, v151
    v_cvt_pk_bf16_f32 v182, v156, v157
    v_cvt_pk_bf16_f32 v183, v158, v159
    s_nop 0
    v_accvgpr_write_b32 a112, v176
    v_accvgpr_write_b32 a113, v177
    v_accvgpr_write_b32 a114, v178
    v_accvgpr_write_b32 a115, v179
    v_accvgpr_write_b32 a116, v180
    v_accvgpr_write_b32 a117, v181
    v_accvgpr_write_b32 a118, v182
    v_accvgpr_write_b32 a119, v183
    s_waitcnt vmcnt(30)
    v_mfma_f32_16x16x32_bf16 v[144:147], a[128:131], v[224:227], 0
    v_mfma_f32_16x16x32_bf16 v[148:151], a[128:131], v[228:231], 0
    v_mfma_f32_16x16x32_bf16 v[152:155], a[132:135], v[224:227], 0
    v_mfma_f32_16x16x32_bf16 v[156:159], a[132:135], v[228:231], 0
    v_cvt_pk_bf16_f32 v176, v160, v161
    v_cvt_pk_bf16_f32 v177, v162, v163
    v_cvt_pk_bf16_f32 v178, v168, v169
    v_cvt_pk_bf16_f32 v179, v170, v171
    v_cvt_pk_bf16_f32 v180, v164, v165
    v_cvt_pk_bf16_f32 v181, v166, v167
    v_cvt_pk_bf16_f32 v182, v172, v173
    v_cvt_pk_bf16_f32 v183, v174, v175
    s_nop 0
    v_accvgpr_write_b32 a120, v176
    v_accvgpr_write_b32 a121, v177
    v_accvgpr_write_b32 a122, v178
    v_accvgpr_write_b32 a123, v179
    v_accvgpr_write_b32 a124, v180
    v_accvgpr_write_b32 a125, v181
    v_accvgpr_write_b32 a126, v182
    v_accvgpr_write_b32 a127, v183
    s_waitcnt vmcnt(28)
    v_mfma_f32_16x16x32_bf16 v[160:163], a[136:139], v[224:227], 0
    v_mfma_f32_16x16x32_bf16 v[164:167], a[136:139], v[228:231], 0
    v_mfma_f32_16x16x32_bf16 v[168:171], a[140:143], v[224:227], 0
    v_mfma_f32_16x16x32_bf16 v[172:175], a[140:143], v[228:231], 0
    v_cvt_pk_bf16_f32 v176, v144, v145
    v_cvt_pk_bf16_f32 v177, v146, v147
    v_cvt_pk_bf16_f32 v178, v152, v153
    v_cvt_pk_bf16_f32 v179, v154, v155
    v_cvt_pk_bf16_f32 v180, v148, v149
    v_cvt_pk_bf16_f32 v181, v150, v151
    v_cvt_pk_bf16_f32 v182, v156, v157
    v_cvt_pk_bf16_f32 v183, v158, v159
    s_nop 0
    v_accvgpr_write_b32 a128, v176
    v_accvgpr_write_b32 a129, v177
    v_accvgpr_write_b32 a130, v178
    v_accvgpr_write_b32 a131, v179
    v_accvgpr_write_b32 a132, v180
    v_accvgpr_write_b32 a133, v181
    v_accvgpr_write_b32 a134, v182
    v_accvgpr_write_b32 a135, v183
    s_waitcnt vmcnt(26)
    v_mfma_f32_16x16x32_bf16 v[144:147], a[144:147], v[224:227], 0
    v_mfma_f32_16x16x32_bf16 v[148:151], a[144:147], v[228:231], 0
    v_mfma_f32_16x16x32_bf16 v[152:155], a[148:151], v[224:227], 0
    v_mfma_f32_16x16x32_bf16 v[156:159], a[148:151], v[228:231], 0
    v_cvt_pk_bf16_f32 v176, v160, v161
    v_cvt_pk_bf16_f32 v177, v162, v163
    v_cvt_pk_bf16_f32 v178, v168, v169
    v_cvt_pk_bf16_f32 v179, v170, v171
    v_cvt_pk_bf16_f32 v180, v164, v165
    v_cvt_pk_bf16_f32 v181, v166, v167
    v_cvt_pk_bf16_f32 v182, v172, v173
    v_cvt_pk_bf16_f32 v183, v174, v175
    s_nop 0
    v_accvgpr_write_b32 a136, v176
    v_accvgpr_write_b32 a137, v177
    v_accvgpr_write_b32 a138, v178
    v_accvgpr_write_b32 a139, v179
    v_accvgpr_write_b32 a140, v180
    v_accvgpr_write_b32 a141, v181
    v_accvgpr_write_b32 a142, v182
    v_accvgpr_write_b32 a143, v183
    s_waitcnt vmcnt(24)
    v_mfma_f32_16x16x32_bf16 v[160:163], a[152:155], v[224:227], 0
    v_mfma_f32_16x16x32_bf16 v[164:167], a[152:155], v[228:231], 0
    v_mfma_f32_16x16x32_bf16 v[168:171], a[156:159], v[224:227], 0
    v_mfma_f32_16x16x32_bf16 v[172:175], a[156:159], v[228:231], 0
    v_cvt_pk_bf16_f32 v176, v144, v145
    v_cvt_pk_bf16_f32 v177, v146, v147
    v_cvt_pk_bf16_f32 v178, v152, v153
    v_cvt_pk_bf16_f32 v179, v154, v155
    v_cvt_pk_bf16_f32 v180, v148, v149
    v_cvt_pk_bf16_f32 v181, v150, v151
    v_cvt_pk_bf16_f32 v182, v156, v157
    v_cvt_pk_bf16_f32 v183, v158, v159
    s_nop 0
    v_accvgpr_write_b32 a144, v176
    v_accvgpr_write_b32 a145, v177
    v_accvgpr_write_b32 a146, v178
    v_accvgpr_write_b32 a147, v179
    v_accvgpr_write_b32 a148, v180
    v_accvgpr_write_b32 a149, v181
    v_accvgpr_write_b32 a150, v182
    v_accvgpr_write_b32 a151, v183
    s_waitcnt vmcnt(22)
    v_mfma_f32_16x16x32_bf16 v[144:147], a[160:163], v[224:227], 0
    v_mfma_f32_16x16x32_bf16 v[148:151], a[160:163], v[228:231], 0
    v_mfma_f32_16x16x32_bf16 v[152:155], a[164:167], v[224:227], 0
    v_mfma_f32_16x16x32_bf16 v[156:159], a[164:167], v[228:231], 0
    v_cvt_pk_bf16_f32 v176, v160, v161
    v_cvt_pk_bf16_f32 v177, v162, v163
    v_cvt_pk_bf16_f32 v178, v168, v169
    v_cvt_pk_bf16_f32 v179, v170, v171
    v_cvt_pk_bf16_f32 v180, v164, v165
    v_cvt_pk_bf16_f32 v181, v166, v167
    v_cvt_pk_bf16_f32 v182, v172, v173
    v_cvt_pk_bf16_f32 v183, v174, v175
    s_nop 0
    v_accvgpr_write_b32 a152, v176
    v_accvgpr_write_b32 a153, v177
    v_accvgpr_write_b32 a154, v178
    v_accvgpr_write_b32 a155, v179
    v_accvgpr_write_b32 a156, v180
    v_accvgpr_write_b32 a157, v181
    v_accvgpr_write_b32 a158, v182
    v_accvgpr_write_b32 a159, v183
    s_waitcnt vmcnt(20)
    v_mfma_f32_16x16x32_bf16 v[160:163], a[168:171], v[224:227], 0
    v_mfma_f32_16x16x32_bf16 v[164:167], a[168:171], v[228:231], 0
    v_mfma_f32_16x16x32_bf16 v[168:171], a[172:175], v[224:227], 0
    v_mfma_f32_16x16x32_bf16 v[172:175], a[172:175], v[228:231], 0
    v_cvt_pk_bf16_f32 v176, v144, v145
    v_cvt_pk_bf16_f32 v177, v146, v147
    v_cvt_pk_bf16_f32 v178, v152, v153
    v_cvt_pk_bf16_f32 v179, v154, v155
    v_cvt_pk_bf16_f32 v180, v148, v149
    v_cvt_pk_bf16_f32 v181, v150, v151
    v_cvt_pk_bf16_f32 v182, v156, v157
    v_cvt_pk_bf16_f32 v183, v158, v159
    s_nop 0
    v_accvgpr_write_b32 a160, v176
    v_accvgpr_write_b32 a161, v177
    v_accvgpr_write_b32 a162, v178
    v_accvgpr_write_b32 a163, v179
    v_accvgpr_write_b32 a164, v180
    v_accvgpr_write_b32 a165, v181
    v_accvgpr_write_b32 a166, v182
    v_accvgpr_write_b32 a167, v183
    s_waitcnt vmcnt(18)
    v_mfma_f32_16x16x32_bf16 v[144:147], a[176:179], v[224:227], 0
    v_mfma_f32_16x16x32_bf16 v[148:151], a[176:179], v[228:231], 0
    v_mfma_f32_16x16x32_bf16 v[152:155], a[180:183], v[224:227], 0
    v_mfma_f32_16x16x32_bf16 v[156:159], a[180:183], v[228:231], 0
    v_cvt_pk_bf16_f32 v176, v160, v161
    v_cvt_pk_bf16_f32 v177, v162, v163
    v_cvt_pk_bf16_f32 v178, v168, v169
    v_cvt_pk_bf16_f32 v179, v170, v171
    v_cvt_pk_bf16_f32 v180, v164, v165
    v_cvt_pk_bf16_f32 v181, v166, v167
    v_cvt_pk_bf16_f32 v182, v172, v173
    v_cvt_pk_bf16_f32 v183, v174, v175
    s_nop 0
    v_accvgpr_write_b32 a168, v176
    v_accvgpr_write_b32 a169, v177
    v_accvgpr_write_b32 a170, v178
    v_accvgpr_write_b32 a171, v179
    v_accvgpr_write_b32 a172, v180
    v_accvgpr_write_b32 a173, v181
    v_accvgpr_write_b32 a174, v182
    v_accvgpr_write_b32 a175, v183
    s_waitcnt vmcnt(16)
    v_mfma_f32_16x16x32_bf16 v[160:163], a[184:187], v[224:227], 0
    v_mfma_f32_16x16x32_bf16 v[164:167], a[184:187], v[228:231], 0
    v_mfma_f32_16x16x32_bf16 v[168:171], a[188:191], v[224:227], 0
    v_mfma_f32_16x16x32_bf16 v[172:175], a[188:191], v[228:231], 0
    v_cvt_pk_bf16_f32 v176, v144, v145
    v_cvt_pk_bf16_f32 v177, v146, v147
    v_cvt_pk_bf16_f32 v178, v152, v153
    v_cvt_pk_bf16_f32 v179, v154, v155
    v_cvt_pk_bf16_f32 v180, v148, v149
    v_cvt_pk_bf16_f32 v181, v150, v151
    v_cvt_pk_bf16_f32 v182, v156, v157
    v_cvt_pk_bf16_f32 v183, v158, v159
    s_nop 0
    v_accvgpr_write_b32 a176, v176
    v_accvgpr_write_b32 a177, v177
    v_accvgpr_write_b32 a178, v178
    v_accvgpr_write_b32 a179, v179
    v_accvgpr_write_b32 a180, v180
    v_accvgpr_write_b32 a181, v181
    v_accvgpr_write_b32 a182, v182
    v_accvgpr_write_b32 a183, v183
    s_waitcnt vmcnt(14)
    v_mfma_f32_16x16x32_bf16 v[144:147], a[192:195], v[224:227], 0
    v_mfma_f32_16x16x32_bf16 v[148:151], a[192:195], v[228:231], 0
    v_mfma_f32_16x16x32_bf16 v[152:155], a[196:199], v[224:227], 0
    v_mfma_f32_16x16x32_bf16 v[156:159], a[196:199], v[228:231], 0
    v_cvt_pk_bf16_f32 v176, v160, v161
    v_cvt_pk_bf16_f32 v177, v162, v163
    v_cvt_pk_bf16_f32 v178, v168, v169
    v_cvt_pk_bf16_f32 v179, v170, v171
    v_cvt_pk_bf16_f32 v180, v164, v165
    v_cvt_pk_bf16_f32 v181, v166, v167
    v_cvt_pk_bf16_f32 v182, v172, v173
    v_cvt_pk_bf16_f32 v183, v174, v175
    s_nop 0
    v_accvgpr_write_b32 a184, v176
    v_accvgpr_write_b32 a185, v177
    v_accvgpr_write_b32 a186, v178
    v_accvgpr_write_b32 a187, v179
    v_accvgpr_write_b32 a188, v180
    v_accvgpr_write_b32 a189, v181
    v_accvgpr_write_b32 a190, v182
    v_accvgpr_write_b32 a191, v183
    s_waitcnt vmcnt(12)
    v_mfma_f32_16x16x32_bf16 v[160:163], a[200:203], v[224:227], 0
    v_mfma_f32_16x16x32_bf16 v[164:167], a[200:203], v[228:231], 0
    v_mfma_f32_16x16x32_bf16 v[168:171], a[204:207], v[224:227], 0
    v_mfma_f32_16x16x32_bf16 v[172:175], a[204:207], v[228:231], 0
    v_cvt_pk_bf16_f32 v176, v144, v145
    v_cvt_pk_bf16_f32 v177, v146, v147
    v_cvt_pk_bf16_f32 v178, v152, v153
    v_cvt_pk_bf16_f32 v179, v154, v155
    v_cvt_pk_bf16_f32 v180, v148, v149
    v_cvt_pk_bf16_f32 v181, v150, v151
    v_cvt_pk_bf16_f32 v182, v156, v157
    v_cvt_pk_bf16_f32 v183, v158, v159
    s_nop 0
    v_accvgpr_write_b32 a192, v176
    v_accvgpr_write_b32 a193, v177
    v_accvgpr_write_b32 a194, v178
    v_accvgpr_write_b32 a195, v179
    v_accvgpr_write_b32 a196, v180
    v_accvgpr_write_b32 a197, v181
    v_accvgpr_write_b32 a198, v182
    v_accvgpr_write_b32 a199, v183
    s_waitcnt vmcnt(10)
    v_mfma_f32_16x16x32_bf16 v[144:147], a[208:211], v[224:227], 0
    v_mfma_f32_16x16x32_bf16 v[148:151], a[208:211], v[228:231], 0
    v_mfma_f32_16x16x32_bf16 v[152:155], a[212:215], v[224:227], 0
    v_mfma_f32_16x16x32_bf16 v[156:159], a[212:215], v[228:231], 0
    v_cvt_pk_bf16_f32 v176, v160, v161
    v_cvt_pk_bf16_f32 v177, v162, v163
    v_cvt_pk_bf16_f32 v178, v168, v169
    v_cvt_pk_bf16_f32 v179, v170, v171
    v_cvt_pk_bf16_f32 v180, v164, v165
    v_cvt_pk_bf16_f32 v181, v166, v167
    v_cvt_pk_bf16_f32 v182, v172, v173
    v_cvt_pk_bf16_f32 v183, v174, v175
    s_nop 0
    v_accvgpr_write_b32 a200, v176
    v_accvgpr_write_b32 a201, v177
    v_accvgpr_write_b32 a202, v178
    v_accvgpr_write_b32 a203, v179
    v_accvgpr_write_b32 a204, v180
    v_accvgpr_write_b32 a205, v181
    v_accvgpr_write_b32 a206, v182
    v_accvgpr_write_b32 a207, v183
    s_waitcnt vmcnt(8)
    v_mfma_f32_16x16x32_bf16 v[160:163], a[216:219], v[224:227], 0
    v_mfma_f32_16x16x32_bf16 v[164:167], a[216:219], v[228:231], 0
    v_mfma_f32_16x16x32_bf16 v[168:171], a[220:223], v[224:227], 0
    v_mfma_f32_16x16x32_bf16 v[172:175], a[220:223], v[228:231], 0
    v_cvt_pk_bf16_f32 v176, v144, v145
    v_cvt_pk_bf16_f32 v177, v146, v147
    v_cvt_pk_bf16_f32 v178, v152, v153
    v_cvt_pk_bf16_f32 v179, v154, v155
    v_cvt_pk_bf16_f32 v180, v148, v149
    v_cvt_pk_bf16_f32 v181, v150, v151
    v_cvt_pk_bf16_f32 v182, v156, v157
    v_cvt_pk_bf16_f32 v183, v158, v159
    s_nop 0
    v_accvgpr_write_b32 a208, v176
    v_accvgpr_write_b32 a209, v177
    v_accvgpr_write_b32 a210, v178
    v_accvgpr_write_b32 a211, v179
    v_accvgpr_write_b32 a212, v180
    v_accvgpr_write_b32 a213, v181
    v_accvgpr_write_b32 a214, v182
    v_accvgpr_write_b32 a215, v183
    s_waitcnt vmcnt(6)
    v_mfma_f32_16x16x32_bf16 v[144:147], a[224:227], v[224:227], 0
    v_mfma_f32_16x16x32_bf16 v[148:151], a[224:227], v[228:231], 0
    v_mfma_f32_16x16x32_bf16 v[152:155], a[228:231], v[224:227], 0
    v_mfma_f32_16x16x32_bf16 v[156:159], a[228:231], v[228:231], 0
    v_cvt_pk_bf16_f32 v176, v160, v161
    v_cvt_pk_bf16_f32 v177, v162, v163
    v_cvt_pk_bf16_f32 v178, v168, v169
    v_cvt_pk_bf16_f32 v179, v170, v171
    v_cvt_pk_bf16_f32 v180, v164, v165
    v_cvt_pk_bf16_f32 v181, v166, v167
    v_cvt_pk_bf16_f32 v182, v172, v173
    v_cvt_pk_bf16_f32 v183, v174, v175
    s_nop 0
    v_accvgpr_write_b32 a216, v176
    v_accvgpr_write_b32 a217, v177
    v_accvgpr_write_b32 a218, v178
    v_accvgpr_write_b32 a219, v179
    v_accvgpr_write_b32 a220, v180
    v_accvgpr_write_b32 a221, v181
    v_accvgpr_write_b32 a222, v182
    v_accvgpr_write_b32 a223, v183
    s_waitcnt vmcnt(4)
    v_mfma_f32_16x16x32_bf16 v[160:163], a[232:235], v[224:227], 0
    v_mfma_f32_16x16x32_bf16 v[164:167], a[232:235], v[228:231], 0
    v_mfma_f32_16x16x32_bf16 v[168:171], a[236:239], v[224:227], 0
    v_mfma_f32_16x16x32_bf16 v[172:175], a[236:239], v[228:231], 0
    v_cvt_pk_bf16_f32 v176, v144, v145
    v_cvt_pk_bf16_f32 v177, v146, v147
    v_cvt_pk_bf16_f32 v178, v152, v153
    v_cvt_pk_bf16_f32 v179, v154, v155
    v_cvt_pk_bf16_f32 v180, v148, v149
    v_cvt_pk_bf16_f32 v181, v150, v151
    v_cvt_pk_bf16_f32 v182, v156, v157
    v_cvt_pk_bf16_f32 v183, v158, v159
    s_nop 0
    v_accvgpr_write_b32 a224, v176
    v_accvgpr_write_b32 a225, v177
    v_accvgpr_write_b32 a226, v178
    v_accvgpr_write_b32 a227, v179
    v_accvgpr_write_b32 a228, v180
    v_accvgpr_write_b32 a229, v181
    v_accvgpr_write_b32 a230, v182
    v_accvgpr_write_b32 a231, v183
    s_waitcnt vmcnt(2)
    v_mfma_f32_16x16x32_bf16 v[144:147], a[240:243], v[224:227], 0
    v_mfma_f32_16x16x32_bf16 v[148:151], a[240:243], v[228:231], 0
    v_mfma_f32_16x16x32_bf16 v[152:155], a[244:247], v[224:227], 0
    v_mfma_f32_16x16x32_bf16 v[156:159], a[244:247], v[228:231], 0
    v_cvt_pk_bf16_f32 v176, v160, v161
    v_cvt_pk_bf16_f32 v177, v162, v163
    v_cvt_pk_bf16_f32 v178, v168, v169
    v_cvt_pk_bf16_f32 v179, v170, v171
    v_cvt_pk_bf16_f32 v180, v164, v165
    v_cvt_pk_bf16_f32 v181, v166, v167
    v_cvt_pk_bf16_f32 v182, v172, v173
    v_cvt_pk_bf16_f32 v183, v174, v175
    s_nop 0
    v_accvgpr_write_b32 a232, v176
    v_accvgpr_write_b32 a233, v177
    v_accvgpr_write_b32 a234, v178
    v_accvgpr_write_b32 a235, v179
    v_accvgpr_write_b32 a236, v180
    v_accvgpr_write_b32 a237, v181
    v_accvgpr_write_b32 a238, v182
    v_accvgpr_write_b32 a239, v183
    s_waitcnt vmcnt(0)
    v_mfma_f32_16x16x32_bf16 v[160:163], a[248:251], v[224:227], 0
    v_mfma_f32_16x16x32_bf16 v[164:167], a[248:251], v[228:231], 0
    v_mfma_f32_16x16x32_bf16 v[168:171], a[252:255], v[224:227], 0
    v_mfma_f32_16x16x32_bf16 v[172:175], a[252:255], v[228:231], 0
    v_cvt_pk_bf16_f32 v176, v144, v145
    v_cvt_pk_bf16_f32 v177, v146, v147
    v_cvt_pk_bf16_f32 v178, v152, v153
    v_cvt_pk_bf16_f32 v179, v154, v155
    v_cvt_pk_bf16_f32 v180, v148, v149
    v_cvt_pk_bf16_f32 v181, v150, v151
    v_cvt_pk_bf16_f32 v182, v156, v157
    v_cvt_pk_bf16_f32 v183, v158, v159
    s_nop 0
    v_accvgpr_write_b32 a240, v176
    v_accvgpr_write_b32 a241, v177
    v_accvgpr_write_b32 a242, v178
    v_accvgpr_write_b32 a243, v179
    v_accvgpr_write_b32 a244, v180
    v_accvgpr_write_b32 a245, v181
    v_accvgpr_write_b32 a246, v182
    v_accvgpr_write_b32 a247, v183
    s_nop 7
    v_cvt_pk_bf16_f32 v176, v160, v161
    v_cvt_pk_bf16_f32 v177, v162, v163
    v_cvt_pk_bf16_f32 v178, v168, v169
    v_cvt_pk_bf16_f32 v179, v170, v171
    v_cvt_pk_bf16_f32 v180, v164, v165
    v_cvt_pk_bf16_f32 v181, v166, v167
    v_cvt_pk_bf16_f32 v182, v172, v173
    v_cvt_pk_bf16_f32 v183, v174, v175
    s_nop 0
    v_accvgpr_write_b32 a248, v176
    v_accvgpr_write_b32 a249, v177
    v_accvgpr_write_b32 a250, v178
    v_accvgpr_write_b32 a251, v179
    v_accvgpr_write_b32 a252, v180
    v_accvgpr_write_b32 a253, v181
    v_accvgpr_write_b32 a254, v182
    v_accvgpr_write_b32 a255, v183
WK_SEG:
    s_cmp_ge_u32 s42, 64
    s_cbranch_scc1 WK_SEGX
    s_lshl_b32 s14, s43, 1
    s_lshr_b32 s15, s3, 1
    s_add_u32 s14, s14, s15
    s_mov_b32 s13, s42
    s_lshl_b32 s12, s13, 5
    s_add_u32 s12, s12, s14
    s_lshl_b32 s15, s14, 9
    s_lshr_b32 s16, s13, 1
    s_lshl_b32 s16, s16, 4
    s_add_u32 s15, s15, s16
    s_add_u32 s15, s15, 4456448
    s_lshl_b32 s16, s12, 8
    s_add_u32 s16, s16, 7340032
    v_mov_b32 v206, s15
    v_and_b32 v207, 3, v2
    v_lshlrev_b32 v207, 6, v207
    v_add_u32 v207, s16, v207
WK_APOLL:
    global_load_dwordx4 v[208:211], v206, s[4:5] sc1
    s_waitcnt vmcnt(0)
    v_xor_b32 v208, s56, v208
    v_xor_b32 v209, s56, v209
    v_xor_b32 v210, s56, v210
    v_or3_b32 v208, v208, v209, v210
    v_cmp_ne_u32 vcc, 0, v208
    s_cbranch_vccz WK_AGO
    s_sleep 8
    s_branch WK_APOLL
WK_AGO:
    s_and_b32 s15, s3, 1
    s_cmp_eq_u32 s15, 1
    s_cbranch_scc1 WK_AT1
    s_lshl_b32 s16, s14, 6
    s_add_u32 s28, s16, s13
    s_lshl_b32 s16, s28, 13
    s_add_u32 s17, s16, 33554432
    s_add_u32 s18, s4, s17
    s_addc_u32 s19, s5, 0
    s_add_u32 s17, s16, 50331648
    s_add_u32 s20, s4, s17
    s_addc_u32 s21, s5, 0
    s_add_u32 s17, s16, 67108864
    s_add_u32 s22, s4, s17
    s_addc_u32 s23, s5, 0
    s_lshl_b32 s16, s28, 12
    s_add_u32 s17, s16, 83886080
    s_add_u32 s24, s4, s17
    s_addc_u32 s25, s5, 0
    s_add_u32 s17, s16, 92274688
    s_add_u32 s26, s4, s17
    s_addc_u32 s27, s5, 0
    v_add_u32 v4, 4096, v3
    v_lshrrev_b32 v5, 1, v3
    global_load_dwordx4 v[8:11], v3, s[18:19] offset:0 sc1
    global_load_dwordx4 v[16:19], v3, s[18:19] offset:2048 sc1
    global_load_dwordx4 v[24:27], v4, s[18:19] offset:0 sc1
    global_load_dwordx4 v[32:35], v4, s[18:19] offset:2048 sc1
    global_load_dwordx4 v[40:43], v3, s[20:21] offset:0 sc1
    global_load_dwordx4 v[48:51], v3, s[20:21] offset:2048 sc1
    global_load_dwordx4 v[56:59], v4, s[20:21] offset:0 sc1
    global_load_dwordx4 v[64:67], v4, s[20:21] offset:2048 sc1
    global_load_dwordx4 v[88:91], v3, s[22:23] offset:0 sc1
    global_load_dwordx4 v[92:95], v3, s[22:23] offset:1024 sc1
    global_load_dwordx4 v[96:99], v3, s[22:23] offset:2048 sc1
    global_load_dwordx4 v[100:103], v3, s[22:23] offset:3072 sc1
    global_load_dwordx4 v[104:107], v4, s[22:23] offset:0 sc1
    global_load_dwordx4 v[108:111], v4, s[22:23] offset:1024 sc1
    global_load_dwordx4 v[112:115], v4, s[22:23] offset:2048 sc1
    global_load_dwordx4 v[116:119], v4, s[22:23] offset:3072 sc1
    v_mov_b64 v[120:121], 0
    v_mov_b64 v[122:123], 0
    v_mov_b64 v[124:125], 0
    v_mov_b64 v[126:127], 0
    v_mov_b64 v[128:129], 0
    v_mov_b64 v[130:131], 0
    v_mov_b64 v[132:133], 0
    v_mov_b64 v[134:135], 0
    v_mov_b64 v[136:137], 0
    v_mov_b64 v[138:139], 0
    v_mov_b64 v[140:141], 0
    v_mov_b64 v[142:143], 0
    v_mov_b64 v[144:145], 0
    v_mov_b64 v[146:147], 0
    v_mov_b64 v[148:149], 0
    v_mov_b64 v[150:151], 0
    s_cmp_eq_u32 s13, 63
    s_cbranch_scc1 WKA0_DP
WK_MP0:
    global_load_dword v212, v207, s[4:5] sc1
    s_waitcnt vmcnt(0)
    v_cmp_ne_u32 vcc, s56, v212
    s_cbranch_vccz WK_MG0
    s_sleep 8
    s_branch WK_MP0
WK_MG0:
    global_load_dwordx4 v[72:75], v3, s[24:25] offset:0 sc1
    global_load_dwordx4 v[76:79], v3, s[24:25] offset:1024 sc1
    global_load_dwordx4 v[80:83], v3, s[24:25] offset:2048 sc1
    global_load_dwordx4 v[84:87], v3, s[24:25] offset:3072 sc1
    s_mov_b32 exec_hi, 0
    global_load_dwordx2 v[120:121], v5, s[26:27] offset:0 sc1
    global_load_dwordx2 v[124:125], v5, s[26:27] offset:512 sc1
    global_load_dwordx2 v[128:129], v5, s[26:27] offset:1024 sc1
    global_load_dwordx2 v[132:133], v5, s[26:27] offset:1536 sc1
    global_load_dwordx2 v[136:137], v5, s[26:27] offset:2048 sc1
    global_load_dwordx2 v[140:141], v5, s[26:27] offset:2560 sc1
    global_load_dwordx2 v[144:145], v5, s[26:27] offset:3072 sc1
    global_load_dwordx2 v[148:149], v5, s[26:27] offset:3584 sc1
    s_mov_b32 exec_hi, -1
    s_branch WKA0_DPE
WKA0_DPS:
    s_sleep 2
WKA0_DP:
    global_load_dwordx4 v[72:75], v3, s[24:25] offset:0 sc1
    global_load_dwordx4 v[76:79], v3, s[24:25] offset:1024 sc1
    global_load_dwordx4 v[80:83], v3, s[24:25] offset:2048 sc1
    global_load_dwordx4 v[84:87], v3, s[24:25] offset:3072 sc1
    s_mov_b32 exec_hi, 0
    global_load_dwordx2 v[120:121], v5, s[26:27] offset:0 sc1
    global_load_dwordx2 v[124:125], v5, s[26:27] offset:512 sc1
    global_load_dwordx2 v[128:129], v5, s[26:27] offset:1024 sc1
    global_load_dwordx2 v[132:133], v5, s[26:27] offset:1536 sc1
    global_load_dwordx2 v[136:137], v5, s[26:27] offset:2048 sc1
    global_load_dwordx2 v[140:141], v5, s[26:27] offset:2560 sc1
    global_load_dwordx2 v[144:145], v5, s[26:27] offset:3072 sc1
    global_load_dwordx2 v[148:149], v5, s[26:27] offset:3584 sc1
    s_mov_b32 exec_hi, -1
    s_waitcnt vmcnt(0)
    v_max3_u32 v200, v72, v73, v74
    v_max3_u32 v200, v200, v75, v76
    v_max3_u32 v200, v200, v77, v78
    v_max3_u32 v200, v200, v79, v80
    v_max3_u32 v200, v200, v81, v82
    v_max3_u32 v200, v200, v83, v84
    v_max3_u32 v200, v200, v85, v86
    v_max_u32 v200, v200, v87
    v_max3_u32 v201, v120, v121, v124
    v_max3_u32 v201, v201, v125, v128
    v_max3_u32 v201, v201, v129, v132
    v_max3_u32 v201, v201, v133, v136
    v_max3_u32 v201, v201, v137, v140
    v_max3_u32 v201, v201, v141, v144
    v_max3_u32 v201, v201, v145, v148
    v_max_u32 v201, v201, v149
    v_cmp_eq_u32 vcc, -1, v200
    s_or_b32 s16, vcc_lo, vcc_hi
    s_and_b32 s16, s16, 0x00ff00ff
    v_cmp_eq_u32 vcc, -1, v201
    s_or_b32 s16, s16, vcc_lo
    s_or_b32 s16, s16, vcc_hi
    s_cbranch_scc1 WKA0_DPS
WKA0_DPE:
    v_lshrrev_b32 v6, 4, v2
    v_lshlrev_b32 v6, 2, v6
    v_and_b32 v7, 15, v2
    v_add_u32 v1, 0, v6
    v_cmp_le_u32 s[28:29], v1, v7
    v_add_u32 v1, 1, v6
    v_cmp_le_u32 s[30:31], v1, v7
    v_add_u32 v1, 2, v6
    v_cmp_le_u32 s[32:33], v1, v7
    v_add_u32 v1, 3, v6
    v_cmp_le_u32 s[34:35], v1, v7
    s_mov_b32 s36, -1
    s_mov_b32 s37, 0
    s_waitcnt vmcnt(8)
    v_mfma_f32_16x16x32_bf16 v[152:155], v[72:75], v[8:11], 0
    v_mfma_f32_16x16x32_bf16 v[152:155], v[76:79], v[16:19], v[152:155]
    v_mfma_f32_16x16x32_bf16 v[152:155], v[80:83], v[24:27], v[152:155]
    v_mfma_f32_16x16x32_bf16 v[152:155], v[84:87], v[32:35], v[152:155]
    v_mfma_f32_16x16x32_bf16 v[156:159], v[40:43], v[8:11], 0
    v_mfma_f32_16x16x32_bf16 v[156:159], v[48:51], v[16:19], v[156:159]
    v_mfma_f32_16x16x32_bf16 v[156:159], v[56:59], v[24:27], v[156:159]
    v_mfma_f32_16x16x32_bf16 v[156:159], v[64:67], v[32:35], v[156:159]
    s_nop 7
    v_mov_b32 v200, 0xff800000
    v_mov_b32 v201, 0x3fb8aa3b
    v_cvt_pk_bf16_f32 v202, v152, v153
    v_cvt_pk_bf16_f32 v203, v154, v155
    v_lshlrev_b32 v152, 16, v202
    v_and_b32 v153, 0xffff0000, v202
    v_lshlrev_b32 v154, 16, v203
    v_and_b32 v155, 0xffff0000, v203
    v_mul_f32 v152, 0x3db504f3, v152
    v_mul_f32 v153, 0x3db504f3, v153
    v_mul_f32 v154, 0x3db504f3, v154
    v_mul_f32 v155, 0x3db504f3, v155
    v_cvt_pk_bf16_f32 v202, v152, v153
    v_cvt_pk_bf16_f32 v203, v154, v155
    v_lshlrev_b32 v152, 16, v202
    v_and_b32 v153, 0xffff0000, v202
    v_lshlrev_b32 v154, 16, v203
    v_and_b32 v155, 0xffff0000, v203
    v_cndmask_b32 v152, v200, v152, s[36:37]
    v_cndmask_b32 v153, v200, v153, s[36:37]
    v_cndmask_b32 v154, v200, v154, s[36:37]
    v_cndmask_b32 v155, v200, v155, s[36:37]
    v_cvt_pk_bf16_f32 v202, v156, v157
    v_cvt_pk_bf16_f32 v203, v158, v159
    v_lshlrev_b32 v156, 16, v202
    v_and_b32 v157, 0xffff0000, v202
    v_lshlrev_b32 v158, 16, v203
    v_and_b32 v159, 0xffff0000, v203
    v_mul_f32 v156, 0x3db504f3, v156
    v_mul_f32 v157, 0x3db504f3, v157
    v_mul_f32 v158, 0x3db504f3, v158
    v_mul_f32 v159, 0x3db504f3, v159
    v_cvt_pk_bf16_f32 v202, v156, v157
    v_cvt_pk_bf16_f32 v203, v158, v159
    v_lshlrev_b32 v156, 16, v202
    v_and_b32 v157, 0xffff0000, v202
    v_lshlrev_b32 v158, 16, v203
    v_and_b32 v159, 0xffff0000, v203
    v_cndmask_b32 v156, v200, v156, s[28:29]
    v_cndmask_b32 v157, v200, v157, s[30:31]
    v_cndmask_b32 v158, v200, v158, s[32:33]
    v_cndmask_b32 v159, v200, v159, s[34:35]
    v_max_f32 v204, v152, v153
    v_max3_f32 v204, v204, v154, v155
    v_max3_f32 v204, v204, v156, v157
    v_max3_f32 v204, v204, v158, v159
    v_mov_b32 v205, v204
    s_nop 1
    v_permlane16_swap_b32 v204, v205
    s_nop 1
    v_max_f32 v204, v204, v205
    v_mov_b32 v205, v204
    s_nop 1
    v_permlane32_swap_b32 v204, v205
    s_nop 1
    v_max_f32 v204, v204, v205
    v_sub_f32 v152, v152, v204
    v_mul_f32 v152, v201, v152
    v_exp_f32 v152, v152
    v_sub_f32 v153, v153, v204
    v_mul_f32 v153, v201, v153
    v_exp_f32 v153, v153
    v_sub_f32 v154, v154, v204
    v_mul_f32 v154, v201, v154
    v_exp_f32 v154, v154
    v_sub_f32 v155, v155, v204
    v_mul_f32 v155, v201, v155
    v_exp_f32 v155, v155
    v_sub_f32 v156, v156, v204
    v_mul_f32 v156, v201, v156
    v_exp_f32 v156, v156
    v_sub_f32 v157, v157, v204
    v_mul_f32 v157, v201, v157
    v_exp_f32 v157, v157
    v_sub_f32 v158, v158, v204
    v_mul_f32 v158, v201, v158
    v_exp_f32 v158, v158
    v_sub_f32 v159, v159, v204
    v_mul_f32 v159, v201, v159
    v_exp_f32 v159, v159
    s_nop 0
    v_add_f32 v204, v152, v153
    v_add_f32 v204, v204, v154
    v_add_f32 v204, v204, v155
    v_add_f32 v204, v204, v156
    v_add_f32 v204, v204, v157
    v_add_f32 v204, v204, v158
    v_add_f32 v204, v204, v159
    v_mov_b32 v205, v204
    s_nop 1
    v_permlane16_swap_b32 v204, v205
    s_nop 1
    v_add_f32 v204, v204, v205
    v_mov_b32 v205, v204
    s_nop 1
    v_permlane32_swap_b32 v204, v205
    s_nop 1
    v_add_f32 v204, v204, v205
    v_rcp_f32 v204, v204
    s_nop 0
    v_mul_f32 v152, v152, v204
    v_mul_f32 v153, v153, v204
    v_mul_f32 v154, v154, v204
    v_mul_f32 v155, v155, v204
    v_mul_f32 v156, v156, v204
    v_mul_f32 v157, v157, v204
    v_mul_f32 v158, v158, v204
    v_mul_f32 v159, v159, v204
    v_cvt_pk_bf16_f32 v180, v152, v153
    v_cvt_pk_bf16_f32 v181, v154, v155
    v_mov_b32 v182, 0
    v_mov_b32 v183, 0
    v_cvt_pk_bf16_f32 v176, v156, v157
    v_cvt_pk_bf16_f32 v177, v158, v159
    v_mov_b32 v178, 0
    v_mov_b32 v179, 0
    s_waitcnt vmcnt(0)
    s_nop 1
    v_mfma_f32_16x16x32_bf16 v[8:11], v[88:91], v[176:179], 0
    v_mfma_f32_16x16x32_bf16 v[12:15], v[92:95], v[176:179], 0
    v_mfma_f32_16x16x32_bf16 v[16:19], v[96:99], v[176:179], 0
    v_mfma_f32_16x16x32_bf16 v[20:23], v[100:103], v[176:179], 0
    v_mfma_f32_16x16x32_bf16 v[24:27], v[104:107], v[176:179], 0
    v_mfma_f32_16x16x32_bf16 v[28:31], v[108:111], v[176:179], 0
    v_mfma_f32_16x16x32_bf16 v[32:35], v[112:115], v[176:179], 0
    v_mfma_f32_16x16x32_bf16 v[36:39], v[116:119], v[176:179], 0
    v_mfma_f32_16x16x32_bf16 v[8:11], v[120:123], v[180:183], v[8:11]
    v_mfma_f32_16x16x32_bf16 v[12:15], v[124:127], v[180:183], v[12:15]
    v_mfma_f32_16x16x32_bf16 v[16:19], v[128:131], v[180:183], v[16:19]
    v_mfma_f32_16x16x32_bf16 v[20:23], v[132:135], v[180:183], v[20:23]
    v_mfma_f32_16x16x32_bf16 v[24:27], v[136:139], v[180:183], v[24:27]
    v_mfma_f32_16x16x32_bf16 v[28:31], v[140:143], v[180:183], v[28:31]
    v_mfma_f32_16x16x32_bf16 v[32:35], v[144:147], v[180:183], v[32:35]
    v_mfma_f32_16x16x32_bf16 v[36:39], v[148:151], v[180:183], v[36:39]
    s_nop 7
    s_lshl_b32 s16, s13, 18
    s_lshl_b32 s17, s14, 12
    s_add_u32 s16, s16, s17
    s_add_u32 s16, s16, 100663296
    s_add_u32 s18, s4, s16
    s_addc_u32 s19, s5, 0
    v_add_u32 v4, 0, v3
    v_cvt_pk_bf16_f32 v184, v8, v9
    v_cvt_pk_bf16_f32 v185, v10, v11
    v_cvt_pk_bf16_f32 v186, v12, v13
    v_cvt_pk_bf16_f32 v187, v14, v15
    v_min_u32 v184, -2, v184
    v_min_u32 v185, -2, v185
    v_min_u32 v186, -2, v186
    v_min_u32 v187, -2, v187
    global_store_dwordx4 v4, v[184:187], s[18:19] offset:0 sc1
    v_cvt_pk_bf16_f32 v188, v16, v17
    v_cvt_pk_bf16_f32 v189, v18, v19
    v_cvt_pk_bf16_f32 v190, v20, v21
    v_cvt_pk_bf16_f32 v191, v22, v23
    v_min_u32 v188, -2, v188
    v_min_u32 v189, -2, v189
    v_min_u32 v190, -2, v190
    v_min_u32 v191, -2, v191
    global_store_dwordx4 v4, v[188:191], s[18:19] offset:1024 sc1
    v_cvt_pk_bf16_f32 v192, v24, v25
    v_cvt_pk_bf16_f32 v193, v26, v27
    v_cvt_pk_bf16_f32 v194, v28, v29
    v_cvt_pk_bf16_f32 v195, v30, v31
    v_min_u32 v192, -2, v192
    v_min_u32 v193, -2, v193
    v_min_u32 v194, -2, v194
    v_min_u32 v195, -2, v195
    global_store_dwordx4 v4, v[192:195], s[18:19] offset:2048 sc1
    v_cvt_pk_bf16_f32 v196, v32, v33
    v_cvt_pk_bf16_f32 v197, v34, v35
    v_cvt_pk_bf16_f32 v198, v36, v37
    v_cvt_pk_bf16_f32 v199, v38, v39
    v_min_u32 v196, -2, v196
    v_min_u32 v197, -2, v197
    v_min_u32 v198, -2, v198
    v_min_u32 v199, -2, v199
    global_store_dwordx4 v4, v[196:199], s[18:19] offset:3072 sc1
    s_nop 1
    s_branch WK_ATD
WK_AT1:
    s_lshl_b32 s16, s14, 6
    s_add_u32 s28, s16, s13
    s_lshl_b32 s16, s28, 13
    s_add_u32 s17, s16, 33554432
    s_add_u32 s18, s4, s17
    s_addc_u32 s19, s5, 0
    s_add_u32 s17, s16, 50331648
    s_add_u32 s20, s4, s17
    s_addc_u32 s21, s5, 0
    s_add_u32 s17, s16, 67108864
    s_add_u32 s22, s4, s17
    s_addc_u32 s23, s5, 0
    s_lshl_b32 s16, s28, 12
    s_add_u32 s17, s16, 83886080
    s_add_u32 s24, s4, s17
    s_addc_u32 s25, s5, 0
    s_add_u32 s17, s16, 92274688
    s_add_u32 s26, s4, s17
    s_addc_u32 s27, s5, 0
    v_add_u32 v4, 4096, v3
    v_lshrrev_b32 v5, 1, v3
    global_load_dwordx4 v[12:15], v3, s[18:19] offset:1024 sc1
    global_load_dwordx4 v[20:23], v3, s[18:19] offset:3072 sc1
    global_load_dwordx4 v[28:31], v4, s[18:19] offset:1024 sc1
    global_load_dwordx4 v[36:39], v4, s[18:19] offset:3072 sc1
    global_load_dwordx4 v[40:43], v3, s[20:21] offset:0 sc1
    global_load_dwordx4 v[44:47], v3, s[20:21] offset:1024 sc1
    global_load_dwordx4 v[48:51], v3, s[20:21] offset:2048 sc1
    global_load_dwordx4 v[52:55], v3, s[20:21] offset:3072 sc1
    global_load_dwordx4 v[56:59], v4, s[20:21] offset:0 sc1
    global_load_dwordx4 v[60:63], v4, s[20:21] offset:1024 sc1
    global_load_dwordx4 v[64:67], v4, s[20:21] offset:2048 sc1
    global_load_dwordx4 v[68:71], v4, s[20:21] offset:3072 sc1
    global_load_dwordx4 v[88:91], v3, s[22:23] offset:0 sc1
    global_load_dwordx4 v[92:95], v3, s[22:23] offset:1024 sc1
    global_load_dwordx4 v[96:99], v3, s[22:23] offset:2048 sc1
    global_load_dwordx4 v[100:103], v3, s[22:23] offset:3072 sc1
    global_load_dwordx4 v[104:107], v4, s[22:23] offset:0 sc1
    global_load_dwordx4 v[108:111], v4, s[22:23] offset:1024 sc1
    global_load_dwordx4 v[112:115], v4, s[22:23] offset:2048 sc1
    global_load_dwordx4 v[116:119], v4, s[22:23] offset:3072 sc1
    v_mov_b64 v[120:121], 0
    v_mov_b64 v[122:123], 0
    v_mov_b64 v[124:125], 0
    v_mov_b64 v[126:127], 0
    v_mov_b64 v[128:129], 0
    v_mov_b64 v[130:131], 0
    v_mov_b64 v[132:133], 0
    v_mov_b64 v[134:135], 0
    v_mov_b64 v[136:137], 0
    v_mov_b64 v[138:139], 0
    v_mov_b64 v[140:141], 0
    v_mov_b64 v[142:143], 0
    v_mov_b64 v[144:145], 0
    v_mov_b64 v[146:147], 0
    v_mov_b64 v[148:149], 0
    v_mov_b64 v[150:151], 0
    s_cmp_eq_u32 s13, 63
    s_cbranch_scc1 WKA1_DP
WK_MP1:
    global_load_dword v212, v207, s[4:5] sc1
    s_waitcnt vmcnt(0)
    v_cmp_ne_u32 vcc, s56, v212
    s_cbranch_vccz WK_MG1
    s_sleep 8
    s_branch WK_MP1
WK_MG1:
    global_load_dwordx4 v[72:75], v3, s[24:25] offset:0 sc1
    global_load_dwordx4 v[76:79], v3, s[24:25] offset:1024 sc1
    global_load_dwordx4 v[80:83], v3, s[24:25] offset:2048 sc1
    global_load_dwordx4 v[84:87], v3, s[24:25] offset:3072 sc1
    s_mov_b32 exec_hi, 0
    global_load_dwordx2 v[120:121], v5, s[26:27] offset:0 sc1
    global_load_dwordx2 v[124:125], v5, s[26:27] offset:512 sc1
    global_load_dwordx2 v[128:129], v5, s[26:27] offset:1024 sc1
    global_load_dwordx2 v[132:133], v5, s[26:27] offset:1536 sc1
    global_load_dwordx2 v[136:137], v5, s[26:27] offset:2048 sc1
    global_load_dwordx2 v[140:141], v5, s[26:27] offset:2560 sc1
    global_load_dwordx2 v[144:145], v5, s[26:27] offset:3072 sc1
    global_load_dwordx2 v[148:149], v5, s[26:27] offset:3584 sc1
    s_mov_b32 exec_hi, -1
    s_branch WKA1_DPE
WKA1_DPS:
    s_sleep 2
WKA1_DP:
    global_load_dwordx4 v[72:75], v3, s[24:25] offset:0 sc1
    global_load_dwordx4 v[76:79], v3, s[24:25] offset:1024 sc1
    global_load_dwordx4 v[80:83], v3, s[24:25] offset:2048 sc1
    global_load_dwordx4 v[84:87], v3, s[24:25] offset:3072 sc1
    s_mov_b32 exec_hi, 0
    global_load_dwordx2 v[120:121], v5, s[26:27] offset:0 sc1
    global_load_dwordx2 v[124:125], v5, s[26:27] offset:512 sc1
    global_load_dwordx2 v[128:129], v5, s[26:27] offset:1024 sc1
    global_load_dwordx2 v[132:133], v5, s[26:27] offset:1536 sc1
    global_load_dwordx2 v[136:137], v5, s[26:27] offset:2048 sc1
    global_load_dwordx2 v[140:141], v5, s[26:27] offset:2560 sc1
    global_load_dwordx2 v[144:145], v5, s[26:27] offset:3072 sc1
    global_load_dwordx2 v[148:149], v5, s[26:27] offset:3584 sc1
    s_mov_b32 exec_hi, -1
    s_waitcnt vmcnt(0)
    v_max3_u32 v200, v72, v73, v74
    v_max3_u32 v200, v200, v75, v76
    v_max3_u32 v200, v200, v77, v78
    v_max3_u32 v200, v200, v79, v80
    v_max3_u32 v200, v200, v81, v82
    v_max3_u32 v200, v200, v83, v84
    v_max3_u32 v200, v200, v85, v86
    v_max_u32 v200, v200, v87
    v_max3_u32 v201, v120, v121, v124
    v_max3_u32 v201, v201, v125, v128
    v_max3_u32 v201, v201, v129, v132
    v_max3_u32 v201, v201, v133, v136
    v_max3_u32 v201, v201, v137, v140
    v_max3_u32 v201, v201, v141, v144
    v_max3_u32 v201, v201, v145, v148
    v_max_u32 v201, v201, v149
    v_cmp_eq_u32 vcc, -1, v200
    s_or_b32 s16, vcc_lo, vcc_hi
    s_and_b32 s16, s16, 0x00ff00ff
    v_cmp_eq_u32 vcc, -1, v201
    s_or_b32 s16, s16, vcc_lo
    s_or_b32 s16, s16, vcc_hi
    s_cbranch_scc1 WKA1_DPS
WKA1_DPE:
    v_lshrrev_b32 v6, 4, v2
    v_lshlrev_b32 v6, 2, v6
    v_and_b32 v7, 15, v2
    v_add_u32 v1, 0, v6
    v_cmp_le_u32 s[28:29], v1, v7
    v_add_u32 v1, 1, v6
    v_cmp_le_u32 s[30:31], v1, v7
    v_add_u32 v1, 2, v6
    v_cmp_le_u32 s[32:33], v1, v7
    v_add_u32 v1, 3, v6
    v_cmp_le_u32 s[34:35], v1, v7
    s_mov_b32 s36, -1
    s_mov_b32 s37, 0
    s_waitcnt vmcnt(8)
    v_mfma_f32_16x16x32_bf16 v[164:167], v[72:75], v[12:15], 0
    v_mfma_f32_16x16x32_bf16 v[164:167], v[76:79], v[20:23], v[164:167]
    v_mfma_f32_16x16x32_bf16 v[164:167], v[80:83], v[28:31], v[164:167]
    v_mfma_f32_16x16x32_bf16 v[164:167], v[84:87], v[36:39], v[164:167]
    v_mfma_f32_16x16x32_bf16 v[168:171], v[40:43], v[12:15], 0
    v_mfma_f32_16x16x32_bf16 v[168:171], v[48:51], v[20:23], v[168:171]
    v_mfma_f32_16x16x32_bf16 v[168:171], v[56:59], v[28:31], v[168:171]
    v_mfma_f32_16x16x32_bf16 v[168:171], v[64:67], v[36:39], v[168:171]
    v_mfma_f32_16x16x32_bf16 v[172:175], v[44:47], v[12:15], 0
    v_mfma_f32_16x16x32_bf16 v[172:175], v[52:55], v[20:23], v[172:175]
    v_mfma_f32_16x16x32_bf16 v[172:175], v[60:63], v[28:31], v[172:175]
    v_mfma_f32_16x16x32_bf16 v[172:175], v[68:71], v[36:39], v[172:175]
    s_nop 7
    v_mov_b32 v200, 0xff800000
    v_mov_b32 v201, 0x3fb8aa3b
    v_cvt_pk_bf16_f32 v202, v164, v165
    v_cvt_pk_bf16_f32 v203, v166, v167
    v_lshlrev_b32 v164, 16, v202
    v_and_b32 v165, 0xffff0000, v202
    v_lshlrev_b32 v166, 16, v203
    v_and_b32 v167, 0xffff0000, v203
    v_mul_f32 v164, 0x3db504f3, v164
    v_mul_f32 v165, 0x3db504f3, v165
    v_mul_f32 v166, 0x3db504f3, v166
    v_mul_f32 v167, 0x3db504f3, v167
    v_cvt_pk_bf16_f32 v202, v164, v165
    v_cvt_pk_bf16_f32 v203, v166, v167
    v_lshlrev_b32 v164, 16, v202
    v_and_b32 v165, 0xffff0000, v202
    v_lshlrev_b32 v166, 16, v203
    v_and_b32 v167, 0xffff0000, v203
    v_cndmask_b32 v164, v200, v164, s[36:37]
    v_cndmask_b32 v165, v200, v165, s[36:37]
    v_cndmask_b32 v166, v200, v166, s[36:37]
    v_cndmask_b32 v167, v200, v167, s[36:37]
    v_cvt_pk_bf16_f32 v202, v168, v169
    v_cvt_pk_bf16_f32 v203, v170, v171
    v_lshlrev_b32 v168, 16, v202
    v_and_b32 v169, 0xffff0000, v202
    v_lshlrev_b32 v170, 16, v203
    v_and_b32 v171, 0xffff0000, v203
    v_mul_f32 v168, 0x3db504f3, v168
    v_mul_f32 v169, 0x3db504f3, v169
    v_mul_f32 v170, 0x3db504f3, v170
    v_mul_f32 v171, 0x3db504f3, v171
    v_cvt_pk_bf16_f32 v202, v168, v169
    v_cvt_pk_bf16_f32 v203, v170, v171
    v_lshlrev_b32 v168, 16, v202
    v_and_b32 v169, 0xffff0000, v202
    v_lshlrev_b32 v170, 16, v203
    v_and_b32 v171, 0xffff0000, v203
    v_cvt_pk_bf16_f32 v202, v172, v173
    v_cvt_pk_bf16_f32 v203, v174, v175
    v_lshlrev_b32 v172, 16, v202
    v_and_b32 v173, 0xffff0000, v202
    v_lshlrev_b32 v174, 16, v203
    v_and_b32 v175, 0xffff0000, v203
    v_mul_f32 v172, 0x3db504f3, v172
    v_mul_f32 v173, 0x3db504f3, v173
    v_mul_f32 v174, 0x3db504f3, v174
    v_mul_f32 v175, 0x3db504f3, v175
    v_cvt_pk_bf16_f32 v202, v172, v173
    v_cvt_pk_bf16_f32 v203, v174, v175
    v_lshlrev_b32 v172, 16, v202
    v_and_b32 v173, 0xffff0000, v202
    v_lshlrev_b32 v174, 16, v203
    v_and_b32 v175, 0xffff0000, v203
    v_cndmask_b32 v172, v200, v172, s[28:29]
    v_cndmask_b32 v173, v200, v173, s[30:31]
    v_cndmask_b32 v174, v200, v174, s[32:33]
    v_cndmask_b32 v175, v200, v175, s[34:35]
    v_max_f32 v204, v164, v165
    v_max3_f32 v204, v204, v166, v167
    v_max3_f32 v204, v204, v168, v169
    v_max3_f32 v204, v204, v170, v171
    v_max3_f32 v204, v204, v172, v173
    v_max3_f32 v204, v204, v174, v175
    v_mov_b32 v205, v204
    s_nop 1
    v_permlane16_swap_b32 v204, v205
    s_nop 1
    v_max_f32 v204, v204, v205
    v_mov_b32 v205, v204
    s_nop 1
    v_permlane32_swap_b32 v204, v205
    s_nop 1
    v_max_f32 v204, v204, v205
    v_sub_f32 v164, v164, v204
    v_mul_f32 v164, v201, v164
    v_exp_f32 v164, v164
    v_sub_f32 v165, v165, v204
    v_mul_f32 v165, v201, v165
    v_exp_f32 v165, v165
    v_sub_f32 v166, v166, v204
    v_mul_f32 v166, v201, v166
    v_exp_f32 v166, v166
    v_sub_f32 v167, v167, v204
    v_mul_f32 v167, v201, v167
    v_exp_f32 v167, v167
    v_sub_f32 v168, v168, v204
    v_mul_f32 v168, v201, v168
    v_exp_f32 v168, v168
    v_sub_f32 v169, v169, v204
    v_mul_f32 v169, v201, v169
    v_exp_f32 v169, v169
    v_sub_f32 v170, v170, v204
    v_mul_f32 v170, v201, v170
    v_exp_f32 v170, v170
    v_sub_f32 v171, v171, v204
    v_mul_f32 v171, v201, v171
    v_exp_f32 v171, v171
    v_sub_f32 v172, v172, v204
    v_mul_f32 v172, v201, v172
    v_exp_f32 v172, v172
    v_sub_f32 v173, v173, v204
    v_mul_f32 v173, v201, v173
    v_exp_f32 v173, v173
    v_sub_f32 v174, v174, v204
    v_mul_f32 v174, v201, v174
    v_exp_f32 v174, v174
    v_sub_f32 v175, v175, v204
    v_mul_f32 v175, v201, v175
    v_exp_f32 v175, v175
    s_nop 0
    v_add_f32 v204, v164, v165
    v_add_f32 v204, v204, v166
    v_add_f32 v204, v204, v167
    v_add_f32 v204, v204, v168
    v_add_f32 v204, v204, v169
    v_add_f32 v204, v204, v170
    v_add_f32 v204, v204, v171
    v_add_f32 v204, v204, v172
    v_add_f32 v204, v204, v173
    v_add_f32 v204, v204, v174
    v_add_f32 v204, v204, v175
    v_mov_b32 v205, v204
    s_nop 1
    v_permlane16_swap_b32 v204, v205
    s_nop 1
    v_add_f32 v204, v204, v205
    v_mov_b32 v205, v204
    s_nop 1
    v_permlane32_swap_b32 v204, v205
    s_nop 1
    v_add_f32 v204, v204, v205
    v_rcp_f32 v204, v204
    s_nop 0
    v_mul_f32 v164, v164, v204
    v_mul_f32 v165, v165, v204
    v_mul_f32 v166, v166, v204
    v_mul_f32 v167, v167, v204
    v_mul_f32 v168, v168, v204
    v_mul_f32 v169, v169, v204
    v_mul_f32 v170, v170, v204
    v_mul_f32 v171, v171, v204
    v_mul_f32 v172, v172, v204
    v_mul_f32 v173, v173, v204
    v_mul_f32 v174, v174, v204
    v_mul_f32 v175, v175, v204
    v_cvt_pk_bf16_f32 v188, v164, v165
    v_cvt_pk_bf16_f32 v189, v166, v167
    v_mov_b32 v190, 0
    v_mov_b32 v191, 0
    v_cvt_pk_bf16_f32 v184, v168, v169
    v_cvt_pk_bf16_f32 v185, v170, v171
    v_cvt_pk_bf16_f32 v186, v172, v173
    v_cvt_pk_bf16_f32 v187, v174, v175
    s_waitcnt vmcnt(0)
    s_nop 1
    v_mfma_f32_16x16x32_bf16 v[40:43], v[88:91], v[184:187], 0
    v_mfma_f32_16x16x32_bf16 v[44:47], v[92:95], v[184:187], 0
    v_mfma_f32_16x16x32_bf16 v[48:51], v[96:99], v[184:187], 0
    v_mfma_f32_16x16x32_bf16 v[52:55], v[100:103], v[184:187], 0
    v_mfma_f32_16x16x32_bf16 v[56:59], v[104:107], v[184:187], 0
    v_mfma_f32_16x16x32_bf16 v[60:63], v[108:111], v[184:187], 0
    v_mfma_f32_16x16x32_bf16 v[64:67], v[112:115], v[184:187], 0
    v_mfma_f32_16x16x32_bf16 v[68:71], v[116:119], v[184:187], 0
    v_mfma_f32_16x16x32_bf16 v[40:43], v[120:123], v[188:191], v[40:43]
    v_mfma_f32_16x16x32_bf16 v[44:47], v[124:127], v[188:191], v[44:47]
    v_mfma_f32_16x16x32_bf16 v[48:51], v[128:131], v[188:191], v[48:51]
    v_mfma_f32_16x16x32_bf16 v[52:55], v[132:135], v[188:191], v[52:55]
    v_mfma_f32_16x16x32_bf16 v[56:59], v[136:139], v[188:191], v[56:59]
    v_mfma_f32_16x16x32_bf16 v[60:63], v[140:143], v[188:191], v[60:63]
    v_mfma_f32_16x16x32_bf16 v[64:67], v[144:147], v[188:191], v[64:67]
    v_mfma_f32_16x16x32_bf16 v[68:71], v[148:151], v[188:191], v[68:71]
    s_nop 7
    s_lshl_b32 s16, s13, 18
    s_lshl_b32 s17, s14, 12
    s_add_u32 s16, s16, s17
    s_add_u32 s16, s16, 100663296
    s_add_u32 s18, s4, s16
    s_addc_u32 s19, s5, 0
    v_add_u32 v4, 131072, v3
    v_cvt_pk_bf16_f32 v184, v40, v41
    v_cvt_pk_bf16_f32 v185, v42, v43
    v_cvt_pk_bf16_f32 v186, v44, v45
    v_cvt_pk_bf16_f32 v187, v46, v47
    v_min_u32 v184, -2, v184
    v_min_u32 v185, -2, v185
    v_min_u32 v186, -2, v186
    v_min_u32 v187, -2, v187
    global_store_dwordx4 v4, v[184:187], s[18:19] offset:0 sc1
    v_cvt_pk_bf16_f32 v188, v48, v49
    v_cvt_pk_bf16_f32 v189, v50, v51
    v_cvt_pk_bf16_f32 v190, v52, v53
    v_cvt_pk_bf16_f32 v191, v54, v55
    v_min_u32 v188, -2, v188
    v_min_u32 v189, -2, v189
    v_min_u32 v190, -2, v190
    v_min_u32 v191, -2, v191
    global_store_dwordx4 v4, v[188:191], s[18:19] offset:1024 sc1
    v_cvt_pk_bf16_f32 v192, v56, v57
    v_cvt_pk_bf16_f32 v193, v58, v59
    v_cvt_pk_bf16_f32 v194, v60, v61
    v_cvt_pk_bf16_f32 v195, v62, v63
    v_min_u32 v192, -2, v192
    v_min_u32 v193, -2, v193
    v_min_u32 v194, -2, v194
    v_min_u32 v195, -2, v195
    global_store_dwordx4 v4, v[192:195], s[18:19] offset:2048 sc1
    v_cvt_pk_bf16_f32 v196, v64, v65
    v_cvt_pk_bf16_f32 v197, v66, v67
    v_cvt_pk_bf16_f32 v198, v68, v69
    v_cvt_pk_bf16_f32 v199, v70, v71
    v_min_u32 v196, -2, v196
    v_min_u32 v197, -2, v197
    v_min_u32 v198, -2, v198
    v_min_u32 v199, -2, v199
    global_store_dwordx4 v4, v[196:199], s[18:19] offset:3072 sc1
    s_nop 1
WK_ATD:
    s_cmp_ge_u32 s42, 61
    s_cbranch_scc1 WK_WOLA
    s_lshl_b32 s41, s12, 3
    s_and_b32 s15, s3, 1
    s_lshl_b32 s15, s15, 2
    s_add_u32 s41, s41, s15
    s_add_u32 s41, s41, 4505600
    s_waitcnt vmcnt(0)
    s_mov_b64 s[38:39], exec
    v_mov_b32 v240, s41
    v_mov_b32 v241, s56
    s_mov_b64 exec, 1
    global_store_dword v240, v241, s[4:5] sc1
    s_mov_b64 exec, s[38:39]
    s_lshl_b32 s15, s42, 8
    s_add_u32 s15, s15, 4505600
    v_lshlrev_b32 v4, 2, v2
    v_and_b32 v5, 31, v2
    v_lshlrev_b32 v5, 2, v5
    v_add_u32 v5, 4523008, v5
    v_add_u32 v4, s15, v4
WK_OPOLL:
    global_load_dword v8, v4, s[4:5] sc1
    global_load_dword v9, v5, s[4:5] sc1
    s_waitcnt vmcnt(0)
    v_xor_b32 v8, s56, v8
    v_xor_b32 v9, s56, v9
    v_or_b32 v8, v8, v9
    v_cmp_ne_u32 vcc, 0, v8
    s_cbranch_vccz WK_OGO
    s_sleep 8
    s_branch WK_OPOLL
WK_OGO:
    s_lshl_b32 s12, s42, 18
    s_lshl_b32 s13, s3, 15
    s_add_u32 s12, s12, s13
    s_add_u32 s12, s12, 100663296
    s_add_u32 s20, s4, s12
    s_addc_u32 s21, s5, 0
    v_add_u32 v4, 131072, v3
    v_and_b32 v5, 15, v2
    v_lshlrev_b32 v5, 10, v5
    v_lshrrev_b32 v6, 4, v2
    v_lshlrev_b32 v6, 3, v6
    v_add_u32 v5, v5, v6
    s_lshl_b32 s12, s42, 15
    s_lshr_b32 s13, s3, 1
    s_lshl_b32 s13, s13, 14
    s_add_u32 s12, s12, s13
    s_lshl_b32 s13, s43, 6
    s_add_u32 s12, s12, s13
    s_and_b32 s13, s3, 1
    s_lshl_b32 s13, s13, 5
    s_add_u32 s12, s12, s13
    v_add_u32 v5, s12, v5
    global_load_dwordx2 v[24:25], v5, s[44:45]
    global_load_dwordx2 v[26:27], v5, s[4:5] sc1
    global_load_dwordx4 v[32:35], v3, s[20:21] offset:0 sc1
    global_load_dwordx4 v[36:39], v4, s[20:21] offset:0 sc1
    global_load_dwordx4 v[40:43], v3, s[20:21] offset:1024 sc1
    global_load_dwordx4 v[44:47], v4, s[20:21] offset:1024 sc1
    global_load_dwordx4 v[48:51], v3, s[20:21] offset:2048 sc1
    global_load_dwordx4 v[52:55], v4, s[20:21] offset:2048 sc1
    global_load_dwordx4 v[56:59], v3, s[20:21] offset:3072 sc1
    global_load_dwordx4 v[60:63], v4, s[20:21] offset:3072 sc1
    s_add_u32 s20, s20, 4096
    s_addc_u32 s21, s21, 0
    global_load_dwordx4 v[64:67], v3, s[20:21] offset:0 sc1
    global_load_dwordx4 v[68:71], v4, s[20:21] offset:0 sc1
    global_load_dwordx4 v[72:75], v3, s[20:21] offset:1024 sc1
    global_load_dwordx4 v[76:79], v4, s[20:21] offset:1024 sc1
    global_load_dwordx4 v[80:83], v3, s[20:21] offset:2048 sc1
    global_load_dwordx4 v[84:87], v4, s[20:21] offset:2048 sc1
    global_load_dwordx4 v[88:91], v3, s[20:21] offset:3072 sc1
    global_load_dwordx4 v[92:95], v4, s[20:21] offset:3072 sc1
    s_add_u32 s20, s20, 4096
    s_addc_u32 s21, s21, 0
    global_load_dwordx4 v[96:99], v3, s[20:21] offset:0 sc1
    global_load_dwordx4 v[100:103], v4, s[20:21] offset:0 sc1
    global_load_dwordx4 v[104:107], v3, s[20:21] offset:1024 sc1
    global_load_dwordx4 v[108:111], v4, s[20:21] offset:1024 sc1
    global_load_dwordx4 v[112:115], v3, s[20:21] offset:2048 sc1
    global_load_dwordx4 v[116:119], v4, s[20:21] offset:2048 sc1
    global_load_dwordx4 v[120:123], v3, s[20:21] offset:3072 sc1
    global_load_dwordx4 v[124:127], v4, s[20:21] offset:3072 sc1
    s_add_u32 s20, s20, 4096
    s_addc_u32 s21, s21, 0
    global_load_dwordx4 v[128:131], v3, s[20:21] offset:0 sc1
    global_load_dwordx4 v[132:135], v4, s[20:21] offset:0 sc1
    global_load_dwordx4 v[136:139], v3, s[20:21] offset:1024 sc1
    global_load_dwordx4 v[140:143], v4, s[20:21] offset:1024 sc1
    global_load_dwordx4 v[144:147], v3, s[20:21] offset:2048 sc1
    global_load_dwordx4 v[148:151], v4, s[20:21] offset:2048 sc1
    global_load_dwordx4 v[152:155], v3, s[20:21] offset:3072 sc1
    global_load_dwordx4 v[156:159], v4, s[20:21] offset:3072 sc1
    s_add_u32 s20, s20, 4096
    s_addc_u32 s21, s21, 0
    global_load_dwordx4 v[160:163], v3, s[20:21] offset:0 sc1
    global_load_dwordx4 v[164:167], v4, s[20:21] offset:0 sc1
    global_load_dwordx4 v[168:171], v3, s[20:21] offset:1024 sc1
    global_load_dwordx4 v[172:175], v4, s[20:21] offset:1024 sc1
    global_load_dwordx4 v[176:179], v3, s[20:21] offset:2048 sc1
    global_load_dwordx4 v[180:183], v4, s[20:21] offset:2048 sc1
    global_load_dwordx4 v[184:187], v3, s[20:21] offset:3072 sc1
    global_load_dwordx4 v[188:191], v4, s[20:21] offset:3072 sc1
    s_add_u32 s20, s20, 4096
    s_addc_u32 s21, s21, 0
    global_load_dwordx4 v[192:195], v3, s[20:21] offset:0 sc1
    global_load_dwordx4 v[196:199], v4, s[20:21] offset:0 sc1
    global_load_dwordx4 v[200:203], v3, s[20:21] offset:1024 sc1
    global_load_dwordx4 v[204:207], v4, s[20:21] offset:1024 sc1
    global_load_dwordx4 v[208:211], v3, s[20:21] offset:2048 sc1
    global_load_dwordx4 v[212:215], v4, s[20:21] offset:2048 sc1
    global_load_dwordx4 v[216:219], v3, s[20:21] offset:3072 sc1
    global_load_dwordx4 v[220:223], v4, s[20:21] offset:3072 sc1
    s_add_u32 s20, s20, 4096
    s_addc_u32 s21, s21, 0
    s_waitcnt vmcnt(46)
    v_mfma_f32_16x16x32_bf16 v[8:11], a[0:3], v[32:35], 0
    v_mfma_f32_16x16x32_bf16 v[12:15], a[4:7], v[32:35], 0
    v_mfma_f32_16x16x32_bf16 v[16:19], a[0:3], v[36:39], 0
    v_mfma_f32_16x16x32_bf16 v[20:23], a[4:7], v[36:39], 0
    global_load_dwordx4 v[32:35], v3, s[20:21] offset:0 sc1
    global_load_dwordx4 v[36:39], v4, s[20:21] offset:0 sc1
    s_waitcnt vmcnt(46)
    v_mfma_f32_16x16x32_bf16 v[8:11], a[8:11], v[40:43], v[8:11]
    v_mfma_f32_16x16x32_bf16 v[12:15], a[12:15], v[40:43], v[12:15]
    v_mfma_f32_16x16x32_bf16 v[16:19], a[8:11], v[44:47], v[16:19]
    v_mfma_f32_16x16x32_bf16 v[20:23], a[12:15], v[44:47], v[20:23]
    global_load_dwordx4 v[40:43], v3, s[20:21] offset:1024 sc1
    global_load_dwordx4 v[44:47], v4, s[20:21] offset:1024 sc1
    s_waitcnt vmcnt(46)
    v_mfma_f32_16x16x32_bf16 v[8:11], a[16:19], v[48:51], v[8:11]
    v_mfma_f32_16x16x32_bf16 v[12:15], a[20:23], v[48:51], v[12:15]
    v_mfma_f32_16x16x32_bf16 v[16:19], a[16:19], v[52:55], v[16:19]
    v_mfma_f32_16x16x32_bf16 v[20:23], a[20:23], v[52:55], v[20:23]
    global_load_dwordx4 v[48:51], v3, s[20:21] offset:2048 sc1
    global_load_dwordx4 v[52:55], v4, s[20:21] offset:2048 sc1
    s_waitcnt vmcnt(46)
    v_mfma_f32_16x16x32_bf16 v[8:11], a[24:27], v[56:59], v[8:11]
    v_mfma_f32_16x16x32_bf16 v[12:15], a[28:31], v[56:59], v[12:15]
    v_mfma_f32_16x16x32_bf16 v[16:19], a[24:27], v[60:63], v[16:19]
    v_mfma_f32_16x16x32_bf16 v[20:23], a[28:31], v[60:63], v[20:23]
    global_load_dwordx4 v[56:59], v3, s[20:21] offset:3072 sc1
    global_load_dwordx4 v[60:63], v4, s[20:21] offset:3072 sc1
    s_add_u32 s20, s20, 4096
    s_addc_u32 s21, s21, 0
    s_waitcnt vmcnt(46)
    v_mfma_f32_16x16x32_bf16 v[8:11], a[32:35], v[64:67], v[8:11]
    v_mfma_f32_16x16x32_bf16 v[12:15], a[36:39], v[64:67], v[12:15]
    v_mfma_f32_16x16x32_bf16 v[16:19], a[32:35], v[68:71], v[16:19]
    v_mfma_f32_16x16x32_bf16 v[20:23], a[36:39], v[68:71], v[20:23]
    global_load_dwordx4 v[64:67], v3, s[20:21] offset:0 sc1
    global_load_dwordx4 v[68:71], v4, s[20:21] offset:0 sc1
    s_waitcnt vmcnt(46)
    v_mfma_f32_16x16x32_bf16 v[8:11], a[40:43], v[72:75], v[8:11]
    v_mfma_f32_16x16x32_bf16 v[12:15], a[44:47], v[72:75], v[12:15]
    v_mfma_f32_16x16x32_bf16 v[16:19], a[40:43], v[76:79], v[16:19]
    v_mfma_f32_16x16x32_bf16 v[20:23], a[44:47], v[76:79], v[20:23]
    global_load_dwordx4 v[72:75], v3, s[20:21] offset:1024 sc1
    global_load_dwordx4 v[76:79], v4, s[20:21] offset:1024 sc1
    s_waitcnt vmcnt(46)
    v_mfma_f32_16x16x32_bf16 v[8:11], a[48:51], v[80:83], v[8:11]
    v_mfma_f32_16x16x32_bf16 v[12:15], a[52:55], v[80:83], v[12:15]
    v_mfma_f32_16x16x32_bf16 v[16:19], a[48:51], v[84:87], v[16:19]
    v_mfma_f32_16x16x32_bf16 v[20:23], a[52:55], v[84:87], v[20:23]
    global_load_dwordx4 v[80:83], v3, s[20:21] offset:2048 sc1
    global_load_dwordx4 v[84:87], v4, s[20:21] offset:2048 sc1
    s_waitcnt vmcnt(46)
    v_mfma_f32_16x16x32_bf16 v[8:11], a[56:59], v[88:91], v[8:11]
    v_mfma_f32_16x16x32_bf16 v[12:15], a[60:63], v[88:91], v[12:15]
    v_mfma_f32_16x16x32_bf16 v[16:19], a[56:59], v[92:95], v[16:19]
    v_mfma_f32_16x16x32_bf16 v[20:23], a[60:63], v[92:95], v[20:23]
    global_load_dwordx4 v[88:91], v3, s[20:21] offset:3072 sc1
    global_load_dwordx4 v[92:95], v4, s[20:21] offset:3072 sc1
    s_add_u32 s20, s20, 4096
    s_addc_u32 s21, s21, 0
    s_waitcnt vmcnt(46)
    v_mfma_f32_16x16x32_bf16 v[8:11], a[64:67], v[96:99], v[8:11]
    v_mfma_f32_16x16x32_bf16 v[12:15], a[68:71], v[96:99], v[12:15]
    v_mfma_f32_16x16x32_bf16 v[16:19], a[64:67], v[100:103], v[16:19]
    v_mfma_f32_16x16x32_bf16 v[20:23], a[68:71], v[100:103], v[20:23]
    s_waitcnt vmcnt(44)
    v_mfma_f32_16x16x32_bf16 v[8:11], a[72:75], v[104:107], v[8:11]
    v_mfma_f32_16x16x32_bf16 v[12:15], a[76:79], v[104:107], v[12:15]
    v_mfma_f32_16x16x32_bf16 v[16:19], a[72:75], v[108:111], v[16:19]
    v_mfma_f32_16x16x32_bf16 v[20:23], a[76:79], v[108:111], v[20:23]
    s_waitcnt vmcnt(42)
    v_mfma_f32_16x16x32_bf16 v[8:11], a[80:83], v[112:115], v[8:11]
    v_mfma_f32_16x16x32_bf16 v[12:15], a[84:87], v[112:115], v[12:15]
    v_mfma_f32_16x16x32_bf16 v[16:19], a[80:83], v[116:119], v[16:19]
    v_mfma_f32_16x16x32_bf16 v[20:23], a[84:87], v[116:119], v[20:23]
    s_waitcnt vmcnt(40)
    v_mfma_f32_16x16x32_bf16 v[8:11], a[88:91], v[120:123], v[8:11]
    v_mfma_f32_16x16x32_bf16 v[12:15], a[92:95], v[120:123], v[12:15]
    v_mfma_f32_16x16x32_bf16 v[16:19], a[88:91], v[124:127], v[16:19]
    v_mfma_f32_16x16x32_bf16 v[20:23], a[92:95], v[124:127], v[20:23]
    s_waitcnt vmcnt(38)
    v_mfma_f32_16x16x32_bf16 v[8:11], a[96:99], v[128:131], v[8:11]
    v_mfma_f32_16x16x32_bf16 v[12:15], a[100:103], v[128:131], v[12:15]
    v_mfma_f32_16x16x32_bf16 v[16:19], a[96:99], v[132:135], v[16:19]
    v_mfma_f32_16x16x32_bf16 v[20:23], a[100:103], v[132:135], v[20:23]
    s_waitcnt vmcnt(36)
    v_mfma_f32_16x16x32_bf16 v[8:11], a[104:107], v[136:139], v[8:11]
    v_mfma_f32_16x16x32_bf16 v[12:15], a[108:111], v[136:139], v[12:15]
    v_mfma_f32_16x16x32_bf16 v[16:19], a[104:107], v[140:143], v[16:19]
    v_mfma_f32_16x16x32_bf16 v[20:23], a[108:111], v[140:143], v[20:23]
    s_waitcnt vmcnt(34)
    v_mfma_f32_16x16x32_bf16 v[8:11], a[112:115], v[144:147], v[8:11]
    v_mfma_f32_16x16x32_bf16 v[12:15], a[116:119], v[144:147], v[12:15]
    v_mfma_f32_16x16x32_bf16 v[16:19], a[112:115], v[148:151], v[16:19]
    v_mfma_f32_16x16x32_bf16 v[20:23], a[116:119], v[148:151], v[20:23]
    s_waitcnt vmcnt(32)
    v_mfma_f32_16x16x32_bf16 v[8:11], a[120:123], v[152:155], v[8:11]
    v_mfma_f32_16x16x32_bf16 v[12:15], a[124:127], v[152:155], v[12:15]
    v_mfma_f32_16x16x32_bf16 v[16:19], a[120:123], v[156:159], v[16:19]
    v_mfma_f32_16x16x32_bf16 v[20:23], a[124:127], v[156:159], v[20:23]
    s_waitcnt vmcnt(30)
    v_mfma_f32_16x16x32_bf16 v[8:11], a[128:131], v[160:163], v[8:11]
    v_mfma_f32_16x16x32_bf16 v[12:15], a[132:135], v[160:163], v[12:15]
    v_mfma_f32_16x16x32_bf16 v[16:19], a[128:131], v[164:167], v[16:19]
    v_mfma_f32_16x16x32_bf16 v[20:23], a[132:135], v[164:167], v[20:23]
    s_waitcnt vmcnt(28)
    v_mfma_f32_16x16x32_bf16 v[8:11], a[136:139], v[168:171], v[8:11]
    v_mfma_f32_16x16x32_bf16 v[12:15], a[140:143], v[168:171], v[12:15]
    v_mfma_f32_16x16x32_bf16 v[16:19], a[136:139], v[172:175], v[16:19]
    v_mfma_f32_16x16x32_bf16 v[20:23], a[140:143], v[172:175], v[20:23]
    s_waitcnt vmcnt(26)
    v_mfma_f32_16x16x32_bf16 v[8:11], a[144:147], v[176:179], v[8:11]
    v_mfma_f32_16x16x32_bf16 v[12:15], a[148:151], v[176:179], v[12:15]
    v_mfma_f32_16x16x32_bf16 v[16:19], a[144:147], v[180:183], v[16:19]
    v_mfma_f32_16x16x32_bf16 v[20:23], a[148:151], v[180:183], v[20:23]
    s_waitcnt vmcnt(24)
    v_mfma_f32_16x16x32_bf16 v[8:11], a[152:155], v[184:187], v[8:11]
    v_mfma_f32_16x16x32_bf16 v[12:15], a[156:159], v[184:187], v[12:15]
    v_mfma_f32_16x16x32_bf16 v[16:19], a[152:155], v[188:191], v[16:19]
    v_mfma_f32_16x16x32_bf16 v[20:23], a[156:159], v[188:191], v[20:23]
    s_waitcnt vmcnt(22)
    v_mfma_f32_16x16x32_bf16 v[8:11], a[160:163], v[192:195], v[8:11]
    v_mfma_f32_16x16x32_bf16 v[12:15], a[164:167], v[192:195], v[12:15]
    v_mfma_f32_16x16x32_bf16 v[16:19], a[160:163], v[196:199], v[16:19]
    v_mfma_f32_16x16x32_bf16 v[20:23], a[164:167], v[196:199], v[20:23]
    s_waitcnt vmcnt(20)
    v_mfma_f32_16x16x32_bf16 v[8:11], a[168:171], v[200:203], v[8:11]
    v_mfma_f32_16x16x32_bf16 v[12:15], a[172:175], v[200:203], v[12:15]
    v_mfma_f32_16x16x32_bf16 v[16:19], a[168:171], v[204:207], v[16:19]
    v_mfma_f32_16x16x32_bf16 v[20:23], a[172:175], v[204:207], v[20:23]
    s_waitcnt vmcnt(18)
    v_mfma_f32_16x16x32_bf16 v[8:11], a[176:179], v[208:211], v[8:11]
    v_mfma_f32_16x16x32_bf16 v[12:15], a[180:183], v[208:211], v[12:15]
    v_mfma_f32_16x16x32_bf16 v[16:19], a[176:179], v[212:215], v[16:19]
    v_mfma_f32_16x16x32_bf16 v[20:23], a[180:183], v[212:215], v[20:23]
    s_waitcnt vmcnt(16)
    v_mfma_f32_16x16x32_bf16 v[8:11], a[184:187], v[216:219], v[8:11]
    v_mfma_f32_16x16x32_bf16 v[12:15], a[188:191], v[216:219], v[12:15]
    v_mfma_f32_16x16x32_bf16 v[16:19], a[184:187], v[220:223], v[16:19]
    v_mfma_f32_16x16x32_bf16 v[20:23], a[188:191], v[220:223], v[20:23]
    s_waitcnt vmcnt(14)
    v_mfma_f32_16x16x32_bf16 v[8:11], a[192:195], v[32:35], v[8:11]
    v_mfma_f32_16x16x32_bf16 v[12:15], a[196:199], v[32:35], v[12:15]
    v_mfma_f32_16x16x32_bf16 v[16:19], a[192:195], v[36:39], v[16:19]
    v_mfma_f32_16x16x32_bf16 v[20:23], a[196:199], v[36:39], v[20:23]
    s_waitcnt vmcnt(12)
    v_mfma_f32_16x16x32_bf16 v[8:11], a[200:203], v[40:43], v[8:11]
    v_mfma_f32_16x16x32_bf16 v[12:15], a[204:207], v[40:43], v[12:15]
    v_mfma_f32_16x16x32_bf16 v[16:19], a[200:203], v[44:47], v[16:19]
    v_mfma_f32_16x16x32_bf16 v[20:23], a[204:207], v[44:47], v[20:23]
    s_waitcnt vmcnt(10)
    v_mfma_f32_16x16x32_bf16 v[8:11], a[208:211], v[48:51], v[8:11]
    v_mfma_f32_16x16x32_bf16 v[12:15], a[212:215], v[48:51], v[12:15]
    v_mfma_f32_16x16x32_bf16 v[16:19], a[208:211], v[52:55], v[16:19]
    v_mfma_f32_16x16x32_bf16 v[20:23], a[212:215], v[52:55], v[20:23]
    s_waitcnt vmcnt(8)
    v_mfma_f32_16x16x32_bf16 v[8:11], a[216:219], v[56:59], v[8:11]
    v_mfma_f32_16x16x32_bf16 v[12:15], a[220:223], v[56:59], v[12:15]
    v_mfma_f32_16x16x32_bf16 v[16:19], a[216:219], v[60:63], v[16:19]
    v_mfma_f32_16x16x32_bf16 v[20:23], a[220:223], v[60:63], v[20:23]
    s_waitcnt vmcnt(6)
    v_mfma_f32_16x16x32_bf16 v[8:11], a[224:227], v[64:67], v[8:11]
    v_mfma_f32_16x16x32_bf16 v[12:15], a[228:231], v[64:67], v[12:15]
    v_mfma_f32_16x16x32_bf16 v[16:19], a[224:227], v[68:71], v[16:19]
    v_mfma_f32_16x16x32_bf16 v[20:23], a[228:231], v[68:71], v[20:23]
    s_waitcnt vmcnt(4)
    v_mfma_f32_16x16x32_bf16 v[8:11], a[232:235], v[72:75], v[8:11]
    v_mfma_f32_16x16x32_bf16 v[12:15], a[236:239], v[72:75], v[12:15]
    v_mfma_f32_16x16x32_bf16 v[16:19], a[232:235], v[76:79], v[16:19]
    v_mfma_f32_16x16x32_bf16 v[20:23], a[236:239], v[76:79], v[20:23]
    s_waitcnt vmcnt(2)
    v_mfma_f32_16x16x32_bf16 v[8:11], a[240:243], v[80:83], v[8:11]
    v_mfma_f32_16x16x32_bf16 v[12:15], a[244:247], v[80:83], v[12:15]
    v_mfma_f32_16x16x32_bf16 v[16:19], a[240:243], v[84:87], v[16:19]
    v_mfma_f32_16x16x32_bf16 v[20:23], a[244:247], v[84:87], v[20:23]
    s_waitcnt vmcnt(0)
    v_mfma_f32_16x16x32_bf16 v[8:11], a[248:251], v[88:91], v[8:11]
    v_mfma_f32_16x16x32_bf16 v[12:15], a[252:255], v[88:91], v[12:15]
    v_mfma_f32_16x16x32_bf16 v[16:19], a[248:251], v[92:95], v[16:19]
    v_mfma_f32_16x16x32_bf16 v[20:23], a[252:255], v[92:95], v[20:23]
    s_nop 7
    s_lshl_b32 s12, s3, 12
    v_add_u32 v6, s12, v3
    ds_write_b128 v6, v[8:11] offset:0
    ds_write_b128 v6, v[12:15] offset:1024
    ds_write_b128 v6, v[16:19] offset:2048
    ds_write_b128 v6, v[20:23] offset:3072
    s_waitcnt lgkmcnt(0)
    s_barrier
    s_lshl_b32 s12, s3, 10
    v_add_u32 v6, s12, v3
    ds_read_b128 v[32:35], v6 offset:0
    ds_read_b128 v[36:39], v6 offset:4096
    ds_read_b128 v[40:43], v6 offset:8192
    ds_read_b128 v[44:47], v6 offset:12288
    s_waitcnt lgkmcnt(0)
    s_barrier
    v_add_f32 v32, v32, v36
    v_add_f32 v40, v40, v44
    v_add_f32 v32, v32, v40
    v_add_f32 v33, v33, v37
    v_add_f32 v41, v41, v45
    v_add_f32 v33, v33, v41
    v_add_f32 v34, v34, v38
    v_add_f32 v42, v42, v46
    v_add_f32 v34, v34, v42
    v_add_f32 v35, v35, v39
    v_add_f32 v43, v43, v47
    v_add_f32 v35, v35, v43
    v_cvt_pk_bf16_f32 v16, v32, v33
    v_cvt_pk_bf16_f32 v17, v34, v35
    v_lshlrev_b32 v20, 16, v16
    v_and_b32 v21, 0xffff0000, v16
    v_lshlrev_b32 v22, 16, v17
    v_and_b32 v23, 0xffff0000, v17
    v_lshlrev_b32 v36, 16, v24
    v_and_b32 v37, 0xffff0000, v24
    v_lshlrev_b32 v38, 16, v25
    v_and_b32 v39, 0xffff0000, v25
    v_add_f32 v20, v20, v36
    v_add_f32 v21, v21, v37
    v_add_f32 v22, v22, v38
    v_add_f32 v23, v23, v39
    v_cvt_pk_bf16_f32 v16, v20, v21
    v_cvt_pk_bf16_f32 v17, v22, v23
    v_lshlrev_b32 v20, 16, v16
    v_and_b32 v21, 0xffff0000, v16
    v_lshlrev_b32 v22, 16, v17
    v_and_b32 v23, 0xffff0000, v17
    v_lshlrev_b32 v36, 16, v26
    v_and_b32 v37, 0xffff0000, v26
    v_lshlrev_b32 v38, 16, v27
    v_and_b32 v39, 0xffff0000, v27
    v_add_f32 v20, v20, v36
    v_add_f32 v21, v21, v37
    v_add_f32 v22, v22, v38
    v_add_f32 v23, v23, v39
    v_cvt_pk_bf16_f32 v16, v20, v21
    v_cvt_pk_bf16_f32 v17, v22, v23
    global_store_dwordx2 v5, v[16:17], s[46:47]
    s_add_u32 s42, s42, 14
    s_branch WK_SEG
WK_SEGX:
    s_lshr_b32 s12, s40, 4
    s_sub_u32 s12, s12, 8
    s_cmp_ge_u32 s12, 3
    s_cbranch_scc1 WK_END
    s_sub_u32 s42, 63, s12
    s_mov_b32 s60, 1
    s_lshl_b32 s12, s42, 13
    s_add_u32 s12, s12, 7340032
    v_lshlrev_b32 v4, 7, v2
    v_add_u32 v4, s12, v4
WK_WBP:
    global_load_dword v8, v4, s[4:5] sc1
    s_waitcnt vmcnt(0)
    v_cmp_ne_u32 vcc, s56, v8
    s_and_b32 s12, vcc_lo, vcc_hi
    s_cmp_eq_u32 s12, -1
    s_cbranch_scc0 WK_WOL
    s_sleep 8
    s_branch WK_WBP
WK_WOLA:
    s_mov_b32 s60, 0
WK_WOL:
    s_lshl_b32 s12, s42, 18
    s_lshl_b32 s13, s3, 15
    s_add_u32 s12, s12, s13
    s_lshl_b32 s13, s60, 17
    s_add_u32 s12, s12, s13
    s_add_u32 s12, s12, 100663296
    s_add_u32 s22, s4, s12
    s_addc_u32 s23, s5, 0
    v_and_b32 v5, 15, v2
    v_lshlrev_b32 v5, 10, v5
    v_lshrrev_b32 v6, 4, v2
    v_lshlrev_b32 v6, 3, v6
    v_add_u32 v5, v5, v6
    s_lshl_b32 s12, s42, 15
    s_lshl_b32 s13, s60, 14
    s_add_u32 s12, s12, s13
    s_lshl_b32 s13, s43, 6
    s_add_u32 s12, s12, s13
    s_and_b32 s13, s3, 1
    s_lshl_b32 s13, s13, 5
    s_add_u32 s12, s12, s13
    v_add_u32 v5, s12, v5
    global_load_dwordx2 v[24:25], v5, s[44:45]
    global_load_dwordx2 v[26:27], v5, s[4:5] sc1
WK_WOLP:
    s_mov_b64 s[20:21], s[22:23]
    global_load_dwordx4 v[32:35], v3, s[20:21] offset:0 sc1
    global_load_dwordx4 v[36:39], v3, s[20:21] offset:1024 sc1
    global_load_dwordx4 v[40:43], v3, s[20:21] offset:2048 sc1
    global_load_dwordx4 v[44:47], v3, s[20:21] offset:3072 sc1
    s_add_u32 s20, s20, 4096
    s_addc_u32 s21, s21, 0
    global_load_dwordx4 v[48:51], v3, s[20:21] offset:0 sc1
    global_load_dwordx4 v[52:55], v3, s[20:21] offset:1024 sc1
    global_load_dwordx4 v[56:59], v3, s[20:21] offset:2048 sc1
    global_load_dwordx4 v[60:63], v3, s[20:21] offset:3072 sc1
    s_add_u32 s20, s20, 4096
    s_addc_u32 s21, s21, 0
    global_load_dwordx4 v[64:67], v3, s[20:21] offset:0 sc1
    global_load_dwordx4 v[68:71], v3, s[20:21] offset:1024 sc1
    global_load_dwordx4 v[72:75], v3, s[20:21] offset:2048 sc1
    global_load_dwordx4 v[76:79], v3, s[20:21] offset:3072 sc1
    s_add_u32 s20, s20, 4096
    s_addc_u32 s21, s21, 0
    global_load_dwordx4 v[80:83], v3, s[20:21] offset:0 sc1
    global_load_dwordx4 v[84:87], v3, s[20:21] offset:1024 sc1
    global_load_dwordx4 v[88:91], v3, s[20:21] offset:2048 sc1
    global_load_dwordx4 v[92:95], v3, s[20:21] offset:3072 sc1
    s_add_u32 s20, s20, 4096
    s_addc_u32 s21, s21, 0
    global_load_dwordx4 v[96:99], v3, s[20:21] offset:0 sc1
    global_load_dwordx4 v[100:103], v3, s[20:21] offset:1024 sc1
    global_load_dwordx4 v[104:107], v3, s[20:21] offset:2048 sc1
    global_load_dwordx4 v[108:111], v3, s[20:21] offset:3072 sc1
    s_add_u32 s20, s20, 4096
    s_addc_u32 s21, s21, 0
    global_load_dwordx4 v[112:115], v3, s[20:21] offset:0 sc1
    global_load_dwordx4 v[116:119], v3, s[20:21] offset:1024 sc1
    global_load_dwordx4 v[120:123], v3, s[20:21] offset:2048 sc1
    global_load_dwordx4 v[124:127], v3, s[20:21] offset:3072 sc1
    s_add_u32 s20, s20, 4096
    s_addc_u32 s21, s21, 0
    global_load_dwordx4 v[128:131], v3, s[20:21] offset:0 sc1
    global_load_dwordx4 v[132:135], v3, s[20:21] offset:1024 sc1
    global_load_dwordx4 v[136:139], v3, s[20:21] offset:2048 sc1
    global_load_dwordx4 v[140:143], v3, s[20:21] offset:3072 sc1
    s_add_u32 s20, s20, 4096
    s_addc_u32 s21, s21, 0
    global_load_dwordx4 v[144:147], v3, s[20:21] offset:0 sc1
    global_load_dwordx4 v[148:151], v3, s[20:21] offset:1024 sc1
    global_load_dwordx4 v[152:155], v3, s[20:21] offset:2048 sc1
    global_load_dwordx4 v[156:159], v3, s[20:21] offset:3072 sc1
    s_waitcnt vmcnt(24)
    v_max3_u32 v160, v32, v33, v34
    v_max3_u32 v160, v160, v35, v36
    v_max3_u32 v160, v160, v37, v38
    v_max3_u32 v160, v160, v39, v40
    v_max3_u32 v160, v160, v41, v42
    v_max3_u32 v160, v160, v43, v44
    v_max3_u32 v160, v160, v45, v46
    v_max3_u32 v160, v160, v47, v48
    v_max3_u32 v160, v160, v49, v50
    v_max3_u32 v160, v160, v51, v52
    v_max3_u32 v160, v160, v53, v54
    v_max3_u32 v160, v160, v55, v56
    v_max3_u32 v160, v160, v57, v58
    v_max3_u32 v160, v160, v59, v60
    v_max3_u32 v160, v160, v61, v62
    v_max_u32 v160, v160, v63
    s_waitcnt vmcnt(16)
    v_max3_u32 v161, v64, v65, v66
    v_max3_u32 v161, v161, v67, v68
    v_max3_u32 v161, v161, v69, v70
    v_max3_u32 v161, v161, v71, v72
    v_max3_u32 v161, v161, v73, v74
    v_max3_u32 v161, v161, v75, v76
    v_max3_u32 v161, v161, v77, v78
    v_max3_u32 v161, v161, v79, v80
    v_max3_u32 v161, v161, v81, v82
    v_max3_u32 v161, v161, v83, v84
    v_max3_u32 v161, v161, v85, v86
    v_max3_u32 v161, v161, v87, v88
    v_max3_u32 v161, v161, v89, v90
    v_max3_u32 v161, v161, v91, v92
    v_max3_u32 v161, v161, v93, v94
    v_max_u32 v161, v161, v95
    s_waitcnt vmcnt(8)
    v_max3_u32 v162, v96, v97, v98
    v_max3_u32 v162, v162, v99, v100
    v_max3_u32 v162, v162, v101, v102
    v_max3_u32 v162, v162, v103, v104
    v_max3_u32 v162, v162, v105, v106
    v_max3_u32 v162, v162, v107, v108
    v_max3_u32 v162, v162, v109, v110
    v_max3_u32 v162, v162, v111, v112
    v_max3_u32 v162, v162, v113, v114
    v_max3_u32 v162, v162, v115, v116
    v_max3_u32 v162, v162, v117, v118
    v_max3_u32 v162, v162, v119, v120
    v_max3_u32 v162, v162, v121, v122
    v_max3_u32 v162, v162, v123, v124
    v_max3_u32 v162, v162, v125, v126
    v_max_u32 v162, v162, v127
    s_waitcnt vmcnt(0)
    v_max3_u32 v163, v128, v129, v130
    v_max3_u32 v163, v163, v131, v132
    v_max3_u32 v163, v163, v133, v134
    v_max3_u32 v163, v163, v135, v136
    v_max3_u32 v163, v163, v137, v138
    v_max3_u32 v163, v163, v139, v140
    v_max3_u32 v163, v163, v141, v142
    v_max3_u32 v163, v163, v143, v144
    v_max3_u32 v163, v163, v145, v146
    v_max3_u32 v163, v163, v147, v148
    v_max3_u32 v163, v163, v149, v150
    v_max3_u32 v163, v163, v151, v152
    v_max3_u32 v163, v163, v153, v154
    v_max3_u32 v163, v163, v155, v156
    v_max3_u32 v163, v163, v157, v158
    v_max_u32 v163, v163, v159
    v_max3_u32 v160, v160, v161, v162
    v_max_u32 v160, v160, v163
    v_cmp_eq_u32 vcc, -1, v160
    s_cbranch_vccnz WK_WOLP
    v_mfma_f32_16x16x32_bf16 v[8:11], a[0:3], v[32:35], 0
    v_mfma_f32_16x16x32_bf16 v[12:15], a[4:7], v[32:35], 0
    v_mfma_f32_16x16x32_bf16 v[8:11], a[8:11], v[36:39], v[8:11]
    v_mfma_f32_16x16x32_bf16 v[12:15], a[12:15], v[36:39], v[12:15]
    v_mfma_f32_16x16x32_bf16 v[8:11], a[16:19], v[40:43], v[8:11]
    v_mfma_f32_16x16x32_bf16 v[12:15], a[20:23], v[40:43], v[12:15]
    v_mfma_f32_16x16x32_bf16 v[8:11], a[24:27], v[44:47], v[8:11]
    v_mfma_f32_16x16x32_bf16 v[12:15], a[28:31], v[44:47], v[12:15]
    v_mfma_f32_16x16x32_bf16 v[8:11], a[32:35], v[48:51], v[8:11]
    v_mfma_f32_16x16x32_bf16 v[12:15], a[36:39], v[48:51], v[12:15]
    v_mfma_f32_16x16x32_bf16 v[8:11], a[40:43], v[52:55], v[8:11]
    v_mfma_f32_16x16x32_bf16 v[12:15], a[44:47], v[52:55], v[12:15]
    v_mfma_f32_16x16x32_bf16 v[8:11], a[48:51], v[56:59], v[8:11]
    v_mfma_f32_16x16x32_bf16 v[12:15], a[52:55], v[56:59], v[12:15]
    v_mfma_f32_16x16x32_bf16 v[8:11], a[56:59], v[60:63], v[8:11]
    v_mfma_f32_16x16x32_bf16 v[12:15], a[60:63], v[60:63], v[12:15]
    v_mfma_f32_16x16x32_bf16 v[8:11], a[64:67], v[64:67], v[8:11]
    v_mfma_f32_16x16x32_bf16 v[12:15], a[68:71], v[64:67], v[12:15]
    v_mfma_f32_16x16x32_bf16 v[8:11], a[72:75], v[68:71], v[8:11]
    v_mfma_f32_16x16x32_bf16 v[12:15], a[76:79], v[68:71], v[12:15]
    v_mfma_f32_16x16x32_bf16 v[8:11], a[80:83], v[72:75], v[8:11]
    v_mfma_f32_16x16x32_bf16 v[12:15], a[84:87], v[72:75], v[12:15]
    v_mfma_f32_16x16x32_bf16 v[8:11], a[88:91], v[76:79], v[8:11]
    v_mfma_f32_16x16x32_bf16 v[12:15], a[92:95], v[76:79], v[12:15]
    v_mfma_f32_16x16x32_bf16 v[8:11], a[96:99], v[80:83], v[8:11]
    v_mfma_f32_16x16x32_bf16 v[12:15], a[100:103], v[80:83], v[12:15]
    v_mfma_f32_16x16x32_bf16 v[8:11], a[104:107], v[84:87], v[8:11]
    v_mfma_f32_16x16x32_bf16 v[12:15], a[108:111], v[84:87], v[12:15]
    v_mfma_f32_16x16x32_bf16 v[8:11], a[112:115], v[88:91], v[8:11]
    v_mfma_f32_16x16x32_bf16 v[12:15], a[116:119], v[88:91], v[12:15]
    v_mfma_f32_16x16x32_bf16 v[8:11], a[120:123], v[92:95], v[8:11]
    v_mfma_f32_16x16x32_bf16 v[12:15], a[124:127], v[92:95], v[12:15]
    v_mfma_f32_16x16x32_bf16 v[8:11], a[128:131], v[96:99], v[8:11]
    v_mfma_f32_16x16x32_bf16 v[12:15], a[132:135], v[96:99], v[12:15]
    v_mfma_f32_16x16x32_bf16 v[8:11], a[136:139], v[100:103], v[8:11]
    v_mfma_f32_16x16x32_bf16 v[12:15], a[140:143], v[100:103], v[12:15]
    v_mfma_f32_16x16x32_bf16 v[8:11], a[144:147], v[104:107], v[8:11]
    v_mfma_f32_16x16x32_bf16 v[12:15], a[148:151], v[104:107], v[12:15]
    v_mfma_f32_16x16x32_bf16 v[8:11], a[152:155], v[108:111], v[8:11]
    v_mfma_f32_16x16x32_bf16 v[12:15], a[156:159], v[108:111], v[12:15]
    v_mfma_f32_16x16x32_bf16 v[8:11], a[160:163], v[112:115], v[8:11]
    v_mfma_f32_16x16x32_bf16 v[12:15], a[164:167], v[112:115], v[12:15]
    v_mfma_f32_16x16x32_bf16 v[8:11], a[168:171], v[116:119], v[8:11]
    v_mfma_f32_16x16x32_bf16 v[12:15], a[172:175], v[116:119], v[12:15]
    v_mfma_f32_16x16x32_bf16 v[8:11], a[176:179], v[120:123], v[8:11]
    v_mfma_f32_16x16x32_bf16 v[12:15], a[180:183], v[120:123], v[12:15]
    v_mfma_f32_16x16x32_bf16 v[8:11], a[184:187], v[124:127], v[8:11]
    v_mfma_f32_16x16x32_bf16 v[12:15], a[188:191], v[124:127], v[12:15]
    v_mfma_f32_16x16x32_bf16 v[8:11], a[192:195], v[128:131], v[8:11]
    v_mfma_f32_16x16x32_bf16 v[12:15], a[196:199], v[128:131], v[12:15]
    v_mfma_f32_16x16x32_bf16 v[8:11], a[200:203], v[132:135], v[8:11]
    v_mfma_f32_16x16x32_bf16 v[12:15], a[204:207], v[132:135], v[12:15]
    v_mfma_f32_16x16x32_bf16 v[8:11], a[208:211], v[136:139], v[8:11]
    v_mfma_f32_16x16x32_bf16 v[12:15], a[212:215], v[136:139], v[12:15]
    v_mfma_f32_16x16x32_bf16 v[8:11], a[216:219], v[140:143], v[8:11]
    v_mfma_f32_16x16x32_bf16 v[12:15], a[220:223], v[140:143], v[12:15]
    v_mfma_f32_16x16x32_bf16 v[8:11], a[224:227], v[144:147], v[8:11]
    v_mfma_f32_16x16x32_bf16 v[12:15], a[228:231], v[144:147], v[12:15]
    v_mfma_f32_16x16x32_bf16 v[8:11], a[232:235], v[148:151], v[8:11]
    v_mfma_f32_16x16x32_bf16 v[12:15], a[236:239], v[148:151], v[12:15]
    v_mfma_f32_16x16x32_bf16 v[8:11], a[240:243], v[152:155], v[8:11]
    v_mfma_f32_16x16x32_bf16 v[12:15], a[244:247], v[152:155], v[12:15]
    v_mfma_f32_16x16x32_bf16 v[8:11], a[248:251], v[156:159], v[8:11]
    v_mfma_f32_16x16x32_bf16 v[12:15], a[252:255], v[156:159], v[12:15]
    s_nop 7
    s_lshl_b32 s12, s3, 12
    v_add_u32 v6, s12, v3
    ds_write_b128 v6, v[8:11] offset:0
    ds_write_b128 v6, v[12:15] offset:1024
    s_waitcnt lgkmcnt(0)
    s_barrier
    s_cmp_ge_u32 s3, 2
    s_cbranch_scc1 WK_END
    s_lshl_b32 s12, s3, 10
    v_add_u32 v6, s12, v3
    ds_read_b128 v[32:35], v6 offset:0
    ds_read_b128 v[36:39], v6 offset:4096
    ds_read_b128 v[40:43], v6 offset:8192
    ds_read_b128 v[44:47], v6 offset:12288
    s_waitcnt lgkmcnt(0)
    v_add_f32 v32, v32, v36
    v_add_f32 v40, v40, v44
    v_add_f32 v32, v32, v40
    v_add_f32 v33, v33, v37
    v_add_f32 v41, v41, v45
    v_add_f32 v33, v33, v41
    v_add_f32 v34, v34, v38
    v_add_f32 v42, v42, v46
    v_add_f32 v34, v34, v42
    v_add_f32 v35, v35, v39
    v_add_f32 v43, v43, v47
    v_add_f32 v35, v35, v43
    v_cvt_pk_bf16_f32 v16, v32, v33
    v_cvt_pk_bf16_f32 v17, v34, v35
    v_lshlrev_b32 v20, 16, v16
    v_and_b32 v21, 0xffff0000, v16
    v_lshlrev_b32 v22, 16, v17
    v_and_b32 v23, 0xffff0000, v17
    v_lshlrev_b32 v36, 16, v24
    v_and_b32 v37, 0xffff0000, v24
    v_lshlrev_b32 v38, 16, v25
    v_and_b32 v39, 0xffff0000, v25
    v_add_f32 v20, v20, v36
    v_add_f32 v21, v21, v37
    v_add_f32 v22, v22, v38
    v_add_f32 v23, v23, v39
    v_cvt_pk_bf16_f32 v16, v20, v21
    v_cvt_pk_bf16_f32 v17, v22, v23
    v_lshlrev_b32 v20, 16, v16
    v_and_b32 v21, 0xffff0000, v16
    v_lshlrev_b32 v22, 16, v17
    v_and_b32 v23, 0xffff0000, v17
    v_lshlrev_b32 v36, 16, v26
    v_and_b32 v37, 0xffff0000, v26
    v_lshlrev_b32 v38, 16, v27
    v_and_b32 v39, 0xffff0000, v27
    v_add_f32 v20, v20, v36
    v_add_f32 v21, v21, v37
    v_add_f32 v22, v22, v38
    v_add_f32 v23, v23, v39
    v_cvt_pk_bf16_f32 v16, v20, v21
    v_cvt_pk_bf16_f32 v17, v22, v23
    global_store_dwordx2 v5, v[16:17], s[46:47]
WK_END:
CH_END:
    s_endpgm
.section .rodata,"a"
.p2align 6
.amdhsa_kernel main_kernel
  .amdhsa_next_free_vgpr 512
  .amdhsa_next_free_sgpr 102
  .amdhsa_accum_offset 256
  .amdhsa_group_segment_fixed_size 0
  .amdhsa_kernarg_size 120
  .amdhsa_user_sgpr_count 2
  .amdhsa_user_sgpr_kernarg_segment_ptr 1
  .amdhsa_system_sgpr_workgroup_id_x 1
.end_amdhsa_kernel
```
